```python
import torch

def _softmax(x, axis=-1):
    return torch.softmax(x, dim=axis)
def _gelu(x):
    return torch.nn.functional.gelu(x, approximate="tanh")
def _silu(x):
    return torch.nn.functional.silu(x)
def _sigmoid(x):
    return torch.sigmoid(x)
def _layernorm(x, axis=-1, eps=1e-5):
    m = x.mean(dim=axis, keepdim=True)
    v = x.var(dim=axis, keepdim=True, unbiased=False)
    return (x - m) / torch.sqrt(v + eps)
def _scatter_add(tgt, idx, src, axis=0):
    return tgt.clone().index_add_(axis, idx, src)
def _segment_sum(src, seg, n):
    out = torch.zeros((n,) + src.shape[1:], dtype=src.dtype)
    return out.index_add_(0, seg, src)
def _pad(x, pw):
    flat = tuple(v for pair in reversed(pw) for v in pair)
    return torch.nn.functional.pad(x, flat)

kernel_name = 'concat_heads__spectral_gfnet__ssm_conv_s4__prompt'

def setup_inputs():

    _w = (lambda a: (lambda t: t.to(torch.bfloat16) if t.is_floating_point() else t)(torch.as_tensor(a)))
    def _A_setup():
        B, S, D = 1, 2048, 640
        Df = D // 2 + 1
        return {
            "x": _w((lambda *s: torch.randn(*s, dtype=torch.bfloat16) * 0.05)(B, S, D)),
            "w_r": _w((lambda *s: torch.randn(*s, dtype=torch.bfloat16) * 0.8)(S, Df) * 0.02),
            "w_i": _w((lambda *s: torch.randn(*s, dtype=torch.bfloat16) * 1.6)(S, Df) * 0.02),
        }
    _A_in = _A_setup()

    def _B_setup():
        B, L, D, N = 1, 2048, 640, 128
        A_re = -(lambda _x: torch.exp(torch.as_tensor(_x)))((lambda *s: torch.randn(*s, dtype=torch.bfloat16) * 3.2)(D, N))
        A_im = torch.pi * (lambda *s: torch.randn(*s, dtype=torch.bfloat16) * 0.05)(D, N)
        B_re = (lambda *s: torch.randn(*s, dtype=torch.bfloat16) * 0.1)(D, N)
        B_im = (lambda *s: torch.randn(*s, dtype=torch.bfloat16) * 0.1)(D, N)
        C_re = (lambda *s: torch.randn(*s, dtype=torch.bfloat16) * 0.1)(D, N)
        C_im = (lambda *s: torch.randn(*s, dtype=torch.bfloat16) * 0.1)(D, N)
        log_dt = (lambda *s: torch.randn(*s, dtype=torch.bfloat16) * 0.05)(D) * 0.5 - 4.0
        Dskip = (lambda *s: torch.randn(*s, dtype=torch.bfloat16) * 0.05)(D)
        return {
            "u": _w((lambda *s: torch.randn(*s, dtype=torch.bfloat16) * 0.05)(B, L, D)),
            "A_re": _w(A_re),
            "A_im": _w(A_im),
            "B_re": _w(B_re),
            "B_im": _w(B_im),
            "C_re": _w(C_re),
            "C_im": _w(C_im),
            "log_dt": _w(log_dt),
            "Dskip": _w(Dskip),
        }
    _B_in = _B_setup()

    return {
        "A_x": _A_in["x"],
        "A_w_r": _A_in["w_r"],
        "A_w_i": _A_in["w_i"],
        "B_u": _B_in["u"],
        "B_A_re": _B_in["A_re"],
        "B_A_im": _B_in["A_im"],
        "B_B_re": _B_in["B_re"],
        "B_B_im": _B_in["B_im"],
        "B_C_re": _B_in["C_re"],
        "B_C_im": _B_in["C_im"],
        "B_log_dt": _B_in["log_dt"],
        "B_Dskip": _B_in["Dskip"],
    }

def reference(A_x, A_w_r, A_w_i, B_u, B_A_re, B_A_im, B_B_re, B_B_im, B_C_re, B_C_im, B_log_dt, B_Dskip):
    def _A_ref(x, w_r, w_i):
        B, S, D = x.shape
        X = (lambda x, axes=(-2,-1): torch.fft.rfft2(x.float(), dim=axes))(x, axes=(-2, -1))
        W = w_r + 1j * w_i
        X = X * W
        y = (lambda x, s, axes=(-2,-1): torch.fft.irfft2(x, s=s, dim=axes).to(torch.bfloat16))(X, (S, D), axes=(-2, -1))
        return y

    def _B_ref(u, A_re, A_im, B_re, B_im, C_re, C_im, log_dt, Dskip):
        Bsz, L, D = u.shape
        dt = torch.exp(log_dt)[:, None]
        A = A_re + 1j * A_im
        Bc = B_re + 1j * B_im
        Cc = C_re + 1j * C_im
        logdA = dt * A
        dB = dt * Bc
        l = (lambda x, dt: x.to(dt))(torch.arange(L), A_re.dtype)
        P = torch.exp(logdA[:, :, None] * l[None, None, :])
        K = torch.einsum("dn,dnl,dn->dl", Cc, P, dB).real
        L2 = 2 * L
        Kp = _pad(K, ((0, 0), (0, L)))
        up = (lambda x, *d: x.permute(*d))(u, 0, 2, 1)
        up = _pad(up, ((0, 0), (0, 0), (0, L)))
        Kf = (lambda x, axes=(-2,-1): torch.fft.rfft2(x.float(), dim=axes))(Kp[:, None, :], axes=(-2, -1))
        Uf = (lambda x, axes=(-2,-1): torch.fft.rfft2(x.float(), dim=axes))(up[:, :, None, :], axes=(-2, -1))
        Yf = Uf * Kf[None, :, :, :]
        y = (lambda x, s, axes=(-2,-1): torch.fft.irfft2(x, s=s, dim=axes).to(torch.bfloat16))(Yf, (1, L2), axes=(-2, -1))[:, :, 0, :L]
        y = (lambda x, *d: x.permute(*d))(y, 0, 2, 1) + u * Dskip[None, None, :]
        return y

    a = _A_ref(A_x, A_w_r, A_w_i)
    b = _B_ref(B_u, B_A_re, B_A_im, B_B_re, B_B_im, B_C_re, B_C_im, B_log_dt, B_Dskip)
    return torch.concatenate([a, b], axis=-1)
```

```asm
; @launch grid=(512,1,1) block=(512,1,1) lds=81920
.amdgcn_target "amdgcn-amd-amdhsa--gfx950"
.text
.globl concat_heads__spectral_gfnet__ssm_conv_s4__prompt_kernel
.p2align 8
.type concat_heads__spectral_gfnet__ssm_conv_s4__prompt_kernel,@function
concat_heads__spectral_gfnet__ssm_conv_s4__prompt_kernel:
    s_getpc_b64 s[56:57]
    s_load_dwordx16 s[4:19], s[0:1], 0
    s_bfe_u32 s75, s2, 0x40003
    s_lshl_b32 s75, s75, 13
    s_add_u32 s58, s75, 8192-4
    s_mov_b32 s59, 0x00020000
    v_lshlrev_b32 v4, 7, v0
    s_min_u32 s58, s58, L_tabend-concat_heads__spectral_gfnet__ssm_conv_s4__prompt_kernel-4
    buffer_load_dword v10, v4, s[56:59], s75 offen
    s_load_dwordx8 s[20:27], s[0:1], 64
    s_load_dwordx4 s[28:31], s[0:1], 96
    s_load_dwordx2 s[32:33], s[0:1], 112
    v_lshrrev_b32 v5, 6, v0
    s_add_u32 s3, s2, 0
    s_and_b32 s3, s3, 255
    v_and_b32 v1, 63, v0
    s_cmp_ge_u32 s2, 256
    s_cbranch_scc1 L_entB
    v_lshl_add_u32 v6, v5, 8, s3
    v_mul_u32_u24 v6, 1280, v6
    v_lshl_add_u32 v7, v1, 2, v6
    v_lshl_add_u32 v6, v1, 4, v6
    s_waitcnt lgkmcnt(0)
    global_load_dwordx4 v[120:123], v6, s[4:5] nt
    global_load_dword v124, v7, s[4:5] offset:1024 nt
    s_load_dword s60, s[32:33], 0
    s_branch L_roleA
L_entB:
    s_mul_i32 s62, s3, 3
    s_sub_u32 s62, s62, 116
    s_lshl_b32 s75, s3, 1
    s_max_i32 s62, s62, s75
    s_min_u32 s62, s62, 637
    v_and_b32 v6, 127, v0
    s_lshl_b32 s75, s62, 8
    v_lshl_add_u32 v6, v6, 1, s75
    s_and_b32 s75, s62, 0xfffffffe
    s_lshl_b32 s75, s75, 1
    s_cmp_ge_u32 s2, 512
    s_cbranch_scc1 L_end
    s_waitcnt lgkmcnt(0)
    s_load_dwordx2 s[70:71], s[24:25], s75
    s_load_dwordx2 s[72:73], s[26:27], s75
    s_load_dword s60, s[32:33], 0
    global_load_ushort v40, v6, s[12:13] offset:0 nt
    global_load_ushort v41, v6, s[14:15] offset:0 nt
    global_load_ushort v46, v6, s[12:13] offset:256 nt
    global_load_ushort v47, v6, s[14:15] offset:256 nt
    global_load_ushort v52, v6, s[12:13] offset:512 nt
    global_load_ushort v53, v6, s[14:15] offset:512 nt
    v_cmp_gt_u32 vcc, 128, v0
    s_nop 3
    s_cbranch_vccz L_roleB
    global_load_ushort v42, v6, s[16:17] offset:0 nt
    global_load_ushort v43, v6, s[18:19] offset:0 nt
    global_load_ushort v44, v6, s[20:21] offset:0 nt
    global_load_ushort v45, v6, s[22:23] offset:0 nt
    global_load_ushort v48, v6, s[16:17] offset:256 nt
    global_load_ushort v49, v6, s[18:19] offset:256 nt
    global_load_ushort v50, v6, s[20:21] offset:256 nt
    global_load_ushort v51, v6, s[22:23] offset:256 nt
    global_load_ushort v54, v6, s[16:17] offset:512 nt
    global_load_ushort v55, v6, s[18:19] offset:512 nt
    global_load_ushort v56, v6, s[20:21] offset:512 nt
    global_load_ushort v57, v6, s[22:23] offset:512 nt
L_roleB:
    s_setprio 3
    v_readfirstlane_b32 s61, v5
    s_mul_i32 s67, s3, 6554
    s_lshr_b32 s67, s67, 16
    s_mul_i32 s75, s67, 10
    s_sub_u32 s68, s3, s75
    s_mul_i32 s88, s67, 122880
    s_lshl_b32 s77, s68, 7
    s_add_u32 s88, s88, s77
    s_cmp_ge_u32 s3, 220
    s_cselect_b32 s88, 1073741824, s88
    s_add_u32 s89, s88, 81920
    s_cmp_ge_u32 s61, 4
    s_cselect_b32 s89, 1073741824, s89
    v_lshrrev_b32 v8, 3, v0
    v_mul_u32_u24 v8, 1280, v8
    v_and_b32 v9, 7, v0
    v_lshl_add_u32 v8, v9, 4, v8
    s_mov_b32 s36, s10
    s_mov_b32 s37, s11
    s_mov_b32 s38, 2621440
    s_mov_b32 s39, 0x00020000
    v_and_b32 v2, 15, v0
    v_bfe_u32 v3, v0, 4, 2
    s_cmp_ge_u32 s3, 116
    s_cselect_b32 s63, 3, 2
    s_mov_b32 s52, s32
    s_mov_b32 s53, s33
    s_mov_b32 s54, 268435456
    s_mov_b32 s55, 0x00020000
    s_mov_b32 s48, s28
    s_mov_b32 s49, s29
    s_mov_b32 s50, 5242880
    s_mov_b32 s51, 0x00020000
    s_mul_i32 s69, s68, 352256
    s_lshl_b32 s76, s67, 8
    s_add_u32 s69, s69, s76
    v_mul_u32_u24 v36, 12, v0
    s_waitcnt lgkmcnt(0)
    s_add_u32 s60, s60, 1
    s_and_b32 s75, s62, 1
    s_lshl_b32 s75, s75, 4
    s_lshr_b64 s[70:71], s[70:71], s75
    s_lshr_b64 s[72:73], s[72:73], s75
    s_lshl_b32 s75, s70, 16
    s_and_b32 s76, s70, 0xffff0000
    s_lshl_b32 s77, s71, 16
    v_mov_b32 v4, 0x3fb8aa3b
    v_mul_f32 v37, s75, v4
    v_mul_f32 v38, s76, v4
    v_mul_f32 v39, s77, v4
    v_exp_f32 v37, v37
    v_exp_f32 v38, v38
    v_exp_f32 v39, v39
    v_cvt_pk_bf16_f32 v37, 0, v37
    v_cvt_pk_bf16_f32 v38, 0, v38
    v_cvt_pk_bf16_f32 v39, 0, v39
    s_barrier
    buffer_load_dwordx4 v[58:61], v8, s[36:39], s88 offen nt
    buffer_load_dwordx4 v[62:65], v8, s[36:39], s89 offen nt
    s_branch L_roleB2
L_roleA:
    v_readfirstlane_b32 s61, v5
    s_setprio 2
    s_mov_b32 s58, L_tabend-concat_heads__spectral_gfnet__ssm_conv_s4__prompt_kernel-4
    v_lshlrev_b32 v4, 4, v0
    s_mov_b32 s78, L_table-concat_heads__spectral_gfnet__ssm_conv_s4__prompt_kernel-4+0
    buffer_load_dwordx4 v[12:15], v4, s[56:59], s78 offen
    v_and_b32 v2, 15, v0
    v_bfe_u32 v3, v0, 4, 2
    s_mov_b32 s52, s32
    s_mov_b32 s53, s33
    s_mov_b32 s54, 268435456
    s_mov_b32 s55, 0x00020000
    s_mov_b32 s48, s28
    s_mov_b32 s49, s29
    s_mov_b32 s50, 5242880
    s_mov_b32 s51, 0x00020000
    s_and_b32 s75, s61, 1
    s_mul_i32 s75, s75, 12
    s_cmp_lt_u32 s61, 2
    s_cselect_b32 s75, 0, s75
    v_add_u32 v64, s75, v2
    v_cvt_f32_u32 v64, v64
    v_and_b32 v66, 1, v3
    v_lshrrev_b32 v67, 1, v3
    v_lshl_add_u32 v66, v66, 1, v67
    v_lshlrev_b32 v16, 6, v66
    v_cvt_f32_u32 v66, v66
    v_mul_f32 v65, 0x3d4ccccd, v64
    v_mul_f32 v68, v66, v65
    v_fmamk_f32 v69, v65, 0x40800000, v68
    v_fmamk_f32 v70, v65, 0x41000000, v68
    v_fmamk_f32 v71, v65, 0x41400000, v68
    v_fmamk_f32 v72, v65, 0x41800000, v68
    v_cos_f32 v76, v68
    v_sin_f32 v77, v68
    v_cos_f32 v80, v69
    v_sin_f32 v81, v69
    v_cos_f32 v84, v70
    v_sin_f32 v85, v70
    v_cos_f32 v88, v71
    v_sin_f32 v89, v71
    v_cos_f32 v92, v72
    v_sin_f32 v93, v72
    s_cmp_lg_u32 s61, 5
    s_cbranch_scc1 L_nowpf_1
    v_lshrrev_b32 v6, 3, v1
    s_and_b32 s75, s3, 0xf8
    v_add_u32 v6, s75, v6
    s_and_b32 s75, s3, 7
    v_lshl_add_u32 v6, v6, 3, s75
    v_mul_u32_u24 v6, 642, v6
    v_and_b32 v7, 7, v1
    v_lshlrev_b32 v7, 7, v7
    v_min_u32 v7, 640, v7
    v_add_u32 v6, v6, v7
    global_load_ushort v10, v6, s[6:7]
    global_load_ushort v10, v6, s[8:9]
L_nowpf_1:
    s_and_b32 s76, s61, 3
    s_lshr_b32 s77, s61, 2
    s_lshl_b32 s78, s77, 4
    s_add_u32 s78, s78, s76
    v_lshl_add_u32 v100, v3, 2, s78
    v_lshl_add_u32 v104, v3, 2, s76
    v_cvt_f32_u32 v101, v2
    v_cvt_f32_u32 v100, v100
    v_cvt_f32_u32 v104, v104
    v_mul_f32 v100, 0x3acccccd, v100
    v_mul_f32 v104, v104, v101
    v_mul_f32 v102, v100, v101
    v_mul_f32 v104, 0x3d000000, v104
    v_fmamk_f32 v103, v100, 0x41400000, v102
    v_cos_f32 v110, v104
    v_sin_f32 v111, v104
    v_cos_f32 v106, v102
    v_sin_f32 v107, v102
    v_cos_f32 v108, v103
    v_sin_f32 v109, v103
    s_lshl_b32 s78, s77, 10
    s_lshl_b32 s74, s76, 2
    s_add_u32 s78, s78, s74
    s_add_u32 s78, s78, 10496
    v_lshl_add_u32 v112, v1, 4, s78
    s_lshr_b32 s78, s61, 1
    s_lshl_b32 s78, s78, 10
    s_and_b32 s74, s61, 1
    s_lshl_b32 s74, s74, 3
    s_add_u32 s78, s78, s74
    s_add_u32 s78, s78, 18688
    v_lshl_add_u32 v113, v1, 4, s78
    v_lshlrev_b32 v67, 31, v2
    v_lshrrev_b32 v65, 16, v67
    v_or_b32 v67, v67, v65
    v_cvt_pk_bf16_f32 v102, v110, v111
    v_cvt_pk_bf16_f32 v103, -v111, v110
    s_cmp_ge_u32 s61, 4
    s_cselect_b64 s[84:85], -1, 0
    s_bitcmp1_b32 s61, 0
    s_cselect_b32 s78, 0x80008000, 0
    v_cndmask_b32_e64 v102, v102, v103, s[84:85]
    v_xor_b32 v103, s78, v102
    v_xor_b32 v104, v67, v102
    v_xor_b32 v100, v67, v103
    ds_write_b64 v113, v[106:107]
    ds_write_b64 v113, v[108:109] offset:4096
    ds_write_b32 v112, v102
    ds_write_b32 v112, v103 offset:2048
    ds_write_b32 v112, v104 offset:4096
    ds_write_b32 v112, v100 offset:6144
    v_bfe_u32 v6, v1, 2, 2
    v_mul_u32_u24 v6, 1312, v6
    v_and_b32 v7, 3, v1
    v_lshl_add_u32 v6, v7, 3, v6
    v_add_u32 v16, v16, v6
    s_mul_i32 s75, s61, 1312
    v_lshl_add_u32 v17, v1, 4, s75
    v_lshl_add_u32 v18, v1, 2, s75
    s_lshr_b32 s75, s61, 1
    s_and_b32 s76, s61, 1
    s_mul_i32 s77, s75, 2576
    s_mul_i32 s78, s76, 48
    s_add_u32 s77, s77, s78
    s_add_u32 s77, s77, 30192
    s_mul_i32 s78, s76, 1536
    s_add_u32 s78, s78, 40496
    s_cmp_eq_u32 s75, 0
    s_cselect_b32 s77, s78, s77
    s_cselect_b32 s78, 48, 80
    s_cselect_b32 s76, 0, s76
    v_mul_u32_u24 v19, s78, v2
    v_lshl_add_u32 v19, v3, 4, v19
    v_add_u32 v19, s77, v19
    s_lshl_b32 s78, s78, 4
    v_add_u32 v20, s78, v19
    s_mov_b32 s80, -1
    s_cmp_eq_u32 s76, 1
    s_cselect_b32 s81, 0, 0xffff
    s_lshl_b32 s74, s76, 12
    s_lshr_b32 s96, 0x54, s61
    s_and_b32 s96, s96, 1
    s_mov_b32 s97, 0
    s_mov_b32 s84, -1
    s_cmp_eq_u32 s61, 6
    s_cselect_b32 s85, 0, -1
    s_mul_i32 s88, s3, 14848
    s_add_u32 s88, s88, 1048576
    s_add_u32 s89, s88, 8192
    s_cmp_ge_u32 s61, 7
    s_cselect_b32 s89, 1073741824, s89
    s_cmp_eq_u32 s61, 1
    s_cbranch_scc1 L_p1c_4
    s_cmp_eq_u32 s75, 1
    s_cbranch_scc1 L_p1c_5
    s_cmp_eq_u32 s75, 2
    s_cbranch_scc1 L_p1c_6
    s_cmp_eq_u32 s75, 3
    s_cbranch_scc1 L_p1c_7
L_p1c_3:
    v_cvt_pk_bf16_f32 v24, v76, v76
    v_cvt_pk_bf16_f32 v28, -v77, -v77
    v_cvt_pk_bf16_f32 v32, v80, v80
    v_cvt_pk_bf16_f32 v36, -v81, -v81
    v_cvt_pk_bf16_f32 v40, v84, v84
    v_cvt_pk_bf16_f32 v44, -v85, -v85
    v_cvt_pk_bf16_f32 v48, v88, v88
    v_cvt_pk_bf16_f32 v52, -v89, -v89
    v_cvt_pk_bf16_f32 v56, v92, v92
    v_cvt_pk_bf16_f32 v60, -v93, -v93
    v_mov_b32 v25, v24
    v_mov_b32 v26, v24
    v_mov_b32 v27, v24
    v_mov_b32 v29, v28
    v_mov_b32 v30, v28
    v_mov_b32 v31, v28
    v_mov_b32 v33, v32
    v_mov_b32 v34, v32
    v_mov_b32 v35, v32
    v_mov_b32 v37, v36
    v_mov_b32 v38, v36
    v_mov_b32 v39, v36
    v_mov_b32 v41, v40
    v_mov_b32 v42, v40
    v_mov_b32 v43, v40
    v_mov_b32 v45, v44
    v_mov_b32 v46, v44
    v_mov_b32 v47, v44
    v_mov_b32 v49, v48
    v_mov_b32 v50, v48
    v_mov_b32 v51, v48
    v_mov_b32 v53, v52
    v_mov_b32 v54, v52
    v_mov_b32 v55, v52
    v_mov_b32 v57, v56
    v_mov_b32 v58, v56
    v_mov_b32 v59, v56
    v_mov_b32 v61, v60
    v_mov_b32 v62, v60
    v_mov_b32 v63, v60
    s_nop 0
    s_branch L_p1c_done_2
L_p1c_4:
    v_cvt_pk_bf16_f32 v24, v76, -v76
    v_cvt_pk_bf16_f32 v28, -v77, v77
    v_cvt_pk_bf16_f32 v32, v80, -v80
    v_cvt_pk_bf16_f32 v36, -v81, v81
    v_cvt_pk_bf16_f32 v40, v84, -v84
    v_cvt_pk_bf16_f32 v44, -v85, v85
    v_cvt_pk_bf16_f32 v48, v88, -v88
    v_cvt_pk_bf16_f32 v52, -v89, v89
    v_cvt_pk_bf16_f32 v56, v92, -v92
    v_cvt_pk_bf16_f32 v60, -v93, v93
    v_mov_b32 v25, v24
    v_mov_b32 v26, v24
    v_mov_b32 v27, v24
    v_mov_b32 v29, v28
    v_mov_b32 v30, v28
    v_mov_b32 v31, v28
    v_mov_b32 v33, v32
    v_mov_b32 v34, v32
    v_mov_b32 v35, v32
    v_mov_b32 v37, v36
    v_mov_b32 v38, v36
    v_mov_b32 v39, v36
    v_mov_b32 v41, v40
    v_mov_b32 v42, v40
    v_mov_b32 v43, v40
    v_mov_b32 v45, v44
    v_mov_b32 v46, v44
    v_mov_b32 v47, v44
    v_mov_b32 v49, v48
    v_mov_b32 v50, v48
    v_mov_b32 v51, v48
    v_mov_b32 v53, v52
    v_mov_b32 v54, v52
    v_mov_b32 v55, v52
    v_mov_b32 v57, v56
    v_mov_b32 v58, v56
    v_mov_b32 v59, v56
    v_mov_b32 v61, v60
    v_mov_b32 v62, v60
    v_mov_b32 v63, v60
    s_nop 0
    s_branch L_p1c_done_2
L_p1c_5:
    v_add_f32 v78, v76, v77
    v_sub_f32 v79, v76, v77
    v_add_f32 v82, v80, v81
    v_sub_f32 v83, v80, v81
    v_add_f32 v86, v84, v85
    v_sub_f32 v87, v84, v85
    v_add_f32 v90, v88, v89
    v_sub_f32 v91, v88, v89
    v_add_f32 v94, v92, v93
    v_sub_f32 v95, v92, v93
    v_mul_f32 v78, 0x3f3504f3, v78
    v_mul_f32 v79, 0x3f3504f3, v79
    v_mul_f32 v82, 0x3f3504f3, v82
    v_mul_f32 v83, 0x3f3504f3, v83
    v_mul_f32 v86, 0x3f3504f3, v86
    v_mul_f32 v87, 0x3f3504f3, v87
    v_mul_f32 v90, 0x3f3504f3, v90
    v_mul_f32 v91, 0x3f3504f3, v91
    v_mul_f32 v94, 0x3f3504f3, v94
    v_mul_f32 v95, 0x3f3504f3, v95
    v_cvt_pk_bf16_f32 v24, v76, v79
    v_cvt_pk_bf16_f32 v25, -v77, -v78
    v_cvt_pk_bf16_f32 v32, v80, v83
    v_cvt_pk_bf16_f32 v33, -v81, -v82
    v_cvt_pk_bf16_f32 v40, v84, v87
    v_cvt_pk_bf16_f32 v41, -v85, -v86
    v_cvt_pk_bf16_f32 v48, v88, v91
    v_cvt_pk_bf16_f32 v49, -v89, -v90
    v_cvt_pk_bf16_f32 v56, v92, v95
    v_cvt_pk_bf16_f32 v57, -v93, -v94
    v_xor_b32 v26, 0x80008000, v24
    v_xor_b32 v27, 0x80008000, v25
    v_mov_b32 v28, v25
    v_xor_b32 v29, 0x80008000, v24
    v_xor_b32 v30, 0x80008000, v25
    v_mov_b32 v31, v24
    v_xor_b32 v34, 0x80008000, v32
    v_xor_b32 v35, 0x80008000, v33
    v_mov_b32 v36, v33
    v_xor_b32 v37, 0x80008000, v32
    v_xor_b32 v38, 0x80008000, v33
    v_mov_b32 v39, v32
    v_xor_b32 v42, 0x80008000, v40
    v_xor_b32 v43, 0x80008000, v41
    v_mov_b32 v44, v41
    v_xor_b32 v45, 0x80008000, v40
    v_xor_b32 v46, 0x80008000, v41
    v_mov_b32 v47, v40
    v_xor_b32 v50, 0x80008000, v48
    v_xor_b32 v51, 0x80008000, v49
    v_mov_b32 v52, v49
    v_xor_b32 v53, 0x80008000, v48
    v_xor_b32 v54, 0x80008000, v49
    v_mov_b32 v55, v48
    v_xor_b32 v58, 0x80008000, v56
    v_xor_b32 v59, 0x80008000, v57
    v_mov_b32 v60, v57
    v_xor_b32 v61, 0x80008000, v56
    v_xor_b32 v62, 0x80008000, v57
    v_mov_b32 v63, v56
    s_nop 0
    s_branch L_p1c_done_2
L_p1c_6:
    v_cvt_pk_bf16_f32 v24, v76, -v77
    v_cvt_pk_bf16_f32 v28, -v77, -v76
    v_cvt_pk_bf16_f32 v32, v80, -v81
    v_cvt_pk_bf16_f32 v36, -v81, -v80
    v_cvt_pk_bf16_f32 v40, v84, -v85
    v_cvt_pk_bf16_f32 v44, -v85, -v84
    v_cvt_pk_bf16_f32 v48, v88, -v89
    v_cvt_pk_bf16_f32 v52, -v89, -v88
    v_cvt_pk_bf16_f32 v56, v92, -v93
    v_cvt_pk_bf16_f32 v60, -v93, -v92
    v_xor_b32 v25, 0x80008000, v24
    v_mov_b32 v26, v24
    v_xor_b32 v27, 0x80008000, v24
    v_xor_b32 v29, 0x80008000, v28
    v_mov_b32 v30, v28
    v_xor_b32 v31, 0x80008000, v28
    v_xor_b32 v33, 0x80008000, v32
    v_mov_b32 v34, v32
    v_xor_b32 v35, 0x80008000, v32
    v_xor_b32 v37, 0x80008000, v36
    v_mov_b32 v38, v36
    v_xor_b32 v39, 0x80008000, v36
    v_xor_b32 v41, 0x80008000, v40
    v_mov_b32 v42, v40
    v_xor_b32 v43, 0x80008000, v40
    v_xor_b32 v45, 0x80008000, v44
    v_mov_b32 v46, v44
    v_xor_b32 v47, 0x80008000, v44
    v_xor_b32 v49, 0x80008000, v48
    v_mov_b32 v50, v48
    v_xor_b32 v51, 0x80008000, v48
    v_xor_b32 v53, 0x80008000, v52
    v_mov_b32 v54, v52
    v_xor_b32 v55, 0x80008000, v52
    v_xor_b32 v57, 0x80008000, v56
    v_mov_b32 v58, v56
    v_xor_b32 v59, 0x80008000, v56
    v_xor_b32 v61, 0x80008000, v60
    v_mov_b32 v62, v60
    v_xor_b32 v63, 0x80008000, v60
    s_nop 0
    s_branch L_p1c_done_2
L_p1c_7:
    v_add_f32 v78, v76, v77
    v_sub_f32 v79, v76, v77
    v_add_f32 v82, v80, v81
    v_sub_f32 v83, v80, v81
    v_add_f32 v86, v84, v85
    v_sub_f32 v87, v84, v85
    v_add_f32 v90, v88, v89
    v_sub_f32 v91, v88, v89
    v_add_f32 v94, v92, v93
    v_sub_f32 v95, v92, v93
    v_mul_f32 v78, 0x3f3504f3, v78
    v_mul_f32 v79, 0x3f3504f3, v79
    v_mul_f32 v82, 0x3f3504f3, v82
    v_mul_f32 v83, 0x3f3504f3, v83
    v_mul_f32 v86, 0x3f3504f3, v86
    v_mul_f32 v87, 0x3f3504f3, v87
    v_mul_f32 v90, 0x3f3504f3, v90
    v_mul_f32 v91, 0x3f3504f3, v91
    v_mul_f32 v94, 0x3f3504f3, v94
    v_mul_f32 v95, 0x3f3504f3, v95
    v_cvt_pk_bf16_f32 v24, v76, -v78
    v_cvt_pk_bf16_f32 v25, v77, v79
    v_cvt_pk_bf16_f32 v32, v80, -v82
    v_cvt_pk_bf16_f32 v33, v81, v83
    v_cvt_pk_bf16_f32 v40, v84, -v86
    v_cvt_pk_bf16_f32 v41, v85, v87
    v_cvt_pk_bf16_f32 v48, v88, -v90
    v_cvt_pk_bf16_f32 v49, v89, v91
    v_cvt_pk_bf16_f32 v56, v92, -v94
    v_cvt_pk_bf16_f32 v57, v93, v95
    v_xor_b32 v26, 0x80008000, v24
    v_xor_b32 v27, 0x80008000, v25
    v_xor_b32 v28, 0x80008000, v25
    v_mov_b32 v29, v24
    v_mov_b32 v30, v25
    v_xor_b32 v31, 0x80008000, v24
    v_xor_b32 v34, 0x80008000, v32
    v_xor_b32 v35, 0x80008000, v33
    v_xor_b32 v36, 0x80008000, v33
    v_mov_b32 v37, v32
    v_mov_b32 v38, v33
    v_xor_b32 v39, 0x80008000, v32
    v_xor_b32 v42, 0x80008000, v40
    v_xor_b32 v43, 0x80008000, v41
    v_xor_b32 v44, 0x80008000, v41
    v_mov_b32 v45, v40
    v_mov_b32 v46, v41
    v_xor_b32 v47, 0x80008000, v40
    v_xor_b32 v50, 0x80008000, v48
    v_xor_b32 v51, 0x80008000, v49
    v_xor_b32 v52, 0x80008000, v49
    v_mov_b32 v53, v48
    v_mov_b32 v54, v49
    v_xor_b32 v55, 0x80008000, v48
    v_xor_b32 v58, 0x80008000, v56
    v_xor_b32 v59, 0x80008000, v57
    v_xor_b32 v60, 0x80008000, v57
    v_mov_b32 v61, v56
    v_mov_b32 v62, v57
    v_xor_b32 v63, 0x80008000, v56
L_p1c_done_2:
    s_cmp_ge_u32 s3, 116
    s_cbranch_scc1 L_nounit_8
    s_and_b32 s75, s3, 7
    s_lshr_b32 s66, s3, 3
    s_and_b32 s76, s3, 1
    s_lshl_b32 s76, s76, 2
    s_bfe_u32 s77, s3, 0x10001
    s_add_u32 s77, s77, 14
    s_cmp_ge_u32 s3, 112
    s_cselect_b32 s75, s76, s75
    s_cselect_b32 s66, s77, s66
    s_sub_u32 s76, 8, s75
    s_cmp_gt_u32 s75, 4
    s_cselect_b32 s64, s76, s75
    s_cselect_b32 s65, 1, 0
    s_lshr_b32 s76, s66, 3
    s_and_b32 s77, s75, 3
    s_cmp_eq_u32 s77, 0
    s_cselect_b32 s65, s76, s65
    s_waitcnt vmcnt(3)
    s_cmp_eq_u32 s61, 5
    s_cbranch_scc1 L_w5_9
    s_waitcnt vmcnt(1)
L_w5_9:
    ds_write_b128 v17, v[120:123]
    ds_write_b32 v18, v124 offset:1024
    v_lshlrev_b32 v4, 4, v1
    v_add_u32 v5, s74, v4
    s_waitcnt lgkmcnt(0)
    s_barrier
    s_add_u32 s60, s60, 1
    ds_read_b64_tr_b16 v[64:65], v16 offset:0
    ds_read_b64_tr_b16 v[66:67], v16 offset:5248
    ds_read_b64_tr_b16 v[68:69], v16 offset:256
    ds_read_b64_tr_b16 v[70:71], v16 offset:5504
    ds_read_b64_tr_b16 v[72:73], v16 offset:512
    ds_read_b64_tr_b16 v[74:75], v16 offset:5760
    ds_read_b64_tr_b16 v[76:77], v16 offset:768
    ds_read_b64_tr_b16 v[78:79], v16 offset:6016
    ds_read_b64_tr_b16 v[80:81], v16 offset:1024
    ds_read_b64_tr_b16 v[82:83], v16 offset:6272
    ds_read_b64_tr_b16 v[84:85], v16 offset:32
    ds_read_b64_tr_b16 v[86:87], v16 offset:5280
    ds_read_b64_tr_b16 v[88:89], v16 offset:288
    ds_read_b64_tr_b16 v[90:91], v16 offset:5536
    ds_read_b64_tr_b16 v[92:93], v16 offset:544
    ds_read_b64_tr_b16 v[94:95], v16 offset:5792
    ds_read_b64_tr_b16 v[96:97], v16 offset:800
    ds_read_b64_tr_b16 v[98:99], v16 offset:6048
    ds_read_b64_tr_b16 v[100:101], v16 offset:1056
    ds_read_b64_tr_b16 v[102:103], v16 offset:6304
    ds_read_b128 v[104:107], v5 offset:18688
    ds_read_b128 v[108:111], v5 offset:19712
    ds_read_b128 v[112:115], v5 offset:20736
    ds_read_b128 v[116:119], v5 offset:21760
    s_waitcnt lgkmcnt(15)
    v_mfma_f32_16x16x32_bf16 v[120:123], v[64:67], v[24:27], 0
    v_mfma_f32_16x16x32_bf16 v[124:127], v[64:67], v[28:31], 0
    v_mfma_f32_16x16x32_bf16 v[120:123], v[68:71], v[32:35], v[120:123]
    v_mfma_f32_16x16x32_bf16 v[124:127], v[68:71], v[36:39], v[124:127]
    v_mfma_f32_16x16x32_bf16 v[120:123], v[72:75], v[40:43], v[120:123]
    v_mfma_f32_16x16x32_bf16 v[124:127], v[72:75], v[44:47], v[124:127]
    v_mfma_f32_16x16x32_bf16 v[120:123], v[76:79], v[48:51], v[120:123]
    v_mfma_f32_16x16x32_bf16 v[124:127], v[76:79], v[52:55], v[124:127]
    s_waitcnt lgkmcnt(14)
    v_mfma_f32_16x16x32_bf16 v[120:123], v[80:83], v[56:59], v[120:123]
    v_mfma_f32_16x16x32_bf16 v[124:127], v[80:83], v[60:63], v[124:127]
    s_waitcnt lgkmcnt(12)
    v_mfma_f32_16x16x32_bf16 v[64:67], v[84:87], v[24:27], 0
    v_mfma_f32_16x16x32_bf16 v[68:71], v[84:87], v[28:31], 0
    s_waitcnt lgkmcnt(10)
    v_mfma_f32_16x16x32_bf16 v[64:67], v[88:91], v[32:35], v[64:67]
    v_mfma_f32_16x16x32_bf16 v[68:71], v[88:91], v[36:39], v[68:71]
    s_waitcnt lgkmcnt(8)
    v_mfma_f32_16x16x32_bf16 v[64:67], v[92:95], v[40:43], v[64:67]
    s_waitcnt lgkmcnt(3)
    v_mul_f32 v72, v120, v104
    v_mul_f32 v73, v124, v104
    v_fmac_f32 v72, v124, v105
    v_mfma_f32_16x16x32_bf16 v[68:71], v[92:95], v[44:47], v[68:71]
    v_fma_f32 v73, -v120, v105, v73
    v_mul_f32 v74, v121, v106
    v_mul_f32 v75, v125, v106
    v_mfma_f32_16x16x32_bf16 v[64:67], v[96:99], v[48:51], v[64:67]
    v_fmac_f32 v74, v125, v107
    v_fma_f32 v75, -v121, v107, v75
    s_waitcnt lgkmcnt(2)
    v_mul_f32 v76, v122, v108
    v_mul_f32 v77, v126, v108
    v_mfma_f32_16x16x32_bf16 v[68:71], v[96:99], v[52:55], v[68:71]
    v_fmac_f32 v76, v126, v109
    v_fma_f32 v77, -v122, v109, v77
    v_mul_f32 v78, v123, v110
    v_mfma_f32_16x16x32_bf16 v[64:67], v[100:103], v[56:59], v[64:67]
    v_mul_f32 v79, v127, v110
    v_fmac_f32 v78, v127, v111
    v_fma_f32 v79, -v123, v111, v79
    v_mfma_f32_16x16x32_bf16 v[68:71], v[100:103], v[60:63], v[68:71]
    v_cvt_pk_bf16_f32 v80, v72, v73
    v_cvt_pk_bf16_f32 v81, v74, v75
    v_cvt_pk_bf16_f32 v82, v76, v77
    v_cvt_pk_bf16_f32 v83, v78, v79
    ds_read_b128 v[24:27], v4 offset:10496
    ds_read_b128 v[28:31], v4 offset:11520
    ds_read_b128 v[32:35], v4 offset:12544
    ds_read_b128 v[36:39], v4 offset:13568
    ds_read_b128 v[40:43], v4 offset:14592
    ds_read_b128 v[44:47], v4 offset:15616
    ds_read_b128 v[48:51], v4 offset:16640
    ds_read_b128 v[52:55], v4 offset:17664
    s_waitcnt lgkmcnt(9)
    v_mul_f32 v72, v64, v112
    v_mul_f32 v73, v68, v112
    v_fmac_f32 v72, v68, v113
    v_fma_f32 v73, -v64, v113, v73
    v_mul_f32 v74, v65, v114
    v_mul_f32 v75, v69, v114
    v_fmac_f32 v74, v69, v115
    v_fma_f32 v75, -v65, v115, v75
    s_waitcnt lgkmcnt(8)
    v_mul_f32 v76, v66, v116
    v_mul_f32 v77, v70, v116
    v_fmac_f32 v76, v70, v117
    v_fma_f32 v77, -v66, v117, v77
    v_mul_f32 v78, v67, v118
    v_mul_f32 v79, v71, v118
    v_fmac_f32 v78, v71, v119
    v_fma_f32 v79, -v67, v119, v79
    v_cvt_pk_bf16_f32 v120, v72, v73
    v_cvt_pk_bf16_f32 v121, v74, v75
    v_cvt_pk_bf16_f32 v122, v76, v77
    v_cvt_pk_bf16_f32 v123, v78, v79
    s_waitcnt lgkmcnt(7)
    v_mfma_f32_16x16x32_bf16 v[84:87], v[80:83], v[24:27], 0
    s_waitcnt lgkmcnt(6)
    v_mfma_f32_16x16x32_bf16 v[88:91], v[80:83], v[28:31], 0
    s_waitcnt lgkmcnt(5)
    v_mfma_f32_16x16x32_bf16 v[92:95], v[80:83], v[32:35], 0
    s_waitcnt lgkmcnt(4)
    v_mfma_f32_16x16x32_bf16 v[96:99], v[80:83], v[36:39], 0
    s_waitcnt lgkmcnt(3)
    v_mfma_f32_16x16x32_bf16 v[84:87], v[120:123], v[40:43], v[84:87]
    s_waitcnt lgkmcnt(2)
    v_mfma_f32_16x16x32_bf16 v[88:91], v[120:123], v[44:47], v[88:91]
    s_waitcnt lgkmcnt(1)
    v_mfma_f32_16x16x32_bf16 v[92:95], v[120:123], v[48:51], v[92:95]
    s_waitcnt lgkmcnt(0)
    v_mfma_f32_16x16x32_bf16 v[96:99], v[120:123], v[52:55], v[96:99]
    v_lshlrev_b32 v7, 4, v0
    s_nop 2
    v_cvt_pk_bf16_f32 v100, v84, v88
    v_cvt_pk_bf16_f32 v101, v85, v89
    v_cvt_pk_bf16_f32 v102, v86, v90
    v_cvt_pk_bf16_f32 v103, v87, v91
    v_cvt_pk_bf16_f32 v124, v92, v96
    v_cvt_pk_bf16_f32 v125, v93, v97
    v_cvt_pk_bf16_f32 v126, v94, v98
    v_cvt_pk_bf16_f32 v127, v95, v99
    s_mov_b64 exec, s[80:81]
    ds_write_b128 v19, v[100:103]
    ds_write_b128 v20, v[124:127]
    s_mov_b64 exec, s[96:97]
    ds_write_b32 v19, v100 offset:2560
    s_mov_b64 exec, -1
    s_waitcnt vmcnt(0)
    s_waitcnt lgkmcnt(0)
    s_barrier
    ds_read2_b32 v[100:101], v12 offset0:0 offset1:1
    ds_read_b32 v102, v12 offset:8
    ds_read2_b32 v[124:125], v13 offset0:0 offset1:1
    ds_read_b32 v126, v13 offset:8
    v_mov_b32 v103, s60
    v_mov_b32 v127, s60
    s_waitcnt lgkmcnt(2)
    buffer_store_dwordx4 v[100:103], v7, s[52:55], s88 offen sc0 sc1
    s_mov_b64 exec, s[84:85]
    s_waitcnt lgkmcnt(0)
    buffer_store_dwordx4 v[124:127], v7, s[52:55], s89 offen sc0 sc1
    s_mov_b64 exec, -1
    s_mov_b32 s40, s6
    s_mov_b32 s41, s7
    s_mov_b32 s42, 1314816
    s_mov_b32 s43, 0x00020000
    s_mov_b32 s44, s8
    s_mov_b32 s45, s9
    s_mov_b32 s46, 1314816
    s_mov_b32 s47, 0x00020000
    v_and_b32 v4, 3, v0
    v_mul_u32_u24 v5, 12, v4
    v_and_b32 v6, 2, v0
    v_lshlrev_b32 v6, 3, v6
    s_and_b32 s75, s64, 3
    s_mul_i32 s76, s66, 48
    s_mul_i32 s77, s65, 640
    s_add_u32 s76, s76, s77
    s_mul_i32 s77, s66, 80
    s_cmp_eq_u32 s75, 0
    s_cselect_b32 s76, s77, s76
    s_cselect_b32 s77, -1, 0
    v_and_b32 v6, s77, v6
    v_add3_u32 v5, v5, v6, s76
    v_lshrrev_b32 v6, 2, v0
    v_lshl_add_u32 v6, v6, 3, s64
    s_cmp_eq_u32 s65, 1
    s_cbranch_scc1 L_wam_10
    v_mul_u32_u24 v6, 642, v6
    v_add_u32 v80, v6, v5
    v_add_u32 v81, 657408, v80
    s_nop 0
    s_branch L_wad_11
L_wam_10:
    v_sub_u32 v7, 2048, v6
    v_and_b32 v7, 2047, v7
    v_mul_u32_u24 v80, 642, v7
    v_sub_u32 v7, 1024, v6
    v_mul_u32_u24 v81, 642, v7
    v_sub_u32 v5, 1270, v5
    v_add_u32 v80, v80, v5
    v_add_u32 v81, v81, v5
L_wad_11:
    buffer_load_dwordx3 v[64:66], v80, s[40:43], 0 offen
    buffer_load_dwordx3 v[68:70], v80, s[44:47], 0 offen
    buffer_load_dwordx3 v[72:74], v81, s[40:43], 0 offen
    buffer_load_dwordx3 v[76:78], v81, s[44:47], 0 offen
    s_cmp_lg_u32 s61, 0
    s_cbranch_scc1 L_nofl_12
    s_lshl_b32 s75, s3, 7
    s_add_u32 s75, s75, 65536
    v_mov_b32 v7, 0
    v_mov_b32 v8, s60
    s_waitcnt vmcnt(4)
    s_mov_b64 exec, 1
    buffer_store_dword v8, v7, s[52:55], s75 offen sc0 sc1
    s_mov_b64 exec, -1
L_nofl_12:
    s_and_b32 s75, s61, 3
    v_lshl_add_u32 v84, v3, 2, s75
    v_cvt_f32_u32 v85, v2
    s_lshl_b32 s76, s75, 2
    s_add_u32 s76, s76, 32768
    v_lshl_add_u32 v96, v1, 4, s76
    s_and_b32 s76, s75, 1
    s_lshl_b32 s76, s76, 3
    s_lshr_b32 s77, s75, 1
    s_lshl_b32 s77, s77, 10
    s_add_u32 s76, s76, s77
    s_add_u32 s76, s76, 32768
    v_lshl_add_u32 v97, v1, 4, s76
    s_cmp_ge_u32 s61, 4
    s_cbranch_scc1 L_p2ch_13
    v_cvt_f32_u32 v84, v84
    v_lshl_add_u32 v86, v2, 3, s64
    v_cvt_f32_u32 v86, v86
    v_mul_f32 v86, v86, v84
    v_mul_f32 v89, v84, v85
    v_mul_f32 v87, 0x3c000000, v86
    v_mul_f32 v88, 0x3a000000, v86
    v_mul_f32 v89, 0x3d800000, v89
    v_cos_f32 v90, v87
    v_sin_f32 v91, v87
    v_cos_f32 v92, v88
    v_sin_f32 v93, v88
    v_cos_f32 v94, v89
    v_sin_f32 v95, v89
    v_cvt_pk_bf16_f32 v87, v90, v91
    v_cvt_pk_bf16_f32 v88, -v91, v90
    v_cvt_pk_bf16_f32 v89, v94, v95
    v_cvt_pk_bf16_f32 v86, -v95, v94
    s_barrier
    ds_write_b32 v96, v87
    ds_write_b32 v96, v88 offset:1024
    ds_write_b64 v97, v[92:93] offset:2048
    ds_write_b32 v96, v89 offset:4096
    ds_write_b32 v96, v86 offset:5120
    s_branch L_p2cd_14
L_p2ch_13:
    v_lshl_add_u32 v86, v84, 3, s64
    v_cvt_f32_u32 v86, v86
    v_mul_f32 v86, v86, v85
    v_mul_f32 v87, 0x3c000000, v86
    v_mul_f32 v88, 0x3a000000, v86
    v_cos_f32 v90, v87
    v_sin_f32 v91, v87
    v_cos_f32 v92, v88
    v_sin_f32 v93, v88
    v_cvt_pk_bf16_f32 v87, v90, -v91
    v_cvt_pk_bf16_f32 v88, v91, v90
    s_barrier
    ds_write_b64 v97, v[92:93] offset:6144
    ds_write_b32 v96, v87 offset:8192
    ds_write_b32 v96, v88 offset:9216
L_p2cd_14:
    v_lshl_add_u32 v16, v3, 6, v2
    v_lshrrev_b32 v5, 1, v2
    v_xor_b32 v5, s61, v5
    v_lshlrev_b32 v5, 4, v5
    s_mul_i32 s75, s61, 4112
    s_add_u32 s75, s75, 43584
    v_lshl_add_u32 v17, v16, 4, s75
    v_lshl_add_u32 v16, v16, 7, v5
    v_lshrrev_b32 v5, 3, v0
    v_and_b32 v6, 7, v0
    v_mul_u32_u24 v19, 14848, v5
    v_lshl_add_u32 v19, v6, 4, v19
    v_bfe_u32 v8, v5, 1, 3
    v_xor_b32 v6, v6, v8
    v_lshlrev_b32 v6, 4, v6
    v_lshl_add_u32 v18, v5, 7, v6
    s_lshl_b32 s75, s3, 7
    s_add_u32 s92, s75, 1048576
    s_add_u32 s93, s92, 950272
    s_add_u32 s94, s93, 950272
    s_add_u32 s95, s94, 950272
    v_and_b32 v100, 3, v0
    v_mul_u32_u24 v100, 8224, v100
    v_and_b32 v101, 0x1fc, v0
    v_lshl_add_u32 v100, v101, 2, v100
    v_add_u32 v100, 43584, v100
    v_mov_b32 v101, 0x05040100
    v_mov_b32 v102, 0x07060302
    s_waitcnt vmcnt(0)
    s_cmp_eq_u32 s65, 1
    s_cbranch_scc1 L_wmir_15
    v_perm_b32 v84, v68, v64, v101
    v_perm_b32 v85, v68, v64, v102
    v_perm_b32 v86, v69, v65, v101
    v_perm_b32 v88, v69, v65, v102
    v_perm_b32 v89, v70, v66, v101
    v_perm_b32 v90, v70, v66, v102
    ds_write_b128 v100, v[84:87] offset:0
    ds_write_b128 v100, v[88:91] offset:4112
    v_perm_b32 v92, v76, v72, v101
    v_perm_b32 v93, v76, v72, v102
    v_perm_b32 v94, v77, v73, v101
    v_perm_b32 v96, v77, v73, v102
    v_perm_b32 v97, v78, v74, v101
    v_perm_b32 v98, v78, v74, v102
    ds_write_b128 v100, v[92:95] offset:2048
    ds_write_b128 v100, v[96:99] offset:6160
    s_branch L_wdone_16
L_wmir_15:
    v_xor_b32 v68, 0x80008000, v68
    v_xor_b32 v69, 0x80008000, v69
    v_xor_b32 v70, 0x80008000, v70
    v_perm_b32 v84, v70, v66, v102
    v_perm_b32 v85, v70, v66, v101
    v_perm_b32 v86, v69, v65, v102
    v_perm_b32 v88, v69, v65, v101
    v_perm_b32 v89, v68, v64, v102
    v_perm_b32 v90, v68, v64, v101
    ds_write_b128 v100, v[84:87] offset:0
    ds_write_b128 v100, v[88:91] offset:4112
    v_xor_b32 v76, 0x80008000, v76
    v_xor_b32 v77, 0x80008000, v77
    v_xor_b32 v78, 0x80008000, v78
    v_perm_b32 v92, v78, v74, v102
    v_perm_b32 v93, v78, v74, v101
    v_perm_b32 v94, v77, v73, v102
    v_perm_b32 v96, v77, v73, v101
    v_perm_b32 v97, v76, v72, v102
    v_perm_b32 v98, v76, v72, v101
    ds_write_b128 v100, v[92:95] offset:2048
    ds_write_b128 v100, v[96:99] offset:6160
L_wdone_16:
    s_waitcnt lgkmcnt(0)
    s_barrier
    s_setprio 2
    buffer_load_dwordx4 v[104:107], v19, s[52:55], s92 offen sc0 sc1
    buffer_load_dwordx4 v[108:111], v19, s[52:55], s93 offen sc0 sc1
    buffer_load_dwordx4 v[112:115], v19, s[52:55], s94 offen sc0 sc1
    buffer_load_dwordx4 v[116:119], v19, s[52:55], s95 offen sc0 sc1
    v_lshlrev_b32 v6, 4, v1
    ds_read_b128 v[24:27], v6 offset:32768
    ds_read_b128 v[28:31], v6 offset:33792
    ds_read_b128 v[32:35], v6 offset:34816
    ds_read_b128 v[36:39], v6 offset:35840
    ds_read_b128 v[40:43], v6 offset:36864
    ds_read_b128 v[44:47], v6 offset:37888
    ds_read_b128 v[48:51], v6 offset:38912
    ds_read_b128 v[52:55], v6 offset:39936
    ds_read_b128 v[56:59], v6 offset:40960
    ds_read_b128 v[60:63], v6 offset:41984
    s_mov_b32 s79, 0
    s_waitcnt lgkmcnt(0)
L_poll_17:
    s_waitcnt vmcnt(0)
    v_cmp_ne_u32 vcc, s60, v107
    v_cmp_ne_u32 s[82:83], s60, v111
    s_nop 0
    s_or_b64 vcc, vcc, s[82:83]
    v_cmp_ne_u32 s[82:83], s60, v115
    s_nop 0
    s_or_b64 vcc, vcc, s[82:83]
    v_cmp_ne_u32 s[82:83], s60, v119
    s_nop 0
    s_or_b64 vcc, vcc, s[82:83]
    s_and_b64 exec, exec, vcc
    s_cbranch_execz L_polld_18
    s_add_u32 s79, s79, 1
    s_cmp_gt_u32 s79, 200000
    s_cbranch_scc1 L_polld_18
    s_sleep 4
    buffer_load_dwordx4 v[104:107], v19, s[52:55], s92 offen sc0 sc1
    buffer_load_dwordx4 v[108:111], v19, s[52:55], s93 offen sc0 sc1
    buffer_load_dwordx4 v[112:115], v19, s[52:55], s94 offen sc0 sc1
    buffer_load_dwordx4 v[116:119], v19, s[52:55], s95 offen sc0 sc1
    s_branch L_poll_17
L_polld_18:
    s_mov_b64 exec, -1
    ds_write_b128 v18, v[104:107] offset:0
    ds_write_b128 v18, v[108:111] offset:8192
    ds_write_b128 v18, v[112:115] offset:16384
    ds_write_b128 v18, v[116:119] offset:24576
    s_waitcnt lgkmcnt(0)
    s_barrier
    ds_read_b128 v[64:67], v16 offset:0
    ds_read_b128 v[68:71], v16 offset:2048
    ds_read_b128 v[72:75], v16 offset:4096
    ds_read_b128 v[76:79], v16 offset:6144
    ds_read_b128 v[88:91], v17 offset:0
    ds_read_b128 v[92:95], v17 offset:256
    ds_read_b128 v[96:99], v17 offset:512
    ds_read_b128 v[100:103], v17 offset:768
    s_xor_b32 s60, s60, 0x80000000
    s_waitcnt lgkmcnt(7)
    v_mov_b32 v104, v64
    v_mov_b32 v108, v65
    v_mov_b32 v112, v66
    s_waitcnt lgkmcnt(6)
    v_mov_b32 v105, v68
    v_mov_b32 v109, v69
    v_mov_b32 v113, v70
    s_waitcnt lgkmcnt(5)
    v_mov_b32 v106, v72
    v_mov_b32 v110, v73
    v_mov_b32 v114, v74
    s_waitcnt lgkmcnt(4)
    v_mov_b32 v107, v76
    v_mov_b32 v111, v77
    v_mov_b32 v115, v78
    v_mfma_f32_16x16x32_bf16 v[64:67], v[104:107], v[24:27], 0
    v_mfma_f32_16x16x32_bf16 v[68:71], v[104:107], v[28:31], 0
    v_mfma_f32_16x16x32_bf16 v[72:75], v[108:111], v[24:27], 0
    v_mfma_f32_16x16x32_bf16 v[76:79], v[108:111], v[28:31], 0
    v_mfma_f32_16x16x32_bf16 v[80:83], v[112:115], v[24:27], 0
    v_mfma_f32_16x16x32_bf16 v[84:87], v[112:115], v[28:31], 0
    s_nop 2
    v_mul_f32 v116, v64, v32
    v_mul_f32 v117, v68, v32
    v_fmac_f32 v116, v68, v33
    v_fma_f32 v117, -v64, v33, v117
    v_mul_f32 v118, v65, v34
    v_mul_f32 v119, v69, v34
    v_fmac_f32 v118, v69, v35
    v_fma_f32 v119, -v65, v35, v119
    v_mul_f32 v120, v66, v36
    v_mul_f32 v121, v70, v36
    v_fmac_f32 v120, v70, v37
    v_fma_f32 v121, -v66, v37, v121
    v_mul_f32 v122, v67, v38
    v_mul_f32 v123, v71, v38
    v_fmac_f32 v122, v71, v39
    v_fma_f32 v123, -v67, v39, v123
    v_cvt_pk_bf16_f32 v104, v116, v117
    v_cvt_pk_bf16_f32 v105, v118, v119
    v_cvt_pk_bf16_f32 v106, v120, v121
    v_cvt_pk_bf16_f32 v107, v122, v123
    s_nop 1
    v_mfma_f32_16x16x32_bf16 v[64:67], v[40:43], v[104:107], 0
    v_mfma_f32_16x16x32_bf16 v[68:71], v[44:47], v[104:107], 0
    v_mul_f32 v116, v72, v32
    v_mul_f32 v117, v76, v32
    v_fmac_f32 v116, v76, v33
    v_fma_f32 v117, -v72, v33, v117
    v_mul_f32 v118, v73, v34
    v_mul_f32 v119, v77, v34
    v_fmac_f32 v118, v77, v35
    v_fma_f32 v119, -v73, v35, v119
    v_mul_f32 v120, v74, v36
    v_mul_f32 v121, v78, v36
    v_fmac_f32 v120, v78, v37
    v_fma_f32 v121, -v74, v37, v121
    v_mul_f32 v122, v75, v38
    v_mul_f32 v123, v79, v38
    v_fmac_f32 v122, v79, v39
    v_fma_f32 v123, -v75, v39, v123
    v_cvt_pk_bf16_f32 v108, v116, v117
    v_cvt_pk_bf16_f32 v109, v118, v119
    v_cvt_pk_bf16_f32 v110, v120, v121
    v_cvt_pk_bf16_f32 v111, v122, v123
    s_nop 1
    v_mfma_f32_16x16x32_bf16 v[72:75], v[40:43], v[108:111], 0
    v_mfma_f32_16x16x32_bf16 v[76:79], v[44:47], v[108:111], 0
    v_mul_f32 v116, v80, v32
    v_mul_f32 v117, v84, v32
    v_fmac_f32 v116, v84, v33
    v_fma_f32 v117, -v80, v33, v117
    v_mul_f32 v118, v81, v34
    v_mul_f32 v119, v85, v34
    v_fmac_f32 v118, v85, v35
    v_fma_f32 v119, -v81, v35, v119
    v_mul_f32 v120, v82, v36
    v_mul_f32 v121, v86, v36
    v_fmac_f32 v120, v86, v37
    v_fma_f32 v121, -v82, v37, v121
    v_mul_f32 v122, v83, v38
    v_mul_f32 v123, v87, v38
    v_fmac_f32 v122, v87, v39
    v_fma_f32 v123, -v83, v39, v123
    v_cvt_pk_bf16_f32 v112, v116, v117
    v_cvt_pk_bf16_f32 v113, v118, v119
    v_cvt_pk_bf16_f32 v114, v120, v121
    v_cvt_pk_bf16_f32 v115, v122, v123
    s_nop 1
    v_mfma_f32_16x16x32_bf16 v[80:83], v[40:43], v[112:115], 0
    v_mfma_f32_16x16x32_bf16 v[84:87], v[44:47], v[112:115], 0
    s_waitcnt lgkmcnt(3)
    v_lshlrev_b32 v124, 16, v88
    v_and_b32 v88, 0xffff0000, v88
    s_waitcnt lgkmcnt(2)
    v_lshlrev_b32 v125, 16, v92
    v_and_b32 v92, 0xffff0000, v92
    s_waitcnt lgkmcnt(1)
    v_lshlrev_b32 v126, 16, v96
    v_and_b32 v96, 0xffff0000, v96
    s_waitcnt lgkmcnt(0)
    v_lshlrev_b32 v127, 16, v100
    v_and_b32 v100, 0xffff0000, v100
    v_mul_f32 v116, v64, v124
    v_mul_f32 v117, v68, v124
    v_fma_f32 v116, -v68, v88, v116
    v_fmac_f32 v117, v64, v88
    v_mul_f32 v118, v65, v125
    v_mul_f32 v119, v69, v125
    v_fma_f32 v118, -v69, v92, v118
    v_fmac_f32 v119, v65, v92
    v_mul_f32 v120, v66, v126
    v_mul_f32 v121, v70, v126
    v_fma_f32 v120, -v70, v96, v120
    v_fmac_f32 v121, v66, v96
    v_mul_f32 v122, v67, v127
    v_mul_f32 v123, v71, v127
    v_fma_f32 v122, -v71, v100, v122
    v_fmac_f32 v123, v67, v100
    v_cvt_pk_bf16_f32 v104, v117, v116
    v_cvt_pk_bf16_f32 v105, v119, v118
    v_cvt_pk_bf16_f32 v106, v121, v120
    v_cvt_pk_bf16_f32 v107, v123, v122
    s_nop 1
    v_mfma_f32_16x16x32_bf16 v[64:67], v[104:107], v[44:47], 0
    v_mfma_f32_16x16x32_bf16 v[68:71], v[104:107], v[40:43], 0
    v_lshlrev_b32 v124, 16, v89
    v_and_b32 v89, 0xffff0000, v89
    v_lshlrev_b32 v125, 16, v93
    v_and_b32 v93, 0xffff0000, v93
    v_lshlrev_b32 v126, 16, v97
    v_and_b32 v97, 0xffff0000, v97
    v_lshlrev_b32 v127, 16, v101
    v_and_b32 v101, 0xffff0000, v101
    v_mul_f32 v116, v72, v124
    v_mul_f32 v117, v76, v124
    v_fma_f32 v116, -v76, v89, v116
    v_fmac_f32 v117, v72, v89
    v_mul_f32 v118, v73, v125
    v_mul_f32 v119, v77, v125
    v_fma_f32 v118, -v77, v93, v118
    v_fmac_f32 v119, v73, v93
    v_mul_f32 v120, v74, v126
    v_mul_f32 v121, v78, v126
    v_fma_f32 v120, -v78, v97, v120
    v_fmac_f32 v121, v74, v97
    v_mul_f32 v122, v75, v127
    v_mul_f32 v123, v79, v127
    v_fma_f32 v122, -v79, v101, v122
    v_fmac_f32 v123, v75, v101
    v_cvt_pk_bf16_f32 v108, v117, v116
    v_cvt_pk_bf16_f32 v109, v119, v118
    v_cvt_pk_bf16_f32 v110, v121, v120
    v_cvt_pk_bf16_f32 v111, v123, v122
    s_nop 1
    v_mfma_f32_16x16x32_bf16 v[72:75], v[108:111], v[44:47], 0
    v_mfma_f32_16x16x32_bf16 v[76:79], v[108:111], v[40:43], 0
    v_lshlrev_b32 v124, 16, v90
    v_and_b32 v90, 0xffff0000, v90
    v_lshlrev_b32 v125, 16, v94
    v_and_b32 v94, 0xffff0000, v94
    v_lshlrev_b32 v126, 16, v98
    v_and_b32 v98, 0xffff0000, v98
    v_lshlrev_b32 v127, 16, v102
    v_and_b32 v102, 0xffff0000, v102
    v_mul_f32 v116, v80, v124
    v_mul_f32 v117, v84, v124
    v_fma_f32 v116, -v84, v90, v116
    v_fmac_f32 v117, v80, v90
    v_mul_f32 v118, v81, v125
    v_mul_f32 v119, v85, v125
    v_fma_f32 v118, -v85, v94, v118
    v_fmac_f32 v119, v81, v94
    v_mul_f32 v120, v82, v126
    v_mul_f32 v121, v86, v126
    v_fma_f32 v120, -v86, v98, v120
    v_fmac_f32 v121, v82, v98
    v_mul_f32 v122, v83, v127
    v_mul_f32 v123, v87, v127
    v_fma_f32 v122, -v87, v102, v122
    v_fmac_f32 v123, v83, v102
    v_cvt_pk_bf16_f32 v112, v117, v116
    v_cvt_pk_bf16_f32 v113, v119, v118
    v_cvt_pk_bf16_f32 v114, v121, v120
    v_cvt_pk_bf16_f32 v115, v123, v122
    s_nop 1
    v_mfma_f32_16x16x32_bf16 v[80:83], v[112:115], v[44:47], 0
    v_mfma_f32_16x16x32_bf16 v[84:87], v[112:115], v[40:43], 0
    v_mul_f32 v116, v64, v48
    v_mul_f32 v117, v68, v48
    v_fma_f32 v116, -v68, v49, v116
    v_fmac_f32 v117, v64, v49
    v_mul_f32 v118, v65, v50
    v_mul_f32 v119, v69, v50
    v_fma_f32 v118, -v69, v51, v118
    v_fmac_f32 v119, v65, v51
    v_mul_f32 v120, v66, v52
    v_mul_f32 v121, v70, v52
    v_fma_f32 v120, -v70, v53, v120
    v_fmac_f32 v121, v66, v53
    v_mul_f32 v122, v67, v54
    v_mul_f32 v123, v71, v54
    v_fma_f32 v122, -v71, v55, v122
    v_fmac_f32 v123, v67, v55
    v_cvt_pk_bf16_f32 v104, v116, v117
    v_cvt_pk_bf16_f32 v105, v118, v119
    v_cvt_pk_bf16_f32 v106, v120, v121
    v_cvt_pk_bf16_f32 v107, v122, v123
    s_nop 1
    v_mfma_f32_16x16x32_bf16 v[64:67], v[56:59], v[104:107], 0
    v_mfma_f32_16x16x32_bf16 v[68:71], v[60:63], v[104:107], 0
    v_mul_f32 v116, v72, v48
    v_mul_f32 v117, v76, v48
    v_fma_f32 v116, -v76, v49, v116
    v_fmac_f32 v117, v72, v49
    v_mul_f32 v118, v73, v50
    v_mul_f32 v119, v77, v50
    v_fma_f32 v118, -v77, v51, v118
    v_fmac_f32 v119, v73, v51
    v_mul_f32 v120, v74, v52
    v_mul_f32 v121, v78, v52
    v_fma_f32 v120, -v78, v53, v120
    v_fmac_f32 v121, v74, v53
    v_mul_f32 v122, v75, v54
    v_mul_f32 v123, v79, v54
    v_fma_f32 v122, -v79, v55, v122
    v_fmac_f32 v123, v75, v55
    v_cvt_pk_bf16_f32 v108, v116, v117
    v_cvt_pk_bf16_f32 v109, v118, v119
    v_cvt_pk_bf16_f32 v110, v120, v121
    v_cvt_pk_bf16_f32 v111, v122, v123
    s_nop 1
    v_mfma_f32_16x16x32_bf16 v[72:75], v[56:59], v[108:111], 0
    v_mfma_f32_16x16x32_bf16 v[76:79], v[60:63], v[108:111], 0
    v_mul_f32 v116, v80, v48
    v_mul_f32 v117, v84, v48
    v_fma_f32 v116, -v84, v49, v116
    v_fmac_f32 v117, v80, v49
    v_mul_f32 v118, v81, v50
    v_mul_f32 v119, v85, v50
    v_fma_f32 v118, -v85, v51, v118
    v_fmac_f32 v119, v81, v51
    v_mul_f32 v120, v82, v52
    v_mul_f32 v121, v86, v52
    v_fma_f32 v120, -v86, v53, v120
    v_fmac_f32 v121, v82, v53
    v_mul_f32 v122, v83, v54
    v_mul_f32 v123, v87, v54
    v_fma_f32 v122, -v87, v55, v122
    v_fmac_f32 v123, v83, v55
    v_cvt_pk_bf16_f32 v112, v116, v117
    v_cvt_pk_bf16_f32 v113, v118, v119
    v_cvt_pk_bf16_f32 v114, v120, v121
    v_cvt_pk_bf16_f32 v115, v122, v123
    s_nop 1
    v_mfma_f32_16x16x32_bf16 v[80:83], v[56:59], v[112:115], 0
    v_mfma_f32_16x16x32_bf16 v[84:87], v[60:63], v[112:115], 0
    v_mov_b32 v91, s60
    v_mov_b32 v95, s60
    v_mov_b32 v99, s60
    v_mov_b32 v103, s60
    v_cvt_pk_bf16_f32 v88, v64, v68
    v_cvt_pk_bf16_f32 v92, v65, v69
    v_cvt_pk_bf16_f32 v96, v66, v70
    v_cvt_pk_bf16_f32 v100, v67, v71
    v_cvt_pk_bf16_f32 v89, v72, v76
    v_cvt_pk_bf16_f32 v93, v73, v77
    v_cvt_pk_bf16_f32 v97, v74, v78
    v_cvt_pk_bf16_f32 v101, v75, v79
    v_cvt_pk_bf16_f32 v90, v80, v84
    v_cvt_pk_bf16_f32 v94, v81, v85
    v_cvt_pk_bf16_f32 v98, v82, v86
    v_cvt_pk_bf16_f32 v102, v83, v87
    ds_write_b128 v16, v[88:91] offset:0
    ds_write_b128 v16, v[92:95] offset:2048
    ds_write_b128 v16, v[96:99] offset:4096
    ds_write_b128 v16, v[100:103] offset:6144
    s_waitcnt lgkmcnt(0)
    s_barrier
    ds_read_b128 v[64:67], v18 offset:0
    ds_read_b128 v[68:71], v18 offset:8192
    ds_read_b128 v[72:75], v18 offset:16384
    ds_read_b128 v[76:79], v18 offset:24576
    s_waitcnt lgkmcnt(3)
    buffer_store_dwordx4 v[64:67], v19, s[52:55], s92 offen sc0 sc1
    s_waitcnt lgkmcnt(2)
    buffer_store_dwordx4 v[68:71], v19, s[52:55], s93 offen sc0 sc1
    s_waitcnt lgkmcnt(1)
    buffer_store_dwordx4 v[72:75], v19, s[52:55], s94 offen sc0 sc1
    s_waitcnt lgkmcnt(0)
    buffer_store_dwordx4 v[76:79], v19, s[52:55], s95 offen sc0 sc1
    s_cmp_lg_u32 s61, 0
    s_cbranch_scc1 L_nofl_19
    s_lshl_b32 s75, s3, 7
    s_add_u32 s75, s75, 131072
    v_mov_b32 v7, 0
    v_mov_b32 v8, s60
    s_waitcnt vmcnt(2)
    s_mov_b64 exec, 1
    buffer_store_dword v8, v7, s[52:55], s75 offen sc0 sc1
    s_mov_b64 exec, -1
L_nofl_19:
    s_branch L_aj_20
L_nounit_8:
    s_waitcnt vmcnt(3)
    s_cmp_eq_u32 s61, 5
    s_cbranch_scc1 L_w5_21
    s_waitcnt vmcnt(1)
L_w5_21:
    ds_write_b128 v17, v[120:123]
    ds_write_b32 v18, v124 offset:1024
    v_lshlrev_b32 v4, 4, v1
    v_add_u32 v5, s74, v4
    s_waitcnt lgkmcnt(0)
    s_barrier
    s_add_u32 s60, s60, 1
    ds_read_b64_tr_b16 v[64:65], v16 offset:0
    ds_read_b64_tr_b16 v[66:67], v16 offset:5248
    ds_read_b64_tr_b16 v[68:69], v16 offset:256
    ds_read_b64_tr_b16 v[70:71], v16 offset:5504
    ds_read_b64_tr_b16 v[72:73], v16 offset:512
    ds_read_b64_tr_b16 v[74:75], v16 offset:5760
    ds_read_b64_tr_b16 v[76:77], v16 offset:768
    ds_read_b64_tr_b16 v[78:79], v16 offset:6016
    ds_read_b64_tr_b16 v[80:81], v16 offset:1024
    ds_read_b64_tr_b16 v[82:83], v16 offset:6272
    ds_read_b64_tr_b16 v[84:85], v16 offset:32
    ds_read_b64_tr_b16 v[86:87], v16 offset:5280
    ds_read_b64_tr_b16 v[88:89], v16 offset:288
    ds_read_b64_tr_b16 v[90:91], v16 offset:5536
    ds_read_b64_tr_b16 v[92:93], v16 offset:544
    ds_read_b64_tr_b16 v[94:95], v16 offset:5792
    ds_read_b64_tr_b16 v[96:97], v16 offset:800
    ds_read_b64_tr_b16 v[98:99], v16 offset:6048
    ds_read_b64_tr_b16 v[100:101], v16 offset:1056
    ds_read_b64_tr_b16 v[102:103], v16 offset:6304
    ds_read_b128 v[104:107], v5 offset:18688
    ds_read_b128 v[108:111], v5 offset:19712
    ds_read_b128 v[112:115], v5 offset:20736
    ds_read_b128 v[116:119], v5 offset:21760
    s_waitcnt lgkmcnt(15)
    v_mfma_f32_16x16x32_bf16 v[120:123], v[64:67], v[24:27], 0
    v_mfma_f32_16x16x32_bf16 v[124:127], v[64:67], v[28:31], 0
    v_mfma_f32_16x16x32_bf16 v[120:123], v[68:71], v[32:35], v[120:123]
    v_mfma_f32_16x16x32_bf16 v[124:127], v[68:71], v[36:39], v[124:127]
    v_mfma_f32_16x16x32_bf16 v[120:123], v[72:75], v[40:43], v[120:123]
    v_mfma_f32_16x16x32_bf16 v[124:127], v[72:75], v[44:47], v[124:127]
    v_mfma_f32_16x16x32_bf16 v[120:123], v[76:79], v[48:51], v[120:123]
    v_mfma_f32_16x16x32_bf16 v[124:127], v[76:79], v[52:55], v[124:127]
    s_waitcnt lgkmcnt(14)
    v_mfma_f32_16x16x32_bf16 v[120:123], v[80:83], v[56:59], v[120:123]
    v_mfma_f32_16x16x32_bf16 v[124:127], v[80:83], v[60:63], v[124:127]
    s_waitcnt lgkmcnt(12)
    v_mfma_f32_16x16x32_bf16 v[64:67], v[84:87], v[24:27], 0
    v_mfma_f32_16x16x32_bf16 v[68:71], v[84:87], v[28:31], 0
    s_waitcnt lgkmcnt(10)
    v_mfma_f32_16x16x32_bf16 v[64:67], v[88:91], v[32:35], v[64:67]
    v_mfma_f32_16x16x32_bf16 v[68:71], v[88:91], v[36:39], v[68:71]
    s_waitcnt lgkmcnt(8)
    v_mfma_f32_16x16x32_bf16 v[64:67], v[92:95], v[40:43], v[64:67]
    s_waitcnt lgkmcnt(3)
    v_mul_f32 v72, v120, v104
    v_mul_f32 v73, v124, v104
    v_fmac_f32 v72, v124, v105
    v_mfma_f32_16x16x32_bf16 v[68:71], v[92:95], v[44:47], v[68:71]
    v_fma_f32 v73, -v120, v105, v73
    v_mul_f32 v74, v121, v106
    v_mul_f32 v75, v125, v106
    v_mfma_f32_16x16x32_bf16 v[64:67], v[96:99], v[48:51], v[64:67]
    v_fmac_f32 v74, v125, v107
    v_fma_f32 v75, -v121, v107, v75
    s_waitcnt lgkmcnt(2)
    v_mul_f32 v76, v122, v108
    v_mul_f32 v77, v126, v108
    v_mfma_f32_16x16x32_bf16 v[68:71], v[96:99], v[52:55], v[68:71]
    v_fmac_f32 v76, v126, v109
    v_fma_f32 v77, -v122, v109, v77
    v_mul_f32 v78, v123, v110
    v_mfma_f32_16x16x32_bf16 v[64:67], v[100:103], v[56:59], v[64:67]
    v_mul_f32 v79, v127, v110
    v_fmac_f32 v78, v127, v111
    v_fma_f32 v79, -v123, v111, v79
    v_mfma_f32_16x16x32_bf16 v[68:71], v[100:103], v[60:63], v[68:71]
    v_cvt_pk_bf16_f32 v80, v72, v73
    v_cvt_pk_bf16_f32 v81, v74, v75
    v_cvt_pk_bf16_f32 v82, v76, v77
    v_cvt_pk_bf16_f32 v83, v78, v79
    ds_read_b128 v[24:27], v4 offset:10496
    ds_read_b128 v[28:31], v4 offset:11520
    ds_read_b128 v[32:35], v4 offset:12544
    ds_read_b128 v[36:39], v4 offset:13568
    ds_read_b128 v[40:43], v4 offset:14592
    ds_read_b128 v[44:47], v4 offset:15616
    ds_read_b128 v[48:51], v4 offset:16640
    ds_read_b128 v[52:55], v4 offset:17664
    s_waitcnt lgkmcnt(9)
    v_mul_f32 v72, v64, v112
    v_mul_f32 v73, v68, v112
    v_fmac_f32 v72, v68, v113
    v_fma_f32 v73, -v64, v113, v73
    v_mul_f32 v74, v65, v114
    v_mul_f32 v75, v69, v114
    v_fmac_f32 v74, v69, v115
    v_fma_f32 v75, -v65, v115, v75
    s_waitcnt lgkmcnt(8)
    v_mul_f32 v76, v66, v116
    v_mul_f32 v77, v70, v116
    v_fmac_f32 v76, v70, v117
    v_fma_f32 v77, -v66, v117, v77
    v_mul_f32 v78, v67, v118
    v_mul_f32 v79, v71, v118
    v_fmac_f32 v78, v71, v119
    v_fma_f32 v79, -v67, v119, v79
    v_cvt_pk_bf16_f32 v120, v72, v73
    v_cvt_pk_bf16_f32 v121, v74, v75
    v_cvt_pk_bf16_f32 v122, v76, v77
    v_cvt_pk_bf16_f32 v123, v78, v79
    s_waitcnt lgkmcnt(7)
    v_mfma_f32_16x16x32_bf16 v[84:87], v[80:83], v[24:27], 0
    s_waitcnt lgkmcnt(6)
    v_mfma_f32_16x16x32_bf16 v[88:91], v[80:83], v[28:31], 0
    s_waitcnt lgkmcnt(5)
    v_mfma_f32_16x16x32_bf16 v[92:95], v[80:83], v[32:35], 0
    s_waitcnt lgkmcnt(4)
    v_mfma_f32_16x16x32_bf16 v[96:99], v[80:83], v[36:39], 0
    s_waitcnt lgkmcnt(3)
    v_mfma_f32_16x16x32_bf16 v[84:87], v[120:123], v[40:43], v[84:87]
    s_waitcnt lgkmcnt(2)
    v_mfma_f32_16x16x32_bf16 v[88:91], v[120:123], v[44:47], v[88:91]
    s_waitcnt lgkmcnt(1)
    v_mfma_f32_16x16x32_bf16 v[92:95], v[120:123], v[48:51], v[92:95]
    s_waitcnt lgkmcnt(0)
    v_mfma_f32_16x16x32_bf16 v[96:99], v[120:123], v[52:55], v[96:99]
    v_lshlrev_b32 v7, 4, v0
    s_nop 2
    v_cvt_pk_bf16_f32 v100, v84, v88
    v_cvt_pk_bf16_f32 v101, v85, v89
    v_cvt_pk_bf16_f32 v102, v86, v90
    v_cvt_pk_bf16_f32 v103, v87, v91
    v_cvt_pk_bf16_f32 v124, v92, v96
    v_cvt_pk_bf16_f32 v125, v93, v97
    v_cvt_pk_bf16_f32 v126, v94, v98
    v_cvt_pk_bf16_f32 v127, v95, v99
    s_mov_b64 exec, s[80:81]
    ds_write_b128 v19, v[100:103]
    ds_write_b128 v20, v[124:127]
    s_mov_b64 exec, s[96:97]
    ds_write_b32 v19, v100 offset:2560
    s_mov_b64 exec, -1
    s_waitcnt vmcnt(0)
    s_waitcnt lgkmcnt(0)
    s_barrier
    ds_read2_b32 v[100:101], v12 offset0:0 offset1:1
    ds_read_b32 v102, v12 offset:8
    ds_read2_b32 v[124:125], v13 offset0:0 offset1:1
    ds_read_b32 v126, v13 offset:8
    v_mov_b32 v103, s60
    v_mov_b32 v127, s60
    s_waitcnt lgkmcnt(2)
    buffer_store_dwordx4 v[100:103], v7, s[52:55], s88 offen sc0 sc1
    s_mov_b64 exec, s[84:85]
    s_waitcnt lgkmcnt(0)
    buffer_store_dwordx4 v[124:127], v7, s[52:55], s89 offen sc0 sc1
    s_mov_b64 exec, -1
    s_cmp_lg_u32 s61, 0
    s_cbranch_scc1 L_nofl_22
    s_lshl_b32 s75, s3, 7
    s_add_u32 s75, s75, 65536
    v_mov_b32 v7, 0
    v_mov_b32 v8, s60
    s_waitcnt vmcnt(2)
    s_mov_b64 exec, 1
    buffer_store_dword v8, v7, s[52:55], s75 offen sc0 sc1
    s_mov_b64 exec, -1
L_nofl_22:
    s_xor_b32 s60, s60, 0x80000000
    s_barrier
    s_setprio 0
L_aj_20:
    v_lshlrev_b32 v80, 2, v3
    v_cvt_f32_u32 v80, v80
    s_and_b32 s75, s61, 1
    s_lshl_b32 s75, s75, 4
    v_add_u32 v82, s75, v2
    v_cvt_f32_u32 v82, v82
    v_mul_f32 v81, 0x3d000000, v82
    v_mul_f32 v88, v80, v81
    v_fmamk_f32 v89, v81, 0x3f800000, v88
    v_fmamk_f32 v90, v81, 0x40000000, v88
    v_fmamk_f32 v91, v81, 0x40400000, v88
    v_cos_f32 v96, v88
    v_sin_f32 v97, v88
    v_cos_f32 v98, v89
    v_sin_f32 v99, v89
    v_cos_f32 v100, v90
    v_sin_f32 v101, v90
    v_cos_f32 v102, v91
    v_sin_f32 v103, v91
    v_lshlrev_b32 v83, 31, v2
    v_lshrrev_b32 v81, 16, v83
    v_or_b32 v83, v83, v81
    v_cvt_pk_bf16_f32 v24, v96, -v97
    v_cvt_pk_bf16_f32 v28, v97, v96
    v_cvt_pk_bf16_f32 v25, v98, -v99
    v_cvt_pk_bf16_f32 v29, v99, v98
    v_cvt_pk_bf16_f32 v26, v100, -v101
    v_cvt_pk_bf16_f32 v30, v101, v100
    v_cvt_pk_bf16_f32 v27, v102, -v103
    v_cvt_pk_bf16_f32 v31, v103, v102
    v_xor_b32 v32, v83, v24
    v_xor_b32 v33, v83, v25
    v_xor_b32 v34, v83, v26
    v_xor_b32 v35, v83, v27
    v_xor_b32 v36, v83, v28
    v_xor_b32 v37, v83, v29
    v_xor_b32 v38, v83, v30
    v_xor_b32 v39, v83, v31
    s_lshr_b32 s75, s61, 1
    s_mul_i32 s75, s75, 5120
    s_and_b32 s76, s61, 1
    s_lshl_b32 s76, s76, 2
    v_add_u32 v6, s76, v3
    v_and_b32 v7, 7, v2
    v_xor_b32 v7, v7, v6
    v_lshlrev_b32 v7, 4, v7
    v_lshl_add_u32 v20, v2, 7, v7
    v_add_u32 v20, s75, v20
    v_and_b32 v7, 3, v2
    v_xor_b32 v6, v7, v6
    v_lshlrev_b32 v6, 4, v6
    v_lshl_add_u32 v21, v7, 7, v6
    v_and_b32 v7, 4, v2
    v_mul_u32_u24 v7, 640, v7
    v_add3_u32 v21, v21, v7, s75
    v_lshrrev_b32 v6, 4, v0
    v_bfe_u32 v7, v0, 1, 3
    v_and_b32 v8, 7, v6
    v_xor_b32 v7, v7, v8
    v_lshlrev_b32 v7, 4, v7
    v_lshl_add_u32 v22, v6, 7, v7
    v_and_b32 v7, 1, v0
    v_lshl_add_u32 v22, v7, 3, v22
    v_lshlrev_b32 v23, 2, v0
    s_mul_i32 s34, s3, 14848
    s_add_u32 s34, s34, 1048576
    v_lshlrev_b32 v12, 4, v0
    v_mov_b32 v13, v12
    s_cmp_eq_u32 s61, 6
    s_cselect_b32 exec_hi, 0, -1
    s_cmp_eq_u32 s61, 7
    s_cselect_b32 s76, 0, 8192
    v_add_u32 v13, s76, v13
    s_mov_b64 exec, -1
    s_mul_i32 s88, s3, 2560
    s_add_u32 s89, s88, 655360
    s_add_u32 s90, s89, 655360
    s_add_u32 s91, s90, 655360
    s_add_u32 s92, s91, 655360
    s_add_u32 s93, s92, 655360
    s_add_u32 s94, s93, 655360
    s_add_u32 s95, s94, 655360
    v_mul_f32 v81, 0x3acccccd, v82
    v_cvt_f32_u32 v112, v2
    v_mul_f32 v112, 0x3d4ccccd, v112
    v_and_b32 v113, 3, v2
    v_or_b32 v113, 16, v113
    v_cvt_f32_u32 v113, v113
    v_mul_f32 v113, 0x3d4ccccd, v113
    s_cmp_lt_u32 s61, 2
    s_cbranch_scc1 L_p3r_23
    s_mov_b32 exec_lo, 0x0
    s_mov_b32 exec_hi, 0xffff0000
    v_mov_b32 v80, 0
    s_mov_b64 exec, -1
    v_mul_f32 v88, v80, v81
    v_fmamk_f32 v89, v81, 0x3f800000, v88
    v_fmamk_f32 v90, v81, 0x40000000, v88
    v_fmamk_f32 v91, v81, 0x40400000, v88
    v_fmamk_f32 v92, v81, 0x41400000, v88
    v_fmamk_f32 v93, v81, 0x41500000, v88
    v_fmamk_f32 v94, v81, 0x41600000, v88
    v_fmamk_f32 v95, v81, 0x41700000, v88
    v_cos_f32 v96, v88
    v_sin_f32 v97, v88
    v_cos_f32 v98, v89
    v_sin_f32 v99, v89
    v_cos_f32 v100, v90
    v_sin_f32 v101, v90
    v_cos_f32 v102, v91
    v_sin_f32 v103, v91
    v_cos_f32 v104, v92
    v_sin_f32 v105, v92
    v_cos_f32 v106, v93
    v_sin_f32 v107, v93
    v_cos_f32 v108, v94
    v_sin_f32 v109, v94
    v_cos_f32 v110, v95
    v_sin_f32 v111, v95
    v_mov_b32 v84, 0
    v_mov_b32 v85, 0
    v_mov_b32 v86, 0x354ccccd
    s_mov_b32 exec_lo, 0xffffffff
    s_mov_b32 exec_hi, 0xffff
    v_mov_b32 v84, 0x35cccccd
    s_mov_b32 exec_lo, 0xffffffff
    s_mov_b32 exec_hi, 0x0
    v_mov_b32 v85, 0x35cccccd
    s_mov_b32 exec_lo, 0xffff0000
    s_mov_b32 exec_hi, 0xffff
    v_mov_b32 v86, 0x35cccccd
    s_mov_b64 exec, -1
    s_lshr_b32 s75, s61, 1
    s_mul_i32 s75, s75, 2576
    s_add_u32 s75, s75, 30192
    v_mul_u32_u24 v16, 320, v3
    v_add_u32 v16, s75, v16
    v_and_b32 v17, 7, v2
    v_lshl_add_u32 v17, v17, 2, v16
    v_lshl_add_u32 v16, v2, 2, v16
    s_mov_b32 exec_lo, 0x10001000
    s_mov_b32 exec_hi, 0x10001000
    v_subrev_u32 v16, 48, v16
    s_mov_b64 exec, -1
    v_mov_b32 v18, v16
    v_mov_b32 v19, v16
    s_mov_b32 exec_lo, 0x1000
    s_mov_b32 exec_hi, 0x0
    v_add_u32 v18, 2564, v16
    v_subrev_u32 v19, 4, v16
    s_mov_b64 exec, -1
    v_mul_f32 v40, v96, v86
    v_mul_f32 v41, v97, v86
    v_mul_f32 v42, v98, v84
    v_mul_f32 v43, v99, v84
    v_mul_f32 v44, v100, v84
    v_mul_f32 v45, v101, v84
    v_mul_f32 v46, v102, v84
    v_mul_f32 v47, v103, v84
    v_mul_f32 v48, v104, v85
    v_mul_f32 v49, v105, v85
    v_mul_f32 v50, v106, v85
    v_mul_f32 v51, v107, v85
    v_mul_f32 v52, v108, v85
    v_mul_f32 v53, v109, v85
    v_mul_f32 v54, v110, v85
    v_mul_f32 v55, v111, v85
    v_mul_f32 v88, v80, v112
    v_fmamk_f32 v89, v112, 0x3f800000, v88
    v_fmamk_f32 v90, v112, 0x40000000, v88
    v_fmamk_f32 v91, v112, 0x40400000, v88
    v_fmamk_f32 v92, v112, 0x41400000, v88
    v_fmamk_f32 v93, v112, 0x41500000, v88
    v_fmamk_f32 v94, v112, 0x41600000, v88
    v_fmamk_f32 v95, v112, 0x41700000, v88
    v_cos_f32 v96, v88
    v_sin_f32 v97, v88
    v_cos_f32 v98, v89
    v_sin_f32 v99, v89
    v_cos_f32 v100, v90
    v_sin_f32 v101, v90
    v_cos_f32 v102, v91
    v_sin_f32 v103, v91
    v_cos_f32 v104, v92
    v_sin_f32 v105, v92
    v_cos_f32 v106, v93
    v_sin_f32 v107, v93
    v_cos_f32 v108, v94
    v_sin_f32 v109, v94
    v_cos_f32 v110, v95
    v_sin_f32 v111, v95
    v_cvt_pk_bf16_f32 v56, v96, -v97
    v_cvt_pk_bf16_f32 v64, v97, v96
    v_cvt_pk_bf16_f32 v57, v98, -v99
    v_cvt_pk_bf16_f32 v65, v99, v98
    v_cvt_pk_bf16_f32 v58, v100, -v101
    v_cvt_pk_bf16_f32 v66, v101, v100
    v_cvt_pk_bf16_f32 v59, v102, -v103
    v_cvt_pk_bf16_f32 v67, v103, v102
    v_cvt_pk_bf16_f32 v60, v104, -v105
    v_cvt_pk_bf16_f32 v68, v105, v104
    v_cvt_pk_bf16_f32 v61, v106, -v107
    v_cvt_pk_bf16_f32 v69, v107, v106
    v_cvt_pk_bf16_f32 v62, v108, -v109
    v_cvt_pk_bf16_f32 v70, v109, v108
    v_cvt_pk_bf16_f32 v63, v110, -v111
    v_cvt_pk_bf16_f32 v71, v111, v110
    v_mul_f32 v88, v80, v113
    v_fmamk_f32 v89, v113, 0x3f800000, v88
    v_fmamk_f32 v90, v113, 0x40000000, v88
    v_fmamk_f32 v91, v113, 0x40400000, v88
    v_fmamk_f32 v92, v113, 0x41400000, v88
    v_fmamk_f32 v93, v113, 0x41500000, v88
    v_fmamk_f32 v94, v113, 0x41600000, v88
    v_fmamk_f32 v95, v113, 0x41700000, v88
    v_cos_f32 v96, v88
    v_sin_f32 v97, v88
    v_cos_f32 v98, v89
    v_sin_f32 v99, v89
    v_cos_f32 v100, v90
    v_sin_f32 v101, v90
    v_cos_f32 v102, v91
    v_sin_f32 v103, v91
    v_cos_f32 v104, v92
    v_sin_f32 v105, v92
    v_cos_f32 v106, v93
    v_sin_f32 v107, v93
    v_cos_f32 v108, v94
    v_sin_f32 v109, v94
    v_cos_f32 v110, v95
    v_sin_f32 v111, v95
    v_cvt_pk_bf16_f32 v72, v96, -v97
    v_cvt_pk_bf16_f32 v73, v98, -v99
    v_cvt_pk_bf16_f32 v74, v100, -v101
    v_cvt_pk_bf16_f32 v75, v102, -v103
    v_cvt_pk_bf16_f32 v76, v104, -v105
    v_cvt_pk_bf16_f32 v77, v106, -v107
    v_cvt_pk_bf16_f32 v78, v108, -v109
    v_cvt_pk_bf16_f32 v79, v110, -v111
    s_mov_b32 exec_lo, 0xf0f0f0f0
    s_mov_b32 exec_hi, 0xf0f0f0f0
    v_cvt_pk_bf16_f32 v72, v97, v96
    v_cvt_pk_bf16_f32 v73, v99, v98
    v_cvt_pk_bf16_f32 v74, v101, v100
    v_cvt_pk_bf16_f32 v75, v103, v102
    v_cvt_pk_bf16_f32 v76, v105, v104
    v_cvt_pk_bf16_f32 v77, v107, v106
    v_cvt_pk_bf16_f32 v78, v109, v108
    v_cvt_pk_bf16_f32 v79, v111, v110
    s_mov_b64 exec, -1
    s_branch L_p3d_24
L_p3r_23:
    v_mul_f32 v88, v80, v81
    v_fmamk_f32 v89, v81, 0x3f800000, v88
    v_fmamk_f32 v90, v81, 0x40000000, v88
    v_fmamk_f32 v91, v81, 0x40400000, v88
    v_cos_f32 v96, v88
    v_sin_f32 v97, v88
    v_cos_f32 v98, v89
    v_sin_f32 v99, v89
    v_cos_f32 v100, v90
    v_sin_f32 v101, v90
    v_cos_f32 v102, v91
    v_sin_f32 v103, v91
    v_mov_b32 v84, 0
    v_mov_b32 v85, 0
    v_mov_b32 v86, 0
    v_mov_b32 v87, 0
    s_mov_b32 exec_lo, 0xffffffff
    s_mov_b32 exec_hi, 0xffff
    v_mov_b32 v84, 0x35cccccd
    v_mov_b32 v85, 0x35cccccd
    v_mov_b32 v86, 0x354ccccd
    s_mov_b32 exec_lo, 0xffffffff
    s_mov_b32 exec_hi, 0x0
    v_mov_b32 v86, 0x35cccccd
    v_mov_b32 v87, 0x35cccccd
    s_mov_b32 exec_lo, 0xffff
    s_mov_b32 exec_hi, 0x0
    v_mov_b32 v84, 0x354ccccd
    s_mov_b64 exec, -1
    v_mul_u32_u24 v16, 192, v3
    v_min_u32 v17, 11, v2
    v_lshl_add_u32 v16, v17, 2, v16
    v_add_u32 v16, 40496, v16
    v_mul_f32 v40, v96, v84
    v_mul_f32 v41, v97, v84
    v_mul_f32 v42, v98, v85
    v_mul_f32 v43, v99, v85
    v_mul_f32 v44, v100, v86
    v_mul_f32 v45, v101, v86
    v_mul_f32 v46, v102, v87
    v_mul_f32 v47, v103, v87
    v_mov_b32 v48, v40
    v_mov_b32 v49, v41
    v_mov_b32 v50, v42
    v_mov_b32 v51, v43
    v_mov_b32 v52, v44
    v_mov_b32 v53, v45
    v_mov_b32 v54, v46
    v_mov_b32 v55, v47
    v_mul_f32 v88, v80, v112
    v_fmamk_f32 v89, v112, 0x3f800000, v88
    v_fmamk_f32 v90, v112, 0x40000000, v88
    v_fmamk_f32 v91, v112, 0x40400000, v88
    v_cos_f32 v96, v88
    v_sin_f32 v97, v88
    v_cos_f32 v98, v89
    v_sin_f32 v99, v89
    v_cos_f32 v100, v90
    v_sin_f32 v101, v90
    v_cos_f32 v102, v91
    v_sin_f32 v103, v91
    v_cvt_pk_bf16_f32 v56, v96, -v97
    v_cvt_pk_bf16_f32 v57, v98, -v99
    v_cvt_pk_bf16_f32 v58, v100, -v101
    v_cvt_pk_bf16_f32 v59, v102, -v103
    v_mul_f32 v88, v80, v113
    v_fmamk_f32 v89, v113, 0x3f800000, v88
    v_fmamk_f32 v90, v113, 0x40000000, v88
    v_fmamk_f32 v91, v113, 0x40400000, v88
    v_cos_f32 v96, v88
    v_sin_f32 v97, v88
    v_cos_f32 v98, v89
    v_sin_f32 v99, v89
    v_cos_f32 v100, v90
    v_sin_f32 v101, v90
    v_cos_f32 v102, v91
    v_sin_f32 v103, v91
    v_mov_b32 v68, v56
    v_mov_b32 v60, 0
    v_mov_b32 v64, 0
    v_mov_b32 v72, 0
    v_mov_b32 v76, 0
    v_mov_b32 v69, v57
    v_mov_b32 v61, 0
    v_mov_b32 v65, 0
    v_mov_b32 v73, 0
    v_mov_b32 v77, 0
    v_mov_b32 v70, v58
    v_mov_b32 v62, 0
    v_mov_b32 v66, 0
    v_mov_b32 v74, 0
    v_mov_b32 v78, 0
    v_mov_b32 v71, v59
    v_mov_b32 v63, 0
    v_mov_b32 v67, 0
    v_mov_b32 v75, 0
    v_mov_b32 v79, 0
    s_mov_b32 exec_lo, 0xf0f0f0f
    s_mov_b32 exec_hi, 0xf0f0f0f
    v_cvt_pk_bf16_f32 v72, v96, -v97
    v_cvt_pk_bf16_f32 v73, v98, -v99
    v_cvt_pk_bf16_f32 v74, v100, -v101
    v_cvt_pk_bf16_f32 v75, v102, -v103
    s_mov_b32 exec_lo, 0xf0f0f0f0
    s_mov_b32 exec_hi, 0xf0f0f0f0
    v_cvt_pk_bf16_f32 v76, v96, -v97
    v_cvt_pk_bf16_f32 v77, v98, -v99
    v_cvt_pk_bf16_f32 v78, v100, -v101
    v_cvt_pk_bf16_f32 v79, v102, -v103
    s_mov_b64 exec, -1
L_p3d_24:
    s_setprio 2
    s_mul_i32 s75, s3, 5
    s_mul_i32 s76, s61, 14
    s_add_u32 s75, s75, s76
    v_mul_u32_u24 v4, 4, v1
    v_add_u32 v4, s75, v4
    v_mul_u32_u24 v5, 4520, v4
    v_lshrrev_b32 v5, 19, v5
    v_mul_u32_u24 v5, 116, v5
    v_sub_u32 v4, v4, v5
    v_lshlrev_b32 v4, 7, v4
    s_mov_b32 s79, 0
    s_mov_b32 s75, 131072
    s_mov_b64 exec, 15
L_prb_25:
    buffer_load_dword v9, v4, s[52:55], s75 offen sc0 sc1
    s_waitcnt vmcnt(0)
    v_cmp_ne_u32 vcc, s60, v9
    s_nop 0
    s_and_b64 exec, exec, vcc
    s_cbranch_execz L_prbd_26
    s_add_u32 s79, s79, 1
    s_cmp_gt_u32 s79, 200000
    s_cbranch_scc1 L_prbd_26
    s_sleep 3
    s_branch L_prb_25
L_prbd_26:
    s_mov_b64 exec, -1
    buffer_load_dwordx4 v[80:83], v12, s[52:55], s34 offen sc0 sc1
    buffer_load_dwordx4 v[84:87], v13, s[52:55], s34 offen sc0 sc1
    s_mov_b32 s79, 0
L_poll_27:
    s_waitcnt vmcnt(0)
    v_cmp_ne_u32 vcc, s60, v83
    v_cmp_ne_u32 s[82:83], s60, v87
    s_nop 0
    s_or_b64 vcc, vcc, s[82:83]
    s_and_b64 exec, exec, vcc
    s_cbranch_execz L_polld_28
    s_add_u32 s79, s79, 1
    s_cmp_gt_u32 s79, 200000
    s_cbranch_scc1 L_polld_28
    s_sleep 4
    buffer_load_dwordx4 v[80:83], v12, s[52:55], s34 offen sc0 sc1
    buffer_load_dwordx4 v[84:87], v13, s[52:55], s34 offen sc0 sc1
    s_branch L_poll_27
L_polld_28:
    s_mov_b64 exec, -1
    ds_write2_b32 v14, v80, v81 offset0:0 offset1:1
    ds_write_b32 v14, v82 offset:8
    ds_write2_b32 v15, v84, v85 offset0:0 offset1:1
    ds_write_b32 v15, v86 offset:8
    s_waitcnt lgkmcnt(0)
    s_barrier
    s_cmp_lt_u32 s61, 2
    s_cbranch_scc1 L_p3gr_29
    ds_read_b32 v88, v18 offset:0
    ds_read_b32 v89, v16 offset:80
    ds_read_b32 v90, v16 offset:160
    ds_read_b32 v91, v16 offset:240
    ds_read_b32 v92, v19 offset:1284
    ds_read_b32 v93, v16 offset:1364
    ds_read_b32 v94, v16 offset:1444
    ds_read_b32 v95, v16 offset:1524
    ds_read_b32 v96, v17 offset:48
    ds_read_b32 v97, v17 offset:128
    ds_read_b32 v98, v17 offset:208
    ds_read_b32 v99, v17 offset:288
    ds_read_b32 v100, v17 offset:1332
    ds_read_b32 v101, v17 offset:1412
    ds_read_b32 v102, v17 offset:1492
    ds_read_b32 v103, v17 offset:1572
    s_waitcnt lgkmcnt(12)
    v_mfma_f32_16x16x32_bf16 v[104:107], v[88:91], v[24:27], 0
    v_mfma_f32_16x16x32_bf16 v[108:111], v[88:91], v[28:31], 0
    s_waitcnt lgkmcnt(8)
    v_mfma_f32_16x16x32_bf16 v[104:107], v[92:95], v[32:35], v[104:107]
    v_mfma_f32_16x16x32_bf16 v[108:111], v[92:95], v[36:39], v[108:111]
    s_waitcnt lgkmcnt(4)
    v_mfma_f32_16x16x32_bf16 v[112:115], v[96:99], v[24:27], 0
    v_mfma_f32_16x16x32_bf16 v[116:119], v[96:99], v[28:31], 0
    s_waitcnt lgkmcnt(0)
    v_mfma_f32_16x16x32_bf16 v[112:115], v[100:103], v[32:35], v[112:115]
    v_mfma_f32_16x16x32_bf16 v[116:119], v[100:103], v[36:39], v[116:119]
    s_branch L_p3gd_30
L_p3gr_29:
    ds_read_b32 v88, v16 offset:0
    ds_read_b32 v89, v16 offset:48
    ds_read_b32 v90, v16 offset:96
    ds_read_b32 v91, v16 offset:144
    ds_read_b32 v92, v16 offset:768
    ds_read_b32 v93, v16 offset:816
    ds_read_b32 v94, v16 offset:864
    ds_read_b32 v95, v16 offset:912
    ds_read_b32 v96, v16 offset:1536
    ds_read_b32 v97, v16 offset:1584
    ds_read_b32 v98, v16 offset:1632
    ds_read_b32 v99, v16 offset:1680
    ds_read_b32 v100, v16 offset:2304
    ds_read_b32 v101, v16 offset:2352
    ds_read_b32 v102, v16 offset:2400
    ds_read_b32 v103, v16 offset:2448
    s_waitcnt lgkmcnt(12)
    v_mfma_f32_16x16x32_bf16 v[104:107], v[88:91], v[24:27], 0
    v_mfma_f32_16x16x32_bf16 v[108:111], v[88:91], v[28:31], 0
    s_waitcnt lgkmcnt(8)
    v_mfma_f32_16x16x32_bf16 v[104:107], v[92:95], v[32:35], v[104:107]
    v_mfma_f32_16x16x32_bf16 v[108:111], v[92:95], v[36:39], v[108:111]
    s_waitcnt lgkmcnt(4)
    v_mfma_f32_16x16x32_bf16 v[112:115], v[96:99], v[24:27], 0
    v_mfma_f32_16x16x32_bf16 v[116:119], v[96:99], v[28:31], 0
    s_waitcnt lgkmcnt(0)
    v_mfma_f32_16x16x32_bf16 v[112:115], v[100:103], v[32:35], v[112:115]
    v_mfma_f32_16x16x32_bf16 v[116:119], v[100:103], v[36:39], v[116:119]
L_p3gd_30:
    s_nop 3
    v_mul_f32 v120, v104, v40
    v_mul_f32 v121, v108, v40
    v_fma_f32 v120, -v108, v41, v120
    v_fmac_f32 v121, v104, v41
    v_mul_f32 v122, v105, v42
    v_mul_f32 v123, v109, v42
    v_fma_f32 v122, -v109, v43, v122
    v_fmac_f32 v123, v105, v43
    v_mul_f32 v124, v106, v44
    v_mul_f32 v125, v110, v44
    v_fma_f32 v124, -v110, v45, v124
    v_fmac_f32 v125, v106, v45
    v_mul_f32 v126, v107, v46
    v_mul_f32 v127, v111, v46
    v_fma_f32 v126, -v111, v47, v126
    v_fmac_f32 v127, v107, v47
    v_cvt_pk_bf16_f32 v80, v120, v121
    v_cvt_pk_bf16_f32 v81, v122, v123
    v_cvt_pk_bf16_f32 v82, v124, v125
    v_cvt_pk_bf16_f32 v83, v126, v127
    s_nop 1
    v_mfma_f32_16x16x32_bf16 v[88:91], v[80:83], v[56:59], 0
    v_mfma_f32_16x16x32_bf16 v[92:95], v[80:83], v[64:67], 0
    v_mfma_f32_16x16x32_bf16 v[96:99], v[80:83], v[72:75], 0
    v_mul_f32 v120, v112, v48
    v_mul_f32 v121, v116, v48
    v_fma_f32 v120, -v116, v49, v120
    v_fmac_f32 v121, v112, v49
    v_mul_f32 v122, v113, v50
    v_mul_f32 v123, v117, v50
    v_fma_f32 v122, -v117, v51, v122
    v_fmac_f32 v123, v113, v51
    v_mul_f32 v124, v114, v52
    v_mul_f32 v125, v118, v52
    v_fma_f32 v124, -v118, v53, v124
    v_fmac_f32 v125, v114, v53
    v_mul_f32 v126, v115, v54
    v_mul_f32 v127, v119, v54
    v_fma_f32 v126, -v119, v55, v126
    v_fmac_f32 v127, v115, v55
    v_cvt_pk_bf16_f32 v84, v120, v121
    v_cvt_pk_bf16_f32 v85, v122, v123
    v_cvt_pk_bf16_f32 v86, v124, v125
    v_cvt_pk_bf16_f32 v87, v126, v127
    s_nop 1
    v_mfma_f32_16x16x32_bf16 v[88:91], v[84:87], v[60:63], v[88:91]
    v_mfma_f32_16x16x32_bf16 v[92:95], v[84:87], v[68:71], v[92:95]
    v_mfma_f32_16x16x32_bf16 v[96:99], v[84:87], v[76:79], v[96:99]
    s_mov_b32 s96, 0x3f3504f3
    s_mov_b32 s97, 0x3f3504f3
    s_nop 3
    ds_write_b128 v20, v[88:91]
    ds_write_b128 v20, v[92:95] offset:2560
    s_mov_b32 exec_lo, 0xff00ff
    s_mov_b32 exec_hi, 0xff00ff
    ds_write_b128 v21, v[96:99] offset:2048
    s_mov_b64 exec, -1
    s_waitcnt lgkmcnt(0)
    s_barrier
    s_cmp_ge_u32 s61, 5
    s_cbranch_scc1 L_fin
    ds_read_b64 v[24:25], v22 offset:0
    ds_read_b64 v[26:27], v22 offset:2560
    ds_read_b64 v[32:33], v22 offset:10240
    ds_read_b64 v[34:35], v22 offset:12800
    ds_read_b64 v[28:29], v22 offset:5120
    ds_read_b64 v[36:37], v22 offset:15360
    ds_read_b64 v[30:31], v22 offset:7680
    ds_read_b64 v[38:39], v22 offset:17920
    s_waitcnt lgkmcnt(6)
    v_pk_add_f32 v[40:41], v[24:25], v[26:27]
    v_pk_add_f32 v[42:43], v[24:25], v[26:27] neg_lo:[0,1] neg_hi:[0,1]
    s_waitcnt lgkmcnt(5)
    v_pk_add_f32 v[44:45], v[40:41], v[32:33]
    v_pk_add_f32 v[46:47], v[40:41], v[32:33] neg_lo:[0,1] neg_hi:[0,1]
    s_waitcnt lgkmcnt(4)
    v_pk_add_f32 v[48:49], v[42:43], v[34:35] neg_lo:[0,1] neg_hi:[0,1]
    v_pk_add_f32 v[50:51], v[42:43], v[34:35]
    s_waitcnt lgkmcnt(2)
    v_pk_add_f32 v[52:53], v[28:29], v[36:37]
    v_pk_add_f32 v[56:57], v[28:29], v[36:37] neg_lo:[0,1] neg_hi:[0,1]
    v_pk_add_f32 v[64:65], v[44:45], v[52:53]
    v_pk_add_f32 v[72:73], v[44:45], v[52:53] neg_lo:[0,1] neg_hi:[0,1]
    v_cvt_pk_bf16_f32 v64, v64, v65
    buffer_store_dword v64, v23, s[48:51], s88 offen
    v_cvt_pk_bf16_f32 v72, v72, v73
    buffer_store_dword v72, v23, s[48:51], s92 offen
    s_waitcnt lgkmcnt(0)
    v_pk_add_f32 v[54:55], v[38:39], v[30:31] neg_lo:[0,1] neg_hi:[0,1]
    v_pk_add_f32 v[58:59], v[30:31], v[38:39]
    v_pk_add_f32 v[68:69], v[46:47], v[54:55]
    v_pk_add_f32 v[76:77], v[46:47], v[54:55] neg_lo:[0,1] neg_hi:[0,1]
    v_cvt_pk_bf16_f32 v68, v68, v69
    buffer_store_dword v68, v23, s[48:51], s90 offen
    v_cvt_pk_bf16_f32 v76, v76, v77
    buffer_store_dword v76, v23, s[48:51], s94 offen
    v_pk_add_f32 v[60:61], v[56:57], v[58:59] neg_lo:[0,1] neg_hi:[0,1]
    v_pk_add_f32 v[62:63], v[56:57], v[58:59]
    v_pk_fma_f32 v[66:67], v[60:61], s[96:97], v[48:49]
    v_pk_fma_f32 v[74:75], v[60:61], s[96:97], v[48:49] neg_lo:[1,0,0] neg_hi:[1,0,0]
    v_cvt_pk_bf16_f32 v66, v66, v67
    buffer_store_dword v66, v23, s[48:51], s89 offen
    v_cvt_pk_bf16_f32 v74, v74, v75
    buffer_store_dword v74, v23, s[48:51], s93 offen
    v_pk_fma_f32 v[70:71], v[62:63], s[96:97], v[50:51] neg_lo:[1,0,0] neg_hi:[1,0,0]
    v_pk_fma_f32 v[78:79], v[62:63], s[96:97], v[50:51]
    v_cvt_pk_bf16_f32 v70, v70, v71
    buffer_store_dword v70, v23, s[48:51], s91 offen
    v_cvt_pk_bf16_f32 v78, v78, v79
    buffer_store_dword v78, v23, s[48:51], s95 offen
    s_branch L_fin
L_roleB2:
    s_cmp_ge_u32 s3, 252
    s_cbranch_scc1 L_epoch
    v_lshrrev_b32 v66, 3, v0
    v_and_b32 v69, 7, v0
    v_mul_u32_u24 v67, 43, v66
    v_lshrrev_b32 v67, 8, v67
    v_mul_u32_u24 v68, 6, v67
    v_sub_u32 v68, v66, v68
    v_xor_b32 v67, v67, v69
    v_lshlrev_b32 v67, 4, v67
    v_lshl_add_u32 v67, v68, 1, v67
    v_lshl_add_u32 v67, v69, 11, v67
    v_add_u32 v12, 60416, v67
    v_add_u32 v66, 64, v66
    v_mul_u32_u24 v67, 43, v66
    v_lshrrev_b32 v67, 8, v67
    v_mul_u32_u24 v68, 6, v67
    v_sub_u32 v68, v66, v68
    v_xor_b32 v67, v67, v69
    v_lshlrev_b32 v67, 4, v67
    v_lshl_add_u32 v67, v68, 1, v67
    v_lshl_add_u32 v67, v69, 11, v67
    v_add_u32 v13, 60416, v67
    v_lshrrev_b32 v66, 4, v0
    s_lshr_b32 s75, s61, 1
    v_xor_b32 v67, s75, v2
    v_lshlrev_b32 v67, 4, v67
    v_lshl_add_u32 v67, v66, 8, v67
    v_add_u32 v14, 60416, v67
    v_mul_u32_u24 v15, 5504, v66
    v_lshl_add_u32 v15, v2, 4, v15
    v_lshlrev_b32 v66, 4, v3
    v_mul_u32_u24 v16, 528, v2
    v_add_u32 v16, v16, v66
    v_lshl_add_u32 v22, v2, 5, v66
    v_add_u32 v22, 16672, v22
    v_and_b32 v67, 3, v2
    v_mul_u32_u24 v67, 4160, v67
    v_and_b32 v68, 12, v2
    v_lshlrev_b32 v68, 1, v68
    v_sub_u32 v67, v67, v68
    v_add3_u32 v21, v67, v66, 24
    v_lshlrev_b32 v67, 5, v2
    v_lshl_add_u32 v67, v3, 3, v67
    v_add_u32 v23, 63872, v67
    v_lshrrev_b32 v67, 1, v3
    v_lshlrev_b32 v67, 8, v67
    v_lshl_add_u32 v67, v2, 4, v67
    v_and_b32 v68, 1, v3
    v_lshl_add_u32 v67, v68, 3, v67
    v_add_u32 v17, 77272, v67
    v_lshlrev_b32 v67, 7, v3
    v_add_u32 v67, 77784, v67
    v_lshl_add_u32 v18, v2, 2, v67
    v_add_u32 v19, 64, v18
    v_lshl_add_u32 v20, v2, 1, v67
    v_add_u32 v20, 512, v20
    s_mov_b32 exec_lo, 0xffffffff
    s_mov_b32 exec_hi, 0x0
    v_lshl_add_u32 v18, v2, 3, v67
    v_add_u32 v19, 4, v18
    s_mov_b64 exec, -1
    v_mul_u32_u24 v66, 1552, v1
    v_add_u32 v66, 77264, v66
    v_mov_b32 v68, 0
    v_mov_b32 v69, 0
    s_mov_b64 exec, 7
    ds_write_b64 v66, v[68:69]
    s_mov_b64 exec, -1
    s_waitcnt vmcnt(2)
    s_setprio 1
    s_and_b32 s75, s61, 1
    s_lshl_b32 s75, s75, 8
    s_add_u32 m0, s75, 0
    s_lshr_b32 s75, s61, 1
    s_cmp_eq_u32 s75, 1
    s_cbranch_scc1 L_kg_32
    s_cmp_eq_u32 s75, 2
    s_cbranch_scc1 L_kg_33
    s_cmp_eq_u32 s75, 3
    s_cbranch_scc1 L_kg_34
L_kg_31:
    v_lshlrev_b32 v24, 16, v40
    v_lshlrev_b32 v25, 16, v41
    v_mul_f32 v24, v24, v37
    v_mul_f32 v25, v25, v37
    v_mul_f32 v30, 0x4138aa3b, v24
    v_mul_f32 v31, 0x3fa2f983, v25
    v_fract_f32 v31, v31
    v_exp_f32 v30, v30
    v_cos_f32 v66, v31
    v_sin_f32 v67, v31
    v_lshlrev_b32 v72, 16, v42
    v_lshlrev_b32 v73, 16, v43
    v_lshlrev_b32 v70, 16, v44
    v_lshlrev_b32 v71, 16, v45
    v_mul_f32 v72, v72, v37
    v_mul_f32 v73, v73, v37
    v_mul_f32 v66, v66, v30
    v_mul_f32 v67, v67, v30
    v_mul_f32 v74, v71, v73
    v_mul_f32 v75, v71, v72
    v_mul_f32 v68, v67, v67
    v_mul_f32 v69, v67, v66
    v_fma_f32 v74, v70, v72, -v74
    v_fmac_f32 v75, v70, v73
    v_fma_f32 v68, v66, v66, -v68
    v_fmac_f32 v69, v66, v67
    v_mul_f32 v76, v75, v67
    v_mul_f32 v77, v75, v66
    v_fma_f32 v76, v74, v66, -v76
    v_fmac_f32 v77, v74, v67
    v_mul_f32 v78, v75, v69
    v_mul_f32 v79, v75, v68
    v_mul_f32 v80, v77, v69
    v_mul_f32 v81, v77, v68
    v_fma_f32 v78, v74, v68, -v78
    v_fmac_f32 v79, v74, v69
    v_fma_f32 v80, v76, v68, -v80
    v_fmac_f32 v81, v76, v69
    v_cvt_pk_bf16_f32 v26, v74, -v75
    v_cvt_pk_bf16_f32 v27, v76, -v77
    ds_write_addtid_b32 v26 offset:21648
    ds_write_addtid_b32 v27 offset:22176
    v_mul_f32 v74, v79, v69
    v_mul_f32 v75, v79, v68
    v_mul_f32 v76, v81, v69
    v_mul_f32 v77, v81, v68
    v_fma_f32 v74, v78, v68, -v74
    v_fmac_f32 v75, v78, v69
    v_fma_f32 v76, v80, v68, -v76
    v_fmac_f32 v77, v80, v69
    v_cvt_pk_bf16_f32 v28, v78, -v79
    v_cvt_pk_bf16_f32 v29, v80, -v81
    ds_write_addtid_b32 v28 offset:22704
    ds_write_addtid_b32 v29 offset:23232
    v_mul_f32 v78, v75, v69
    v_mul_f32 v79, v75, v68
    v_mul_f32 v80, v77, v69
    v_mul_f32 v81, v77, v68
    v_fma_f32 v78, v74, v68, -v78
    v_fmac_f32 v79, v74, v69
    v_fma_f32 v80, v76, v68, -v80
    v_fmac_f32 v81, v76, v69
    v_cvt_pk_bf16_f32 v26, v74, -v75
    v_cvt_pk_bf16_f32 v27, v76, -v77
    ds_write_addtid_b32 v26 offset:23760
    ds_write_addtid_b32 v27 offset:24288
    v_mul_f32 v74, v79, v69
    v_mul_f32 v75, v79, v68
    v_mul_f32 v76, v81, v69
    v_mul_f32 v77, v81, v68
    v_fma_f32 v74, v78, v68, -v74
    v_fmac_f32 v75, v78, v69
    v_fma_f32 v76, v80, v68, -v76
    v_fmac_f32 v77, v80, v69
    v_cvt_pk_bf16_f32 v28, v78, -v79
    v_cvt_pk_bf16_f32 v29, v80, -v81
    ds_write_addtid_b32 v28 offset:24816
    ds_write_addtid_b32 v29 offset:25344
    s_waitcnt vmcnt(0)
    ds_write_b16 v12, v58 offset:0
    v_mul_f32 v78, v75, v69
    v_mul_f32 v79, v75, v68
    v_mul_f32 v80, v77, v69
    v_mul_f32 v81, v77, v68
    v_fma_f32 v78, v74, v68, -v78
    v_fmac_f32 v79, v74, v69
    v_fma_f32 v80, v76, v68, -v80
    v_fmac_f32 v81, v76, v69
    v_cvt_pk_bf16_f32 v26, v74, -v75
    v_cvt_pk_bf16_f32 v27, v76, -v77
    ds_write_addtid_b32 v26 offset:25872
    ds_write_b16_d16_hi v12, v58 offset:256
    ds_write_b16 v12, v59 offset:512
    ds_write_addtid_b32 v27 offset:26400
    ds_write_b16_d16_hi v12, v59 offset:768
    ds_write_b16 v12, v60 offset:1024
    v_mul_f32 v74, v79, v69
    v_mul_f32 v75, v79, v68
    v_mul_f32 v76, v81, v69
    v_mul_f32 v77, v81, v68
    v_fma_f32 v74, v78, v68, -v74
    v_fmac_f32 v75, v78, v69
    v_fma_f32 v76, v80, v68, -v76
    v_fmac_f32 v77, v80, v69
    v_cvt_pk_bf16_f32 v28, v78, -v79
    v_cvt_pk_bf16_f32 v29, v80, -v81
    ds_write_addtid_b32 v28 offset:26928
    ds_write_b16_d16_hi v12, v60 offset:1280
    ds_write_b16 v12, v61 offset:1536
    ds_write_addtid_b32 v29 offset:27456
    ds_write_b16_d16_hi v12, v61 offset:1792
    s_cmp_ge_u32 s61, 4
    s_cbranch_scc1 L_t1w_36
    ds_write_b16 v13, v62 offset:0
    ds_write_b16_d16_hi v13, v62 offset:256
    ds_write_b16 v13, v63 offset:512
    ds_write_b16_d16_hi v13, v63 offset:768
    ds_write_b16 v13, v64 offset:1024
    ds_write_b16_d16_hi v13, v64 offset:1280
    ds_write_b16 v13, v65 offset:1536
    ds_write_b16_d16_hi v13, v65 offset:1792
L_t1w_36:
    v_mul_f32 v78, v75, v69
    v_mul_f32 v79, v75, v68
    v_mul_f32 v80, v77, v69
    v_mul_f32 v81, v77, v68
    v_fma_f32 v78, v74, v68, -v78
    v_fmac_f32 v79, v74, v69
    v_fma_f32 v80, v76, v68, -v80
    v_fmac_f32 v81, v76, v69
    v_cvt_pk_bf16_f32 v26, v74, -v75
    v_cvt_pk_bf16_f32 v27, v76, -v77
    ds_write_addtid_b32 v26 offset:27984
    ds_write_addtid_b32 v27 offset:28512
    v_cvt_pk_bf16_f32 v28, v78, -v79
    v_cvt_pk_bf16_f32 v29, v80, -v81
    ds_write_addtid_b32 v28 offset:29040
    ds_write_addtid_b32 v29 offset:29568
    s_branch L_kg_done_35
L_kg_32:
    v_lshlrev_b32 v24, 16, v40
    v_lshlrev_b32 v25, 16, v41
    v_mul_f32 v24, v24, v37
    v_mul_f32 v25, v25, v37
    v_mul_f32 v30, 0x3fb8aa3b, v24
    v_mul_f32 v31, 0x3e22f983, v25
    v_mul_f32 v32, 0x4338aa3b, v24
    v_mul_f32 v33, 0x41a2f983, v25
    v_fract_f32 v31, v31
    v_exp_f32 v30, v30
    v_fract_f32 v33, v33
    v_exp_f32 v32, v32
    v_cos_f32 v68, v31
    v_sin_f32 v69, v31
    v_cos_f32 v82, v33
    v_sin_f32 v83, v33
    v_mov_b32 v29, 0x3f80
    ds_write_addtid_b32 v29 offset:0
    v_mul_f32 v68, v68, v30
    v_mul_f32 v69, v69, v30
    v_mul_f32 v82, v82, v32
    v_mul_f32 v83, v83, v32
    v_mul_f32 v70, v69, v69
    v_mul_f32 v71, v69, v68
    v_mul_f32 v84, v83, v69
    v_mul_f32 v85, v83, v68
    v_fma_f32 v70, v68, v68, -v70
    v_fmac_f32 v71, v68, v69
    v_fma_f32 v84, v82, v68, -v84
    v_fmac_f32 v85, v82, v69
    v_cvt_pk_bf16_f32 v26, v68, v69
    v_cvt_pk_bf16_f32 v27, v82, v83
    ds_write_addtid_b32 v26 offset:528
    ds_write_addtid_b32 v27 offset:4224
    v_mul_f32 v72, v71, v69
    v_mul_f32 v73, v71, v68
    v_mul_f32 v74, v71, v71
    v_mul_f32 v75, v71, v70
    v_mul_f32 v86, v83, v71
    v_mul_f32 v87, v83, v70
    v_fma_f32 v72, v70, v68, -v72
    v_fmac_f32 v73, v70, v69
    v_fma_f32 v74, v70, v70, -v74
    v_fmac_f32 v75, v70, v71
    v_fma_f32 v86, v82, v70, -v86
    v_fmac_f32 v87, v82, v71
    v_cvt_pk_bf16_f32 v28, v70, v71
    v_cvt_pk_bf16_f32 v29, v84, v85
    ds_write_addtid_b32 v28 offset:1056
    ds_write_addtid_b32 v29 offset:4752
    v_mul_f32 v76, v75, v69
    v_mul_f32 v77, v75, v68
    v_mul_f32 v78, v75, v71
    v_mul_f32 v79, v75, v70
    v_mul_f32 v80, v75, v73
    v_mul_f32 v81, v75, v72
    v_mul_f32 v88, v83, v73
    v_mul_f32 v89, v83, v72
    v_mul_f32 v90, v83, v75
    v_mul_f32 v91, v83, v74
    v_fma_f32 v76, v74, v68, -v76
    v_fmac_f32 v77, v74, v69
    v_fma_f32 v78, v74, v70, -v78
    v_fmac_f32 v79, v74, v71
    v_fma_f32 v80, v74, v72, -v80
    v_fmac_f32 v81, v74, v73
    v_fma_f32 v88, v82, v72, -v88
    v_fmac_f32 v89, v82, v73
    v_fma_f32 v90, v82, v74, -v90
    v_fmac_f32 v91, v82, v75
    v_cvt_pk_bf16_f32 v26, v72, v73
    v_cvt_pk_bf16_f32 v27, v74, v75
    v_cvt_pk_bf16_f32 v28, v86, v87
    ds_write_addtid_b32 v26 offset:1584
    ds_write_addtid_b32 v27 offset:2112
    ds_write_addtid_b32 v28 offset:5280
    v_mul_f32 v84, v83, v77
    v_mul_f32 v85, v83, v76
    v_mul_f32 v86, v83, v79
    v_mul_f32 v87, v83, v78
    v_fma_f32 v84, v82, v76, -v84
    v_fmac_f32 v85, v82, v77
    v_fma_f32 v86, v82, v78, -v86
    v_fmac_f32 v87, v82, v79
    v_cvt_pk_bf16_f32 v29, v88, v89
    v_cvt_pk_bf16_f32 v26, v90, v91
    v_cvt_pk_bf16_f32 v27, v76, v77
    ds_write_addtid_b32 v29 offset:5808
    s_waitcnt vmcnt(0)
    ds_write_b16 v12, v58 offset:0
    ds_write_addtid_b32 v26 offset:6336
    ds_write_b16_d16_hi v12, v58 offset:256
    ds_write_b16 v12, v59 offset:512
    ds_write_addtid_b32 v27 offset:2640
    ds_write_b16_d16_hi v12, v59 offset:768
    ds_write_b16 v12, v60 offset:1024
    v_mul_f32 v88, v83, v81
    v_mul_f32 v89, v83, v80
    v_fma_f32 v88, v82, v80, -v88
    v_fmac_f32 v89, v82, v81
    v_cvt_pk_bf16_f32 v28, v78, v79
    v_cvt_pk_bf16_f32 v29, v80, v81
    v_cvt_pk_bf16_f32 v26, v84, v85
    ds_write_addtid_b32 v28 offset:3168
    ds_write_b16_d16_hi v12, v60 offset:1280
    ds_write_b16 v12, v61 offset:1536
    ds_write_addtid_b32 v29 offset:3696
    ds_write_b16_d16_hi v12, v61 offset:1792
    s_cmp_ge_u32 s61, 4
    s_cbranch_scc1 L_t1w_37
    ds_write_b16 v13, v62 offset:0
    ds_write_b16_d16_hi v13, v62 offset:256
    ds_write_b16 v13, v63 offset:512
    ds_write_b16_d16_hi v13, v63 offset:768
    ds_write_b16 v13, v64 offset:1024
    ds_write_b16_d16_hi v13, v64 offset:1280
    ds_write_b16 v13, v65 offset:1536
    ds_write_b16_d16_hi v13, v65 offset:1792
L_t1w_37:
    ds_write_addtid_b32 v26 offset:6864
    v_cvt_pk_bf16_f32 v27, v86, v87
    v_cvt_pk_bf16_f32 v28, v88, v89
    ds_write_addtid_b32 v27 offset:7392
    ds_write_addtid_b32 v28 offset:7920
    s_branch L_kg_done_35
L_kg_33:
    v_lshlrev_b32 v24, 16, v40
    v_lshlrev_b32 v25, 16, v41
    v_mul_f32 v24, v24, v37
    v_mul_f32 v25, v25, v37
    v_mul_f32 v30, 0x4038aa3b, v24
    v_mul_f32 v31, 0x3ea2f983, v25
    v_mul_f32 v32, 0x4338aa3b, v24
    v_mul_f32 v33, 0x41a2f983, v25
    v_fract_f32 v31, v31
    v_exp_f32 v30, v30
    v_fract_f32 v33, v33
    v_exp_f32 v32, v32
    v_cos_f32 v66, v31
    v_sin_f32 v67, v31
    v_cos_f32 v72, v33
    v_sin_f32 v73, v33
    s_nop 0
    v_mul_f32 v66, v66, v30
    v_mul_f32 v67, v67, v30
    v_mul_f32 v72, v72, v32
    v_mul_f32 v73, v73, v32
    v_mul_f32 v68, v67, v67
    v_mul_f32 v69, v67, v66
    v_mul_f32 v74, v73, v73
    v_mul_f32 v75, v73, v72
    v_fma_f32 v68, v66, v66, -v68
    v_fmac_f32 v69, v66, v67
    v_fma_f32 v74, v72, v72, -v74
    v_fmac_f32 v75, v72, v73
    v_mul_f32 v70, v69, v67
    v_mul_f32 v71, v69, v66
    v_mul_f32 v76, v75, v73
    v_mul_f32 v77, v75, v72
    v_mul_f32 v78, v75, v75
    v_mul_f32 v79, v75, v74
    v_mul_f32 v82, v75, v67
    v_mul_f32 v83, v75, v66
    v_mul_f32 v84, v75, v69
    v_mul_f32 v85, v75, v68
    v_fma_f32 v70, v68, v66, -v70
    v_fmac_f32 v71, v68, v67
    v_fma_f32 v76, v74, v72, -v76
    v_fmac_f32 v77, v74, v73
    v_fma_f32 v78, v74, v74, -v78
    v_fmac_f32 v79, v74, v75
    v_fma_f32 v82, v74, v66, -v82
    v_fmac_f32 v83, v74, v67
    v_fma_f32 v84, v74, v68, -v84
    v_fmac_f32 v85, v74, v69
    v_cvt_pk_bf16_f32 v29, v74, v75
    ds_write_addtid_b32 v29 offset:8448
    v_mul_f32 v86, v75, v71
    v_mul_f32 v87, v75, v70
    v_mul_f32 v88, v77, v67
    v_mul_f32 v89, v77, v66
    v_mul_f32 v80, v79, v73
    v_mul_f32 v81, v79, v72
    v_fma_f32 v86, v74, v70, -v86
    v_fmac_f32 v87, v74, v71
    v_fma_f32 v88, v76, v66, -v88
    v_fmac_f32 v89, v76, v67
    v_fma_f32 v80, v78, v72, -v80
    v_fmac_f32 v81, v78, v73
    v_cvt_pk_bf16_f32 v26, v82, v83
    v_cvt_pk_bf16_f32 v27, v84, v85
    v_cvt_pk_bf16_f32 v28, v76, v77
    v_cvt_pk_bf16_f32 v29, v78, v79
    ds_write_addtid_b32 v26 offset:8976
    ds_write_addtid_b32 v27 offset:9504
    ds_write_addtid_b32 v28 offset:10560
    ds_write_addtid_b32 v29 offset:12672
    v_mul_f32 v82, v77, v69
    v_mul_f32 v83, v77, v68
    v_mul_f32 v84, v77, v71
    v_mul_f32 v85, v77, v70
    v_mul_f32 v66, v79, v69
    v_mul_f32 v67, v79, v68
    v_mul_f32 v72, v81, v69
    v_mul_f32 v73, v81, v68
    v_fma_f32 v82, v76, v68, -v82
    v_fmac_f32 v83, v76, v69
    v_fma_f32 v84, v76, v70, -v84
    v_fmac_f32 v85, v76, v71
    v_fma_f32 v66, v78, v68, -v66
    v_fmac_f32 v67, v78, v69
    v_fma_f32 v72, v80, v68, -v72
    v_fmac_f32 v73, v80, v69
    v_cvt_pk_bf16_f32 v26, v86, v87
    v_cvt_pk_bf16_f32 v27, v88, v89
    v_cvt_pk_bf16_f32 v28, v80, v81
    ds_write_addtid_b32 v26 offset:10032
    ds_write_addtid_b32 v27 offset:11088
    ds_write_addtid_b32 v28 offset:13728
    s_waitcnt vmcnt(0)
    ds_write_b16 v12, v58 offset:0
    v_cvt_pk_bf16_f32 v29, v82, v83
    v_cvt_pk_bf16_f32 v26, v84, v85
    v_cvt_pk_bf16_f32 v27, v66, v67
    v_cvt_pk_bf16_f32 v28, v72, v73
    ds_write_addtid_b32 v29 offset:11616
    ds_write_b16_d16_hi v12, v58 offset:256
    ds_write_b16 v12, v59 offset:512
    ds_write_addtid_b32 v26 offset:12144
    ds_write_b16_d16_hi v12, v59 offset:768
    ds_write_b16 v12, v60 offset:1024
    ds_write_addtid_b32 v27 offset:13200
    ds_write_b16_d16_hi v12, v60 offset:1280
    ds_write_b16 v12, v61 offset:1536
    ds_write_addtid_b32 v28 offset:14256
    ds_write_b16_d16_hi v12, v61 offset:1792
    s_cmp_ge_u32 s61, 4
    s_cbranch_scc1 L_t1w_38
    ds_write_b16 v13, v62 offset:0
    ds_write_b16_d16_hi v13, v62 offset:256
    ds_write_b16 v13, v63 offset:512
    ds_write_b16_d16_hi v13, v63 offset:768
    ds_write_b16 v13, v64 offset:1024
    ds_write_b16_d16_hi v13, v64 offset:1280
    ds_write_b16 v13, v65 offset:1536
    ds_write_b16_d16_hi v13, v65 offset:1792
L_t1w_38:
    s_branch L_kg_done_35
L_kg_34:
    v_lshlrev_b32 v24, 16, v40
    v_lshlrev_b32 v25, 16, v41
    v_mul_f32 v24, v24, v37
    v_mul_f32 v25, v25, v37
    v_mul_f32 v30, 0x40b8aa3b, v24
    v_mul_f32 v31, 0x3f22f983, v25
    v_mul_f32 v32, 0x4338aa3b, v24
    v_mul_f32 v33, 0x41a2f983, v25
    v_mul_f32 v34, 0x44b8aa3b, v24
    v_mul_f32 v35, 0x4322f983, v25
    v_fract_f32 v31, v31
    v_exp_f32 v30, v30
    v_fract_f32 v33, v33
    v_exp_f32 v32, v32
    v_fract_f32 v35, v35
    v_exp_f32 v34, v34
    v_cos_f32 v66, v31
    v_sin_f32 v67, v31
    v_cos_f32 v68, v33
    v_sin_f32 v69, v33
    v_cos_f32 v72, v35
    v_sin_f32 v73, v35
    v_mul_f32 v66, v66, v30
    v_mul_f32 v67, v67, v30
    v_mul_f32 v68, v68, v32
    v_mul_f32 v69, v69, v32
    v_mul_f32 v72, v72, v34
    v_mul_f32 v73, v73, v34
    v_mul_f32 v70, v69, v69
    v_mul_f32 v71, v69, v68
    v_mul_f32 v74, v73, v69
    v_mul_f32 v75, v73, v68
    v_mul_f32 v78, v73, v73
    v_mul_f32 v79, v73, v72
    v_fma_f32 v70, v68, v68, -v70
    v_fmac_f32 v71, v68, v69
    v_fma_f32 v74, v72, v68, -v74
    v_fmac_f32 v75, v72, v69
    v_fma_f32 v78, v72, v72, -v78
    v_fmac_f32 v79, v72, v73
    v_cvt_pk_bf16_f32 v29, v72, v73
    ds_write_addtid_b32 v29 offset:16896
    v_mul_f32 v76, v73, v71
    v_mul_f32 v77, v73, v70
    v_mul_f32 v80, v75, v71
    v_mul_f32 v81, v75, v70
    v_mul_f32 v82, v71, v71
    v_mul_f32 v83, v71, v70
    v_fma_f32 v76, v72, v70, -v76
    v_fmac_f32 v77, v72, v71
    v_fma_f32 v80, v74, v70, -v80
    v_fmac_f32 v81, v74, v71
    v_fma_f32 v82, v70, v70, -v82
    v_fmac_f32 v83, v70, v71
    v_cvt_pk_bf16_f32 v26, v74, v75
    v_cvt_pk_bf16_f32 v27, v78, v79
    ds_write_addtid_b32 v26 offset:17424
    ds_write_addtid_b32 v27 offset:21120
    v_mul_f32 v84, v83, v71
    v_mul_f32 v85, v83, v70
    v_mul_f32 v78, v77, v71
    v_mul_f32 v79, v77, v70
    v_mul_f32 v74, v81, v71
    v_mul_f32 v75, v81, v70
    v_fma_f32 v84, v82, v70, -v84
    v_fmac_f32 v85, v82, v71
    v_fma_f32 v78, v76, v70, -v78
    v_fmac_f32 v79, v76, v71
    v_fma_f32 v74, v80, v70, -v74
    v_fmac_f32 v75, v80, v71
    v_cvt_pk_bf16_f32 v28, v76, v77
    v_cvt_pk_bf16_f32 v29, v80, v81
    ds_write_addtid_b32 v28 offset:17952
    ds_write_addtid_b32 v29 offset:18480
    v_mul_f32 v86, v85, v69
    v_mul_f32 v87, v85, v68
    v_mul_f32 v82, v85, v67
    v_mul_f32 v83, v85, v66
    v_mul_f32 v76, v79, v71
    v_mul_f32 v77, v79, v70
    v_mul_f32 v80, v75, v71
    v_mul_f32 v81, v75, v70
    v_fma_f32 v86, v84, v68, -v86
    v_fmac_f32 v87, v84, v69
    v_fma_f32 v82, v84, v66, -v82
    v_fmac_f32 v83, v84, v67
    v_fma_f32 v76, v78, v70, -v76
    v_fmac_f32 v77, v78, v71
    v_fma_f32 v80, v74, v70, -v80
    v_fmac_f32 v81, v74, v71
    v_cvt_pk_bf16_f32 v26, v78, v79
    v_cvt_pk_bf16_f32 v27, v74, v75
    v_cvt_pk_bf16_f32 v28, v84, v85
    ds_write_addtid_b32 v26 offset:19008
    ds_write_addtid_b32 v27 offset:19536
    ds_write_addtid_b32 v28 offset:14784
    s_waitcnt vmcnt(0)
    ds_write_b16 v12, v58 offset:0
    v_mul_f32 v78, v87, v67
    v_mul_f32 v79, v87, v66
    v_fma_f32 v78, v86, v66, -v78
    v_fmac_f32 v79, v86, v67
    v_cvt_pk_bf16_f32 v29, v82, v83
    v_cvt_pk_bf16_f32 v26, v76, v77
    v_cvt_pk_bf16_f32 v27, v80, v81
    v_cvt_pk_bf16_f32 v28, v86, v87
    ds_write_addtid_b32 v29 offset:15312
    ds_write_b16_d16_hi v12, v58 offset:256
    ds_write_b16 v12, v59 offset:512
    ds_write_addtid_b32 v26 offset:20064
    ds_write_b16_d16_hi v12, v59 offset:768
    ds_write_b16 v12, v60 offset:1024
    ds_write_addtid_b32 v27 offset:20592
    ds_write_b16_d16_hi v12, v60 offset:1280
    ds_write_b16 v12, v61 offset:1536
    ds_write_addtid_b32 v28 offset:15840
    ds_write_b16_d16_hi v12, v61 offset:1792
    s_cmp_ge_u32 s61, 4
    s_cbranch_scc1 L_t1w_39
    ds_write_b16 v13, v62 offset:0
    ds_write_b16_d16_hi v13, v62 offset:256
    ds_write_b16 v13, v63 offset:512
    ds_write_b16_d16_hi v13, v63 offset:768
    ds_write_b16 v13, v64 offset:1024
    ds_write_b16_d16_hi v13, v64 offset:1280
    ds_write_b16 v13, v65 offset:1536
    ds_write_b16_d16_hi v13, v65 offset:1792
L_t1w_39:
    v_cvt_pk_bf16_f32 v29, v78, v79
    ds_write_addtid_b32 v29 offset:16368
L_kg_done_35:
    s_waitcnt lgkmcnt(0)
    s_barrier
    v_xor_b32 v6, 64, v14
    ds_read_b128 v[58:61], v14
    ds_read_b128 v[62:65], v6 offset:8192
    s_add_u32 s88, s69, 9437184
    s_add_u32 s89, s88, 176128
    s_waitcnt lgkmcnt(1)
    v_mov_b32 v61, s60
    s_waitcnt lgkmcnt(0)
    v_mov_b32 v65, s60
    s_cmp_ge_u32 s3, 220
    s_cbranch_scc1 L_notile_40
    s_cmp_eq_u32 s67, 21
    s_cselect_b32 exec_lo, 0x00ff00ff, -1
    s_cselect_b32 exec_hi, 0x00ff00ff, -1
    buffer_store_dwordx4 v[58:61], v15, s[52:55], s88 offen sc0 sc1
    buffer_store_dwordx4 v[62:65], v15, s[52:55], s89 offen sc0 sc1
    s_mov_b64 exec, -1
L_notile_40:
    s_and_b32 s75, s61, 1
    s_lshl_b32 s75, s75, 8
    s_add_u32 m0, s75, 30096
    s_lshr_b32 s75, s61, 1
    s_cmp_eq_u32 s75, 1
    s_cbranch_scc1 L_kg_42
    s_cmp_eq_u32 s75, 2
    s_cbranch_scc1 L_kg_43
    s_cmp_eq_u32 s75, 3
    s_cbranch_scc1 L_kg_44
L_kg_41:
    v_lshlrev_b32 v24, 16, v46
    v_lshlrev_b32 v25, 16, v47
    v_mul_f32 v24, v24, v38
    v_mul_f32 v25, v25, v38
    v_mul_f32 v30, 0x4138aa3b, v24
    v_mul_f32 v31, 0x3fa2f983, v25
    v_fract_f32 v31, v31
    v_exp_f32 v30, v30
    v_cos_f32 v66, v31
    v_sin_f32 v67, v31
    v_lshlrev_b32 v72, 16, v48
    v_lshlrev_b32 v73, 16, v49
    v_lshlrev_b32 v70, 16, v50
    v_lshlrev_b32 v71, 16, v51
    v_mul_f32 v72, v72, v38
    v_mul_f32 v73, v73, v38
    v_mul_f32 v66, v66, v30
    v_mul_f32 v67, v67, v30
    v_mul_f32 v74, v71, v73
    v_mul_f32 v75, v71, v72
    v_mul_f32 v68, v67, v67
    v_mul_f32 v69, v67, v66
    v_fma_f32 v74, v70, v72, -v74
    v_fmac_f32 v75, v70, v73
    v_fma_f32 v68, v66, v66, -v68
    v_fmac_f32 v69, v66, v67
    v_mul_f32 v76, v75, v67
    v_mul_f32 v77, v75, v66
    v_fma_f32 v76, v74, v66, -v76
    v_fmac_f32 v77, v74, v67
    v_mul_f32 v78, v75, v69
    v_mul_f32 v79, v75, v68
    v_mul_f32 v80, v77, v69
    v_mul_f32 v81, v77, v68
    v_fma_f32 v78, v74, v68, -v78
    v_fmac_f32 v79, v74, v69
    v_fma_f32 v80, v76, v68, -v80
    v_fmac_f32 v81, v76, v69
    v_cvt_pk_bf16_f32 v26, v74, -v75
    v_cvt_pk_bf16_f32 v27, v76, -v77
    ds_write_addtid_b32 v26 offset:21648
    s_cmp_ge_u32 s61, 3
    s_cbranch_scc1 L_jp_46
    v_add_u32 v5, 0, v16
    s_mul_i32 s78, s61, 8448
    v_add_u32 v4, s78, v5
    ds_read_b128 v[92:95], v4 offset:0
    ds_read_b128 v[108:111], v5 offset:21648
    ds_read_b128 v[96:99], v4 offset:64
    ds_read_b128 v[112:115], v5 offset:21712
    ds_read_b128 v[100:103], v4 offset:128
    ds_read_b128 v[116:119], v5 offset:21776
    ds_read_b128 v[104:107], v4 offset:192
    ds_read_b128 v[120:123], v5 offset:21840
    s_lshr_b64 s[82:83], s[72:73], 0
    s_lshl_b32 s78, s82, 16
    s_cmp_eq_u32 s61, 0
    s_cselect_b32 s78, s78, 0
    v_mov_b32 v124, 0
    v_mov_b32 v125, 0
    v_mov_b32 v126, 0
    v_mov_b32 v127, 0
    v_writelane_b32 v124, s78, 0
L_jp_46:
    ds_write_addtid_b32 v27 offset:22176
    v_mul_f32 v74, v79, v69
    v_mul_f32 v75, v79, v68
    v_mul_f32 v76, v81, v69
    v_mul_f32 v77, v81, v68
    v_fma_f32 v74, v78, v68, -v74
    v_fmac_f32 v75, v78, v69
    v_fma_f32 v76, v80, v68, -v76
    v_fmac_f32 v77, v80, v69
    v_cvt_pk_bf16_f32 v28, v78, -v79
    v_cvt_pk_bf16_f32 v29, v80, -v81
    ds_write_addtid_b32 v28 offset:22704
    ds_write_addtid_b32 v29 offset:23232
    v_mul_f32 v78, v75, v69
    v_mul_f32 v79, v75, v68
    v_mul_f32 v80, v77, v69
    v_mul_f32 v81, v77, v68
    v_fma_f32 v78, v74, v68, -v78
    v_fmac_f32 v79, v74, v69
    v_fma_f32 v80, v76, v68, -v80
    v_fmac_f32 v81, v76, v69
    v_cvt_pk_bf16_f32 v26, v74, -v75
    v_cvt_pk_bf16_f32 v27, v76, -v77
    ds_write_addtid_b32 v26 offset:23760
    s_cmp_ge_u32 s61, 3
    s_cbranch_scc1 L_jp_47
    s_waitcnt lgkmcnt(0)
    v_mfma_f32_16x16x32_bf16 v[124:127], v[92:95], v[108:111], v[124:127]
    v_mfma_f32_16x16x32_bf16 v[124:127], v[96:99], v[112:115], v[124:127]
    v_mfma_f32_16x16x32_bf16 v[124:127], v[100:103], v[116:119], v[124:127]
    v_mfma_f32_16x16x32_bf16 v[124:127], v[104:107], v[120:123], v[124:127]
    ds_read_b128 v[92:95], v4 offset:256
    ds_read_b128 v[108:111], v5 offset:21904
    ds_read_b128 v[96:99], v4 offset:320
    ds_read_b128 v[112:115], v5 offset:21968
    ds_read_b128 v[100:103], v4 offset:384
    ds_read_b128 v[116:119], v5 offset:22032
    ds_read_b128 v[104:107], v4 offset:448
    ds_read_b128 v[120:123], v5 offset:22096
L_jp_47:
    ds_write_addtid_b32 v27 offset:24288
    v_mul_f32 v74, v79, v69
    v_mul_f32 v75, v79, v68
    v_mul_f32 v76, v81, v69
    v_mul_f32 v77, v81, v68
    v_fma_f32 v74, v78, v68, -v74
    v_fmac_f32 v75, v78, v69
    v_fma_f32 v76, v80, v68, -v76
    v_fmac_f32 v77, v80, v69
    v_cvt_pk_bf16_f32 v28, v78, -v79
    v_cvt_pk_bf16_f32 v29, v80, -v81
    ds_write_addtid_b32 v28 offset:24816
    ds_write_addtid_b32 v29 offset:25344
    v_mul_f32 v78, v75, v69
    v_mul_f32 v79, v75, v68
    v_mul_f32 v80, v77, v69
    v_mul_f32 v81, v77, v68
    v_fma_f32 v78, v74, v68, -v78
    v_fmac_f32 v79, v74, v69
    v_fma_f32 v80, v76, v68, -v80
    v_fmac_f32 v81, v76, v69
    v_cvt_pk_bf16_f32 v26, v74, -v75
    v_cvt_pk_bf16_f32 v27, v76, -v77
    ds_write_addtid_b32 v26 offset:25872
    ds_write_addtid_b32 v27 offset:26400
    s_cmp_ge_u32 s61, 3
    s_cbranch_scc1 L_jp_48
    s_waitcnt lgkmcnt(0)
    v_mfma_f32_16x16x32_bf16 v[124:127], v[92:95], v[108:111], v[124:127]
    v_mfma_f32_16x16x32_bf16 v[124:127], v[96:99], v[112:115], v[124:127]
    v_mfma_f32_16x16x32_bf16 v[124:127], v[100:103], v[116:119], v[124:127]
    v_mfma_f32_16x16x32_bf16 v[124:127], v[104:107], v[120:123], v[124:127]
    s_cmp_eq_u32 s61, 0
    s_cselect_b64 s[84:85], -1, 0
    v_add_u32 v6, 4, v17
    v_cndmask_b32_e64 v7, v19, v6, s[84:85]
    v_cndmask_b32_e64 v6, v18, v17, s[84:85]
    s_nop 2
    v_cvt_pk_bf16_f32 v124, v124, v125
    v_cvt_pk_bf16_f32 v126, v126, v127
    s_cmp_eq_u32 s61, 2
    s_cbranch_scc1 L_jp_49
    ds_write_b32 v6, v124 offset:0
    ds_write_b32 v7, v126 offset:0
    s_branch L_jp_48
L_jp_49:
    ds_write_b16 v20, v124 offset:0
    ds_write_b16_d16_hi v20, v124 offset:32
    ds_write_b16 v20, v126 offset:64
    ds_write_b16_d16_hi v20, v126 offset:96
L_jp_48:
    v_mul_f32 v74, v79, v69
    v_mul_f32 v75, v79, v68
    v_mul_f32 v76, v81, v69
    v_mul_f32 v77, v81, v68
    v_fma_f32 v74, v78, v68, -v74
    v_fmac_f32 v75, v78, v69
    v_fma_f32 v76, v80, v68, -v76
    v_fmac_f32 v77, v80, v69
    v_cvt_pk_bf16_f32 v28, v78, -v79
    v_cvt_pk_bf16_f32 v29, v80, -v81
    ds_write_addtid_b32 v28 offset:26928
    ds_write_addtid_b32 v29 offset:27456
    v_mul_f32 v78, v75, v69
    v_mul_f32 v79, v75, v68
    v_mul_f32 v80, v77, v69
    v_mul_f32 v81, v77, v68
    v_fma_f32 v78, v74, v68, -v78
    v_fmac_f32 v79, v74, v69
    v_fma_f32 v80, v76, v68, -v80
    v_fmac_f32 v81, v76, v69
    v_cvt_pk_bf16_f32 v26, v74, -v75
    v_cvt_pk_bf16_f32 v27, v76, -v77
    ds_write_addtid_b32 v26 offset:27984
    ds_write_addtid_b32 v27 offset:28512
    v_cvt_pk_bf16_f32 v28, v78, -v79
    v_cvt_pk_bf16_f32 v29, v80, -v81
    ds_write_addtid_b32 v28 offset:29040
    ds_write_addtid_b32 v29 offset:29568
    s_branch L_kg_done_45
L_kg_42:
    v_lshlrev_b32 v24, 16, v46
    v_lshlrev_b32 v25, 16, v47
    v_mul_f32 v24, v24, v38
    v_mul_f32 v25, v25, v38
    v_mul_f32 v30, 0x3fb8aa3b, v24
    v_mul_f32 v31, 0x3e22f983, v25
    v_mul_f32 v32, 0x4338aa3b, v24
    v_mul_f32 v33, 0x41a2f983, v25
    v_fract_f32 v31, v31
    v_exp_f32 v30, v30
    v_fract_f32 v33, v33
    v_exp_f32 v32, v32
    v_cos_f32 v68, v31
    v_sin_f32 v69, v31
    v_cos_f32 v82, v33
    v_sin_f32 v83, v33
    v_mov_b32 v29, 0x3f80
    ds_write_addtid_b32 v29 offset:0
    v_mul_f32 v68, v68, v30
    v_mul_f32 v69, v69, v30
    v_mul_f32 v82, v82, v32
    v_mul_f32 v83, v83, v32
    v_mul_f32 v70, v69, v69
    v_mul_f32 v71, v69, v68
    v_mul_f32 v84, v83, v69
    v_mul_f32 v85, v83, v68
    v_fma_f32 v70, v68, v68, -v70
    v_fmac_f32 v71, v68, v69
    v_fma_f32 v84, v82, v68, -v84
    v_fmac_f32 v85, v82, v69
    v_cvt_pk_bf16_f32 v26, v68, v69
    v_cvt_pk_bf16_f32 v27, v82, v83
    ds_write_addtid_b32 v26 offset:528
    s_cmp_ge_u32 s61, 3
    s_cbranch_scc1 L_jp_51
    v_add_u32 v5, 0, v16
    s_mul_i32 s78, s61, 8448
    v_add_u32 v4, s78, v5
    ds_read_b128 v[92:95], v4 offset:0
    ds_read_b128 v[108:111], v5 offset:21648
    ds_read_b128 v[96:99], v4 offset:64
    ds_read_b128 v[112:115], v5 offset:21712
    ds_read_b128 v[100:103], v4 offset:128
    ds_read_b128 v[116:119], v5 offset:21776
    ds_read_b128 v[104:107], v4 offset:192
    ds_read_b128 v[120:123], v5 offset:21840
    s_lshr_b64 s[82:83], s[72:73], 0
    s_lshl_b32 s78, s82, 16
    s_cmp_eq_u32 s61, 0
    s_cselect_b32 s78, s78, 0
    v_mov_b32 v124, 0
    v_mov_b32 v125, 0
    v_mov_b32 v126, 0
    v_mov_b32 v127, 0
    v_writelane_b32 v124, s78, 0
L_jp_51:
    ds_write_addtid_b32 v27 offset:4224
    v_mul_f32 v72, v71, v69
    v_mul_f32 v73, v71, v68
    v_mul_f32 v74, v71, v71
    v_mul_f32 v75, v71, v70
    v_mul_f32 v86, v83, v71
    v_mul_f32 v87, v83, v70
    v_fma_f32 v72, v70, v68, -v72
    v_fmac_f32 v73, v70, v69
    v_fma_f32 v74, v70, v70, -v74
    v_fmac_f32 v75, v70, v71
    v_fma_f32 v86, v82, v70, -v86
    v_fmac_f32 v87, v82, v71
    v_cvt_pk_bf16_f32 v28, v70, v71
    v_cvt_pk_bf16_f32 v29, v84, v85
    ds_write_addtid_b32 v28 offset:1056
    ds_write_addtid_b32 v29 offset:4752
    v_mul_f32 v76, v75, v69
    v_mul_f32 v77, v75, v68
    v_mul_f32 v78, v75, v71
    v_mul_f32 v79, v75, v70
    v_mul_f32 v80, v75, v73
    v_mul_f32 v81, v75, v72
    v_mul_f32 v88, v83, v73
    v_mul_f32 v89, v83, v72
    v_mul_f32 v90, v83, v75
    v_mul_f32 v91, v83, v74
    v_fma_f32 v76, v74, v68, -v76
    v_fmac_f32 v77, v74, v69
    v_fma_f32 v78, v74, v70, -v78
    v_fmac_f32 v79, v74, v71
    v_fma_f32 v80, v74, v72, -v80
    v_fmac_f32 v81, v74, v73
    v_fma_f32 v88, v82, v72, -v88
    v_fmac_f32 v89, v82, v73
    v_fma_f32 v90, v82, v74, -v90
    v_fmac_f32 v91, v82, v75
    v_cvt_pk_bf16_f32 v26, v72, v73
    v_cvt_pk_bf16_f32 v27, v74, v75
    v_cvt_pk_bf16_f32 v28, v86, v87
    ds_write_addtid_b32 v26 offset:1584
    s_cmp_ge_u32 s61, 3
    s_cbranch_scc1 L_jp_52
    s_waitcnt lgkmcnt(0)
    v_mfma_f32_16x16x32_bf16 v[124:127], v[92:95], v[108:111], v[124:127]
    v_mfma_f32_16x16x32_bf16 v[124:127], v[96:99], v[112:115], v[124:127]
    v_mfma_f32_16x16x32_bf16 v[124:127], v[100:103], v[116:119], v[124:127]
    v_mfma_f32_16x16x32_bf16 v[124:127], v[104:107], v[120:123], v[124:127]
    ds_read_b128 v[92:95], v4 offset:256
    ds_read_b128 v[108:111], v5 offset:21904
    ds_read_b128 v[96:99], v4 offset:320
    ds_read_b128 v[112:115], v5 offset:21968
    ds_read_b128 v[100:103], v4 offset:384
    ds_read_b128 v[116:119], v5 offset:22032
    ds_read_b128 v[104:107], v4 offset:448
    ds_read_b128 v[120:123], v5 offset:22096
L_jp_52:
    ds_write_addtid_b32 v27 offset:2112
    ds_write_addtid_b32 v28 offset:5280
    v_mul_f32 v84, v83, v77
    v_mul_f32 v85, v83, v76
    v_mul_f32 v86, v83, v79
    v_mul_f32 v87, v83, v78
    v_fma_f32 v84, v82, v76, -v84
    v_fmac_f32 v85, v82, v77
    v_fma_f32 v86, v82, v78, -v86
    v_fmac_f32 v87, v82, v79
    v_cvt_pk_bf16_f32 v29, v88, v89
    v_cvt_pk_bf16_f32 v26, v90, v91
    v_cvt_pk_bf16_f32 v27, v76, v77
    ds_write_addtid_b32 v29 offset:5808
    ds_write_addtid_b32 v26 offset:6336
    ds_write_addtid_b32 v27 offset:2640
    s_cmp_ge_u32 s61, 3
    s_cbranch_scc1 L_jp_53
    s_waitcnt lgkmcnt(0)
    v_mfma_f32_16x16x32_bf16 v[124:127], v[92:95], v[108:111], v[124:127]
    v_mfma_f32_16x16x32_bf16 v[124:127], v[96:99], v[112:115], v[124:127]
    v_mfma_f32_16x16x32_bf16 v[124:127], v[100:103], v[116:119], v[124:127]
    v_mfma_f32_16x16x32_bf16 v[124:127], v[104:107], v[120:123], v[124:127]
    s_cmp_eq_u32 s61, 0
    s_cselect_b64 s[84:85], -1, 0
    v_add_u32 v6, 4, v17
    v_cndmask_b32_e64 v7, v19, v6, s[84:85]
    v_cndmask_b32_e64 v6, v18, v17, s[84:85]
    s_nop 2
    v_cvt_pk_bf16_f32 v124, v124, v125
    v_cvt_pk_bf16_f32 v126, v126, v127
    s_cmp_eq_u32 s61, 2
    s_cbranch_scc1 L_jp_54
    ds_write_b32 v6, v124 offset:0
    ds_write_b32 v7, v126 offset:0
    s_branch L_jp_53
L_jp_54:
    ds_write_b16 v20, v124 offset:0
    ds_write_b16_d16_hi v20, v124 offset:32
    ds_write_b16 v20, v126 offset:64
    ds_write_b16_d16_hi v20, v126 offset:96
L_jp_53:
    v_mul_f32 v88, v83, v81
    v_mul_f32 v89, v83, v80
    v_fma_f32 v88, v82, v80, -v88
    v_fmac_f32 v89, v82, v81
    v_cvt_pk_bf16_f32 v28, v78, v79
    v_cvt_pk_bf16_f32 v29, v80, v81
    v_cvt_pk_bf16_f32 v26, v84, v85
    ds_write_addtid_b32 v28 offset:3168
    ds_write_addtid_b32 v29 offset:3696
    ds_write_addtid_b32 v26 offset:6864
    v_cvt_pk_bf16_f32 v27, v86, v87
    v_cvt_pk_bf16_f32 v28, v88, v89
    ds_write_addtid_b32 v27 offset:7392
    ds_write_addtid_b32 v28 offset:7920
    s_branch L_kg_done_45
L_kg_43:
    v_lshlrev_b32 v24, 16, v46
    v_lshlrev_b32 v25, 16, v47
    v_mul_f32 v24, v24, v38
    v_mul_f32 v25, v25, v38
    v_mul_f32 v30, 0x4038aa3b, v24
    v_mul_f32 v31, 0x3ea2f983, v25
    v_mul_f32 v32, 0x4338aa3b, v24
    v_mul_f32 v33, 0x41a2f983, v25
    v_fract_f32 v31, v31
    v_exp_f32 v30, v30
    v_fract_f32 v33, v33
    v_exp_f32 v32, v32
    v_cos_f32 v66, v31
    v_sin_f32 v67, v31
    v_cos_f32 v72, v33
    v_sin_f32 v73, v33
    s_nop 0
    v_mul_f32 v66, v66, v30
    v_mul_f32 v67, v67, v30
    v_mul_f32 v72, v72, v32
    v_mul_f32 v73, v73, v32
    v_mul_f32 v68, v67, v67
    v_mul_f32 v69, v67, v66
    v_mul_f32 v74, v73, v73
    v_mul_f32 v75, v73, v72
    v_fma_f32 v68, v66, v66, -v68
    v_fmac_f32 v69, v66, v67
    v_fma_f32 v74, v72, v72, -v74
    v_fmac_f32 v75, v72, v73
    v_mul_f32 v70, v69, v67
    v_mul_f32 v71, v69, v66
    v_mul_f32 v76, v75, v73
    v_mul_f32 v77, v75, v72
    v_mul_f32 v78, v75, v75
    v_mul_f32 v79, v75, v74
    v_mul_f32 v82, v75, v67
    v_mul_f32 v83, v75, v66
    v_mul_f32 v84, v75, v69
    v_mul_f32 v85, v75, v68
    v_fma_f32 v70, v68, v66, -v70
    v_fmac_f32 v71, v68, v67
    v_fma_f32 v76, v74, v72, -v76
    v_fmac_f32 v77, v74, v73
    v_fma_f32 v78, v74, v74, -v78
    v_fmac_f32 v79, v74, v75
    v_fma_f32 v82, v74, v66, -v82
    v_fmac_f32 v83, v74, v67
    v_fma_f32 v84, v74, v68, -v84
    v_fmac_f32 v85, v74, v69
    v_cvt_pk_bf16_f32 v29, v74, v75
    ds_write_addtid_b32 v29 offset:8448
    s_cmp_ge_u32 s61, 3
    s_cbranch_scc1 L_jp_56
    v_add_u32 v5, 0, v16
    s_mul_i32 s78, s61, 8448
    v_add_u32 v4, s78, v5
    ds_read_b128 v[92:95], v4 offset:0
    ds_read_b128 v[108:111], v5 offset:21648
    ds_read_b128 v[96:99], v4 offset:64
    ds_read_b128 v[112:115], v5 offset:21712
    ds_read_b128 v[100:103], v4 offset:128
    ds_read_b128 v[116:119], v5 offset:21776
    ds_read_b128 v[104:107], v4 offset:192
    ds_read_b128 v[120:123], v5 offset:21840
    s_lshr_b64 s[82:83], s[72:73], 0
    s_lshl_b32 s78, s82, 16
    s_cmp_eq_u32 s61, 0
    s_cselect_b32 s78, s78, 0
    v_mov_b32 v124, 0
    v_mov_b32 v125, 0
    v_mov_b32 v126, 0
    v_mov_b32 v127, 0
    v_writelane_b32 v124, s78, 0
L_jp_56:
    v_mul_f32 v86, v75, v71
    v_mul_f32 v87, v75, v70
    v_mul_f32 v88, v77, v67
    v_mul_f32 v89, v77, v66
    v_mul_f32 v80, v79, v73
    v_mul_f32 v81, v79, v72
    v_fma_f32 v86, v74, v70, -v86
    v_fmac_f32 v87, v74, v71
    v_fma_f32 v88, v76, v66, -v88
    v_fmac_f32 v89, v76, v67
    v_fma_f32 v80, v78, v72, -v80
    v_fmac_f32 v81, v78, v73
    v_cvt_pk_bf16_f32 v26, v82, v83
    v_cvt_pk_bf16_f32 v27, v84, v85
    v_cvt_pk_bf16_f32 v28, v76, v77
    v_cvt_pk_bf16_f32 v29, v78, v79
    ds_write_addtid_b32 v26 offset:8976
    ds_write_addtid_b32 v27 offset:9504
    ds_write_addtid_b32 v28 offset:10560
    ds_write_addtid_b32 v29 offset:12672
    s_cmp_ge_u32 s61, 3
    s_cbranch_scc1 L_jp_57
    s_waitcnt lgkmcnt(0)
    v_mfma_f32_16x16x32_bf16 v[124:127], v[92:95], v[108:111], v[124:127]
    v_mfma_f32_16x16x32_bf16 v[124:127], v[96:99], v[112:115], v[124:127]
    v_mfma_f32_16x16x32_bf16 v[124:127], v[100:103], v[116:119], v[124:127]
    v_mfma_f32_16x16x32_bf16 v[124:127], v[104:107], v[120:123], v[124:127]
    ds_read_b128 v[92:95], v4 offset:256
    ds_read_b128 v[108:111], v5 offset:21904
    ds_read_b128 v[96:99], v4 offset:320
    ds_read_b128 v[112:115], v5 offset:21968
    ds_read_b128 v[100:103], v4 offset:384
    ds_read_b128 v[116:119], v5 offset:22032
    ds_read_b128 v[104:107], v4 offset:448
    ds_read_b128 v[120:123], v5 offset:22096
L_jp_57:
    v_mul_f32 v82, v77, v69
    v_mul_f32 v83, v77, v68
    v_mul_f32 v84, v77, v71
    v_mul_f32 v85, v77, v70
    v_mul_f32 v66, v79, v69
    v_mul_f32 v67, v79, v68
    v_mul_f32 v72, v81, v69
    v_mul_f32 v73, v81, v68
    v_fma_f32 v82, v76, v68, -v82
    v_fmac_f32 v83, v76, v69
    v_fma_f32 v84, v76, v70, -v84
    v_fmac_f32 v85, v76, v71
    v_fma_f32 v66, v78, v68, -v66
    v_fmac_f32 v67, v78, v69
    v_fma_f32 v72, v80, v68, -v72
    v_fmac_f32 v73, v80, v69
    v_cvt_pk_bf16_f32 v26, v86, v87
    v_cvt_pk_bf16_f32 v27, v88, v89
    v_cvt_pk_bf16_f32 v28, v80, v81
    ds_write_addtid_b32 v26 offset:10032
    ds_write_addtid_b32 v27 offset:11088
    ds_write_addtid_b32 v28 offset:13728
    v_cvt_pk_bf16_f32 v29, v82, v83
    v_cvt_pk_bf16_f32 v26, v84, v85
    v_cvt_pk_bf16_f32 v27, v66, v67
    v_cvt_pk_bf16_f32 v28, v72, v73
    ds_write_addtid_b32 v29 offset:11616
    ds_write_addtid_b32 v26 offset:12144
    s_cmp_ge_u32 s61, 3
    s_cbranch_scc1 L_jp_58
    s_waitcnt lgkmcnt(0)
    v_mfma_f32_16x16x32_bf16 v[124:127], v[92:95], v[108:111], v[124:127]
    v_mfma_f32_16x16x32_bf16 v[124:127], v[96:99], v[112:115], v[124:127]
    v_mfma_f32_16x16x32_bf16 v[124:127], v[100:103], v[116:119], v[124:127]
    v_mfma_f32_16x16x32_bf16 v[124:127], v[104:107], v[120:123], v[124:127]
    s_cmp_eq_u32 s61, 0
    s_cselect_b64 s[84:85], -1, 0
    v_add_u32 v6, 4, v17
    v_cndmask_b32_e64 v7, v19, v6, s[84:85]
    v_cndmask_b32_e64 v6, v18, v17, s[84:85]
    s_nop 2
    v_cvt_pk_bf16_f32 v124, v124, v125
    v_cvt_pk_bf16_f32 v126, v126, v127
    s_cmp_eq_u32 s61, 2
    s_cbranch_scc1 L_jp_59
    ds_write_b32 v6, v124 offset:0
    ds_write_b32 v7, v126 offset:0
    s_branch L_jp_58
L_jp_59:
    ds_write_b16 v20, v124 offset:0
    ds_write_b16_d16_hi v20, v124 offset:32
    ds_write_b16 v20, v126 offset:64
    ds_write_b16_d16_hi v20, v126 offset:96
L_jp_58:
    ds_write_addtid_b32 v27 offset:13200
    ds_write_addtid_b32 v28 offset:14256
    s_branch L_kg_done_45
L_kg_44:
    v_lshlrev_b32 v24, 16, v46
    v_lshlrev_b32 v25, 16, v47
    v_mul_f32 v24, v24, v38
    v_mul_f32 v25, v25, v38
    v_mul_f32 v30, 0x40b8aa3b, v24
    v_mul_f32 v31, 0x3f22f983, v25
    v_mul_f32 v32, 0x4338aa3b, v24
    v_mul_f32 v33, 0x41a2f983, v25
    v_mul_f32 v34, 0x44b8aa3b, v24
    v_mul_f32 v35, 0x4322f983, v25
    v_fract_f32 v31, v31
    v_exp_f32 v30, v30
    v_fract_f32 v33, v33
    v_exp_f32 v32, v32
    v_fract_f32 v35, v35
    v_exp_f32 v34, v34
    v_cos_f32 v66, v31
    v_sin_f32 v67, v31
    v_cos_f32 v68, v33
    v_sin_f32 v69, v33
    v_cos_f32 v72, v35
    v_sin_f32 v73, v35
    v_mul_f32 v66, v66, v30
    v_mul_f32 v67, v67, v30
    v_mul_f32 v68, v68, v32
    v_mul_f32 v69, v69, v32
    v_mul_f32 v72, v72, v34
    v_mul_f32 v73, v73, v34
    v_mul_f32 v70, v69, v69
    v_mul_f32 v71, v69, v68
    v_mul_f32 v74, v73, v69
    v_mul_f32 v75, v73, v68
    v_mul_f32 v78, v73, v73
    v_mul_f32 v79, v73, v72
    v_fma_f32 v70, v68, v68, -v70
    v_fmac_f32 v71, v68, v69
    v_fma_f32 v74, v72, v68, -v74
    v_fmac_f32 v75, v72, v69
    v_fma_f32 v78, v72, v72, -v78
    v_fmac_f32 v79, v72, v73
    v_cvt_pk_bf16_f32 v29, v72, v73
    ds_write_addtid_b32 v29 offset:16896
    s_cmp_ge_u32 s61, 3
    s_cbranch_scc1 L_jp_61
    v_add_u32 v5, 0, v16
    s_mul_i32 s78, s61, 8448
    v_add_u32 v4, s78, v5
    ds_read_b128 v[92:95], v4 offset:0
    ds_read_b128 v[108:111], v5 offset:21648
    ds_read_b128 v[96:99], v4 offset:64
    ds_read_b128 v[112:115], v5 offset:21712
    ds_read_b128 v[100:103], v4 offset:128
    ds_read_b128 v[116:119], v5 offset:21776
    ds_read_b128 v[104:107], v4 offset:192
    ds_read_b128 v[120:123], v5 offset:21840
    s_lshr_b64 s[82:83], s[72:73], 0
    s_lshl_b32 s78, s82, 16
    s_cmp_eq_u32 s61, 0
    s_cselect_b32 s78, s78, 0
    v_mov_b32 v124, 0
    v_mov_b32 v125, 0
    v_mov_b32 v126, 0
    v_mov_b32 v127, 0
    v_writelane_b32 v124, s78, 0
L_jp_61:
    v_mul_f32 v76, v73, v71
    v_mul_f32 v77, v73, v70
    v_mul_f32 v80, v75, v71
    v_mul_f32 v81, v75, v70
    v_mul_f32 v82, v71, v71
    v_mul_f32 v83, v71, v70
    v_fma_f32 v76, v72, v70, -v76
    v_fmac_f32 v77, v72, v71
    v_fma_f32 v80, v74, v70, -v80
    v_fmac_f32 v81, v74, v71
    v_fma_f32 v82, v70, v70, -v82
    v_fmac_f32 v83, v70, v71
    v_cvt_pk_bf16_f32 v26, v74, v75
    v_cvt_pk_bf16_f32 v27, v78, v79
    ds_write_addtid_b32 v26 offset:17424
    ds_write_addtid_b32 v27 offset:21120
    v_mul_f32 v84, v83, v71
    v_mul_f32 v85, v83, v70
    v_mul_f32 v78, v77, v71
    v_mul_f32 v79, v77, v70
    v_mul_f32 v74, v81, v71
    v_mul_f32 v75, v81, v70
    v_fma_f32 v84, v82, v70, -v84
    v_fmac_f32 v85, v82, v71
    v_fma_f32 v78, v76, v70, -v78
    v_fmac_f32 v79, v76, v71
    v_fma_f32 v74, v80, v70, -v74
    v_fmac_f32 v75, v80, v71
    v_cvt_pk_bf16_f32 v28, v76, v77
    v_cvt_pk_bf16_f32 v29, v80, v81
    ds_write_addtid_b32 v28 offset:17952
    ds_write_addtid_b32 v29 offset:18480
    s_cmp_ge_u32 s61, 3
    s_cbranch_scc1 L_jp_62
    s_waitcnt lgkmcnt(0)
    v_mfma_f32_16x16x32_bf16 v[124:127], v[92:95], v[108:111], v[124:127]
    v_mfma_f32_16x16x32_bf16 v[124:127], v[96:99], v[112:115], v[124:127]
    v_mfma_f32_16x16x32_bf16 v[124:127], v[100:103], v[116:119], v[124:127]
    v_mfma_f32_16x16x32_bf16 v[124:127], v[104:107], v[120:123], v[124:127]
    ds_read_b128 v[92:95], v4 offset:256
    ds_read_b128 v[108:111], v5 offset:21904
    ds_read_b128 v[96:99], v4 offset:320
    ds_read_b128 v[112:115], v5 offset:21968
    ds_read_b128 v[100:103], v4 offset:384
    ds_read_b128 v[116:119], v5 offset:22032
    ds_read_b128 v[104:107], v4 offset:448
    ds_read_b128 v[120:123], v5 offset:22096
L_jp_62:
    v_mul_f32 v86, v85, v69
    v_mul_f32 v87, v85, v68
    v_mul_f32 v82, v85, v67
    v_mul_f32 v83, v85, v66
    v_mul_f32 v76, v79, v71
    v_mul_f32 v77, v79, v70
    v_mul_f32 v80, v75, v71
    v_mul_f32 v81, v75, v70
    v_fma_f32 v86, v84, v68, -v86
    v_fmac_f32 v87, v84, v69
    v_fma_f32 v82, v84, v66, -v82
    v_fmac_f32 v83, v84, v67
    v_fma_f32 v76, v78, v70, -v76
    v_fmac_f32 v77, v78, v71
    v_fma_f32 v80, v74, v70, -v80
    v_fmac_f32 v81, v74, v71
    v_cvt_pk_bf16_f32 v26, v78, v79
    v_cvt_pk_bf16_f32 v27, v74, v75
    v_cvt_pk_bf16_f32 v28, v84, v85
    ds_write_addtid_b32 v26 offset:19008
    ds_write_addtid_b32 v27 offset:19536
    ds_write_addtid_b32 v28 offset:14784
    v_mul_f32 v78, v87, v67
    v_mul_f32 v79, v87, v66
    v_fma_f32 v78, v86, v66, -v78
    v_fmac_f32 v79, v86, v67
    v_cvt_pk_bf16_f32 v29, v82, v83
    v_cvt_pk_bf16_f32 v26, v76, v77
    v_cvt_pk_bf16_f32 v27, v80, v81
    v_cvt_pk_bf16_f32 v28, v86, v87
    ds_write_addtid_b32 v29 offset:15312
    ds_write_addtid_b32 v26 offset:20064
    s_cmp_ge_u32 s61, 3
    s_cbranch_scc1 L_jp_63
    s_waitcnt lgkmcnt(0)
    v_mfma_f32_16x16x32_bf16 v[124:127], v[92:95], v[108:111], v[124:127]
    v_mfma_f32_16x16x32_bf16 v[124:127], v[96:99], v[112:115], v[124:127]
    v_mfma_f32_16x16x32_bf16 v[124:127], v[100:103], v[116:119], v[124:127]
    v_mfma_f32_16x16x32_bf16 v[124:127], v[104:107], v[120:123], v[124:127]
    s_cmp_eq_u32 s61, 0
    s_cselect_b64 s[84:85], -1, 0
    v_add_u32 v6, 4, v17
    v_cndmask_b32_e64 v7, v19, v6, s[84:85]
    v_cndmask_b32_e64 v6, v18, v17, s[84:85]
    s_nop 2
    v_cvt_pk_bf16_f32 v124, v124, v125
    v_cvt_pk_bf16_f32 v126, v126, v127
    s_cmp_eq_u32 s61, 2
    s_cbranch_scc1 L_jp_64
    ds_write_b32 v6, v124 offset:0
    ds_write_b32 v7, v126 offset:0
    s_branch L_jp_63
L_jp_64:
    ds_write_b16 v20, v124 offset:0
    ds_write_b16_d16_hi v20, v124 offset:32
    ds_write_b16 v20, v126 offset:64
    ds_write_b16_d16_hi v20, v126 offset:96
L_jp_63:
    ds_write_addtid_b32 v27 offset:20592
    ds_write_addtid_b32 v28 offset:15840
    v_cvt_pk_bf16_f32 v29, v78, v79
    ds_write_addtid_b32 v29 offset:16368
L_kg_done_45:
    s_mov_b32 s58, L_tabend-concat_heads__spectral_gfnet__ssm_conv_s4__prompt_kernel-4
    v_lshlrev_b32 v8, 4, v0
    v_and_b32 v8, 0xfff, v8
    s_mov_b32 s78, L_table-concat_heads__spectral_gfnet__ssm_conv_s4__prompt_kernel-4+8192
    buffer_load_dwordx4 v[40:43], v8, s[56:59], s78 offen
    s_mov_b32 s78, L_table-concat_heads__spectral_gfnet__ssm_conv_s4__prompt_kernel-4+12288
    buffer_load_dwordx4 v[44:47], v8, s[56:59], s78 offen
    s_mov_b32 s78, L_table-concat_heads__spectral_gfnet__ssm_conv_s4__prompt_kernel-4+16384
    buffer_load_dwordx4 v[48:51], v8, s[56:59], s78 offen
    s_waitcnt lgkmcnt(0)
    s_barrier
    s_cmp_eq_u32 s63, 3
    s_cbranch_scc1 L_b3_67
    s_cmp_ge_u32 s61, 3
    s_cbranch_scc1 L_jp_68
    v_add_u32 v5, 30096, v16
    s_mul_i32 s78, s61, 8448
    v_add_u32 v4, s78, v5
    ds_read_b128 v[92:95], v4 offset:0
    ds_read_b128 v[108:111], v5 offset:21648
    ds_read_b128 v[96:99], v4 offset:64
    ds_read_b128 v[112:115], v5 offset:21712
    ds_read_b128 v[100:103], v4 offset:128
    ds_read_b128 v[116:119], v5 offset:21776
    ds_read_b128 v[104:107], v4 offset:192
    ds_read_b128 v[120:123], v5 offset:21840
    s_lshr_b64 s[82:83], s[72:73], 16
    s_lshl_b32 s78, s82, 16
    s_cmp_eq_u32 s61, 0
    s_cselect_b32 s78, s78, 0
    v_mov_b32 v124, 0
    v_mov_b32 v125, 0
    v_mov_b32 v126, 0
    v_mov_b32 v127, 0
    v_writelane_b32 v124, s78, 0
L_jp_68:
    s_cmp_ge_u32 s61, 3
    s_cbranch_scc1 L_jp_69
    s_waitcnt lgkmcnt(0)
    v_mfma_f32_16x16x32_bf16 v[124:127], v[92:95], v[108:111], v[124:127]
    v_mfma_f32_16x16x32_bf16 v[124:127], v[96:99], v[112:115], v[124:127]
    v_mfma_f32_16x16x32_bf16 v[124:127], v[100:103], v[116:119], v[124:127]
    v_mfma_f32_16x16x32_bf16 v[124:127], v[104:107], v[120:123], v[124:127]
    ds_read_b128 v[92:95], v4 offset:256
    ds_read_b128 v[108:111], v5 offset:21904
    ds_read_b128 v[96:99], v4 offset:320
    ds_read_b128 v[112:115], v5 offset:21968
    ds_read_b128 v[100:103], v4 offset:384
    ds_read_b128 v[116:119], v5 offset:22032
    ds_read_b128 v[104:107], v4 offset:448
    ds_read_b128 v[120:123], v5 offset:22096
L_jp_69:
    s_cmp_ge_u32 s61, 3
    s_cbranch_scc1 L_jp_70
    s_waitcnt lgkmcnt(0)
    v_mfma_f32_16x16x32_bf16 v[124:127], v[92:95], v[108:111], v[124:127]
    v_mfma_f32_16x16x32_bf16 v[124:127], v[96:99], v[112:115], v[124:127]
    v_mfma_f32_16x16x32_bf16 v[124:127], v[100:103], v[116:119], v[124:127]
    v_mfma_f32_16x16x32_bf16 v[124:127], v[104:107], v[120:123], v[124:127]
    s_cmp_eq_u32 s61, 0
    s_cselect_b64 s[84:85], -1, 0
    v_add_u32 v6, 4, v17
    v_cndmask_b32_e64 v7, v19, v6, s[84:85]
    v_cndmask_b32_e64 v6, v18, v17, s[84:85]
    s_nop 2
    v_cvt_pk_bf16_f32 v124, v124, v125
    v_cvt_pk_bf16_f32 v126, v126, v127
    s_cmp_eq_u32 s61, 2
    s_cbranch_scc1 L_jp_71
    ds_write_b32 v6, v124 offset:1552
    ds_write_b32 v7, v126 offset:1552
    s_branch L_jp_70
L_jp_71:
    ds_write_b16 v20, v124 offset:1552
    ds_write_b16_d16_hi v20, v124 offset:1584
    ds_write_b16 v20, v126 offset:1616
    ds_write_b16_d16_hi v20, v126 offset:1648
L_jp_70:
    s_waitcnt vmcnt(0)
    s_cmp_ge_u32 s61, 6
    s_cbranch_scc1 L_uti_73
    v_lshlrev_b32 v9, 4, v0
    s_mul_i32 s88, s62, 5504
    s_add_u32 s88, s88, 9437184
    s_add_u32 s89, s88, 5504
    s_add_u32 s90, s89, 5504
    s_cmp_eq_u32 s61, 5
    s_cselect_b32 exec_lo, 0xffffff, -1
    s_cselect_b32 exec_hi, 0, -1
    buffer_load_dwordx4 v[116:119], v9, s[52:55], s88 offen sc0 sc1
    buffer_load_dwordx4 v[120:123], v9, s[52:55], s89 offen sc0 sc1
    s_mov_b64 exec, -1
L_uti_73:
    s_waitcnt lgkmcnt(0)
    s_barrier
    s_cmp_ge_u32 s61, 4
    s_cbranch_scc1 L_e1_74
    ds_read_u16 v75, v40 offset:0
    ds_read_u16 v76, v41 offset:0
    ds_read_u16 v77, v42 offset:0
    ds_read_u16 v78, v43 offset:0
    ds_read_u16 v79, v44 offset:0
    ds_read_u16 v80, v45 offset:0
    ds_read_u16 v81, v46 offset:0
    ds_read_u16 v82, v47 offset:0
    ds_read_u16 v83, v48 offset:0
    ds_read_u16 v84, v49 offset:0
    ds_read_u16 v85, v50 offset:0
    s_waitcnt lgkmcnt(9)
    v_lshl_or_b32 v70, v76, 16, v75
    s_waitcnt lgkmcnt(7)
    v_lshl_or_b32 v71, v78, 16, v77
    s_waitcnt lgkmcnt(5)
    v_lshl_or_b32 v72, v80, 16, v79
    s_waitcnt lgkmcnt(3)
    v_lshl_or_b32 v73, v82, 16, v81
    ds_write_b128 v51, v[70:73] offset:43056
    v_lshl_or_b32 v66, v77, 16, v76
    v_lshl_or_b32 v67, v79, 16, v78
    v_lshl_or_b32 v68, v81, 16, v80
    s_waitcnt lgkmcnt(3)
    v_lshl_or_b32 v69, v83, 16, v82
    ds_write_b128 v51, v[66:69] offset:38896
    v_mov_b32 v62, v71
    v_mov_b32 v63, v72
    v_mov_b32 v64, v73
    s_waitcnt lgkmcnt(3)
    v_lshl_or_b32 v65, v84, 16, v83
    ds_write_b128 v51, v[62:65] offset:34736
    v_mov_b32 v58, v67
    v_mov_b32 v59, v68
    v_mov_b32 v60, v69
    s_waitcnt lgkmcnt(3)
    v_lshl_or_b32 v61, v85, 16, v84
    ds_write_b128 v51, v[58:61] offset:30576
    s_branch L_ex_75
L_e1_74:
    ds_read_u16 v75, v40 offset:1552
    ds_read_u16 v76, v41 offset:1552
    ds_read_u16 v77, v42 offset:1552
    ds_read_u16 v78, v43 offset:1552
    ds_read_u16 v79, v44 offset:1552
    ds_read_u16 v80, v45 offset:1552
    ds_read_u16 v81, v46 offset:1552
    ds_read_u16 v82, v47 offset:1552
    ds_read_u16 v83, v48 offset:1552
    ds_read_u16 v84, v49 offset:1552
    ds_read_u16 v85, v50 offset:1552
    s_waitcnt lgkmcnt(9)
    v_lshl_or_b32 v70, v76, 16, v75
    s_waitcnt lgkmcnt(7)
    v_lshl_or_b32 v71, v78, 16, v77
    s_waitcnt lgkmcnt(5)
    v_lshl_or_b32 v72, v80, 16, v79
    s_waitcnt lgkmcnt(3)
    v_lshl_or_b32 v73, v82, 16, v81
    ds_write_b128 v51, v[70:73] offset:59696
    v_lshl_or_b32 v66, v77, 16, v76
    v_lshl_or_b32 v67, v79, 16, v78
    v_lshl_or_b32 v68, v81, 16, v80
    s_waitcnt lgkmcnt(3)
    v_lshl_or_b32 v69, v83, 16, v82
    ds_write_b128 v51, v[66:69] offset:55536
    v_mov_b32 v62, v71
    v_mov_b32 v63, v72
    v_mov_b32 v64, v73
    s_waitcnt lgkmcnt(3)
    v_lshl_or_b32 v65, v84, 16, v83
    ds_write_b128 v51, v[62:65] offset:51376
    v_mov_b32 v58, v67
    v_mov_b32 v59, v68
    v_mov_b32 v60, v69
    s_waitcnt lgkmcnt(3)
    v_lshl_or_b32 v61, v85, 16, v84
    ds_write_b128 v51, v[58:61] offset:47216
L_ex_75:
    s_cmp_lg_u32 s61, 7
    s_cbranch_scc1 L_zf_76
    v_mov_b32 v110, 0
    v_mov_b32 v111, 0
    v_mov_b32 v112, 0
    v_mov_b32 v113, 0
    v_mul_u32_u24 v4, 4160, v1
    v_lshlrev_b32 v5, 4, v1
    s_mov_b32 exec_lo, 0xff
    s_mov_b32 exec_hi, 0x0
    ds_write_b128 v4, v[110:113] offset:34672
    ds_write_b64 v4, v[110:111] offset:34688
    s_mov_b32 exec_lo, 0xffffffff
    s_mov_b32 exec_hi, 0x0
    ds_write_b128 v5, v[110:113] offset:16640
    ds_write_b128 v5, v[110:113] offset:21280
    s_mov_b64 exec, -1
L_zf_76:
    s_cmp_ge_u32 s61, 6
    s_cbranch_scc1 L_utd_77
    s_cmp_eq_u32 s61, 5
    s_cselect_b32 exec_lo, 0xffffff, -1
    s_cselect_b32 exec_hi, 0, -1
    s_mov_b32 s79, 0
L_poll_78:
    s_waitcnt vmcnt(0)
    v_cmp_ne_u32 vcc, s60, v119
    v_cmp_ne_u32 s[82:83], s60, v123
    s_nop 0
    s_or_b64 vcc, vcc, s[82:83]
    s_and_b64 exec, exec, vcc
    s_cbranch_execz L_polld_79
    s_add_u32 s79, s79, 1
    s_cmp_gt_u32 s79, 200000
    s_cbranch_scc1 L_polld_79
    s_sleep 4
    buffer_load_dwordx4 v[116:119], v9, s[52:55], s88 offen sc0 sc1
    buffer_load_dwordx4 v[120:123], v9, s[52:55], s89 offen sc0 sc1
    s_branch L_poll_78
L_polld_79:
    s_cmp_eq_u32 s61, 5
    s_cselect_b32 exec_lo, 0xffffff, -1
    s_cselect_b32 exec_hi, 0, -1
    v_add_u32 v6, 17152, v36
    ds_write2_b32 v6, v116, v117 offset0:0 offset1:1
    ds_write_b32 v6, v118 offset:8
    v_add_u32 v6, 4640, v6
    ds_write2_b32 v6, v120, v121 offset0:0 offset1:1
    ds_write_b32 v6, v122 offset:8
    s_mov_b64 exec, -1
L_utd_77:
    s_waitcnt lgkmcnt(0)
    s_barrier
    s_setprio 1
    s_cmp_ge_u32 s61, 4
    s_cbranch_scc1 L_c2d_81
    s_lshr_b32 s74, s61, 1
    s_mul_i32 s75, s74, 16640
    s_add_u32 s75, s75, 30576
    s_cmp_eq_u32 s74, 2
    s_cselect_b32 s75, 0, s75
    s_mul_i32 s76, s74, 4640
    s_mul_i32 s77, s74, 4128
    v_add_u32 v124, s75, v21
    v_add_u32 v125, s76, v22
    v_add_u32 v126, s77, v23
    s_bitcmp1_b32 s61, 0
    s_cbranch_scc1 L_c2h1_80
    ds_read_b64 v[60:61], v124 offset:4032
    ds_read_b64 v[62:63], v124 offset:4040
    ds_read_b128 v[120:123], v125 offset:4032
    ds_read_b128 v[116:119], v125 offset:3520
    ds_read_b128 v[100:103], v125 offset:1472
    ds_read_b64 v[64:65], v124 offset:3520
    ds_read_b64 v[66:67], v124 offset:3528
    ds_read_b128 v[112:115], v125 offset:3008
    ds_read_b128 v[96:99], v125 offset:960
    ds_read_b64 v[68:69], v124 offset:3008
    ds_read_b64 v[70:71], v124 offset:3016
    ds_read_b128 v[108:111], v125 offset:2496
    ds_read_b128 v[92:95], v125 offset:448
    ds_read_b64 v[72:73], v124 offset:2496
    ds_read_b64 v[74:75], v124 offset:2504
    ds_read_b128 v[104:107], v125 offset:1984
    ds_read_b64 v[76:77], v124 offset:1984
    ds_read_b64 v[78:79], v124 offset:1992
    ds_read_b64 v[80:81], v124 offset:1472
    ds_read_b64 v[82:83], v124 offset:1480
    ds_read_b64 v[84:85], v124 offset:960
    ds_read_b64 v[86:87], v124 offset:968
    ds_read_b64 v[88:89], v124 offset:448
    ds_read_b64 v[90:91], v124 offset:456
    s_waitcnt lgkmcnt(15)
    v_mfma_f32_16x16x32_bf16 v[48:51], v[60:63], v[120:123], 0
    ds_read_b128 v[120:123], v125 offset:3968
    v_mfma_f32_16x16x32_bf16 v[44:47], v[60:63], v[116:119], 0
    v_mfma_f32_16x16x32_bf16 v[40:43], v[60:63], v[100:103], 0
    ds_read_b64 v[60:61], v124 offset:3968
    v_mfma_f32_16x16x32_bf16 v[48:51], v[64:67], v[116:119], v[48:51]
    ds_read_b64 v[62:63], v124 offset:3976
    v_mfma_f32_16x16x32_bf16 v[44:47], v[64:67], v[112:115], v[44:47]
    ds_read_b128 v[116:119], v125 offset:3456
    v_mfma_f32_16x16x32_bf16 v[40:43], v[64:67], v[96:99], v[40:43]
    ds_read_b64 v[64:65], v124 offset:3456
    s_waitcnt lgkmcnt(15)
    v_mfma_f32_16x16x32_bf16 v[48:51], v[68:71], v[112:115], v[48:51]
    ds_read_b64 v[66:67], v124 offset:3464
    v_mfma_f32_16x16x32_bf16 v[44:47], v[68:71], v[108:111], v[44:47]
    ds_read_b128 v[112:115], v125 offset:2944
    v_mfma_f32_16x16x32_bf16 v[40:43], v[68:71], v[92:95], v[40:43]
    ds_read_b64 v[68:69], v124 offset:2944
    s_waitcnt lgkmcnt(15)
    v_mfma_f32_16x16x32_bf16 v[48:51], v[72:75], v[108:111], v[48:51]
    ds_read_b64 v[70:71], v124 offset:2952
    v_mfma_f32_16x16x32_bf16 v[44:47], v[72:75], v[104:107], v[44:47]
    ds_read_b128 v[108:111], v125 offset:2432
    s_waitcnt lgkmcnt(15)
    v_mfma_f32_16x16x32_bf16 v[48:51], v[76:79], v[104:107], v[48:51]
    ds_read_b64 v[72:73], v124 offset:2432
    v_mfma_f32_16x16x32_bf16 v[44:47], v[76:79], v[100:103], v[44:47]
    ds_read_b64 v[74:75], v124 offset:2440
    s_waitcnt lgkmcnt(15)
    v_mfma_f32_16x16x32_bf16 v[48:51], v[80:83], v[100:103], v[48:51]
    ds_read_b128 v[100:103], v125 offset:1408
    v_mfma_f32_16x16x32_bf16 v[44:47], v[80:83], v[96:99], v[44:47]
    ds_read_b128 v[104:107], v125 offset:1920
    s_waitcnt lgkmcnt(15)
    v_mfma_f32_16x16x32_bf16 v[48:51], v[84:87], v[96:99], v[48:51]
    ds_read_b128 v[96:99], v125 offset:896
    v_mfma_f32_16x16x32_bf16 v[44:47], v[84:87], v[92:95], v[44:47]
    ds_read_b64 v[76:77], v124 offset:1920
    s_waitcnt lgkmcnt(15)
    v_mfma_f32_16x16x32_bf16 v[48:51], v[88:91], v[92:95], v[48:51]
    ds_read_b128 v[92:95], v125 offset:384
    s_waitcnt lgkmcnt(14)
    v_mfma_f32_16x16x32_bf16 v[48:51], v[60:63], v[120:123], v[48:51]
    ds_read_b64 v[78:79], v124 offset:1928
    s_waitcnt lgkmcnt(14)
    v_mfma_f32_16x16x32_bf16 v[44:47], v[60:63], v[116:119], v[44:47]
    ds_read_b64 v[80:81], v124 offset:1408
    s_waitcnt lgkmcnt(6)
    v_mfma_f32_16x16x32_bf16 v[40:43], v[60:63], v[100:103], v[40:43]
    ds_read_b64 v[82:83], v124 offset:1416
    v_mfma_f32_16x16x32_bf16 v[48:51], v[64:67], v[116:119], v[48:51]
    ds_read_b64 v[84:85], v124 offset:896
    v_mfma_f32_16x16x32_bf16 v[44:47], v[64:67], v[112:115], v[44:47]
    ds_read_b64 v[86:87], v124 offset:904
    s_waitcnt lgkmcnt(7)
    v_mfma_f32_16x16x32_bf16 v[40:43], v[64:67], v[96:99], v[40:43]
    ds_read_b64 v[88:89], v124 offset:384
    v_mfma_f32_16x16x32_bf16 v[48:51], v[68:71], v[112:115], v[48:51]
    ds_read_b64 v[90:91], v124 offset:392
    v_mfma_f32_16x16x32_bf16 v[44:47], v[68:71], v[108:111], v[44:47]
    ds_read_b128 v[120:123], v125 offset:3904
    s_waitcnt lgkmcnt(8)
    v_mfma_f32_16x16x32_bf16 v[40:43], v[68:71], v[92:95], v[40:43]
    ds_read_b64 v[60:61], v124 offset:3904
    v_mfma_f32_16x16x32_bf16 v[48:51], v[72:75], v[108:111], v[48:51]
    ds_read_b64 v[62:63], v124 offset:3912
    v_mfma_f32_16x16x32_bf16 v[44:47], v[72:75], v[104:107], v[44:47]
    ds_read_b128 v[116:119], v125 offset:3392
    s_waitcnt lgkmcnt(10)
    v_mfma_f32_16x16x32_bf16 v[48:51], v[76:79], v[104:107], v[48:51]
    ds_read_b64 v[64:65], v124 offset:3392
    v_mfma_f32_16x16x32_bf16 v[44:47], v[76:79], v[100:103], v[44:47]
    ds_read_b64 v[66:67], v124 offset:3400
    s_waitcnt lgkmcnt(10)
    v_mfma_f32_16x16x32_bf16 v[48:51], v[80:83], v[100:103], v[48:51]
    ds_read_b128 v[100:103], v125 offset:1344
    v_mfma_f32_16x16x32_bf16 v[44:47], v[80:83], v[96:99], v[44:47]
    ds_read_b128 v[112:115], v125 offset:2880
    s_waitcnt lgkmcnt(10)
    v_mfma_f32_16x16x32_bf16 v[48:51], v[84:87], v[96:99], v[48:51]
    ds_read_b128 v[96:99], v125 offset:832
    v_mfma_f32_16x16x32_bf16 v[44:47], v[84:87], v[92:95], v[44:47]
    ds_read_b64 v[68:69], v124 offset:2880
    s_waitcnt lgkmcnt(10)
    v_mfma_f32_16x16x32_bf16 v[48:51], v[88:91], v[92:95], v[48:51]
    ds_read_b64 v[70:71], v124 offset:2888
    s_waitcnt lgkmcnt(8)
    v_mfma_f32_16x16x32_bf16 v[48:51], v[60:63], v[120:123], v[48:51]
    ds_read_b128 v[108:111], v125 offset:2368
    s_waitcnt lgkmcnt(8)
    v_mfma_f32_16x16x32_bf16 v[44:47], v[60:63], v[116:119], v[44:47]
    ds_read_b128 v[92:95], v125 offset:320
    s_waitcnt lgkmcnt(6)
    v_mfma_f32_16x16x32_bf16 v[40:43], v[60:63], v[100:103], v[40:43]
    ds_read_b64 v[72:73], v124 offset:2368
    v_mfma_f32_16x16x32_bf16 v[48:51], v[64:67], v[116:119], v[48:51]
    ds_read_b64 v[74:75], v124 offset:2376
    s_waitcnt lgkmcnt(7)
    v_mfma_f32_16x16x32_bf16 v[44:47], v[64:67], v[112:115], v[44:47]
    ds_read_b128 v[104:107], v125 offset:1856
    s_waitcnt lgkmcnt(7)
    v_mfma_f32_16x16x32_bf16 v[40:43], v[64:67], v[96:99], v[40:43]
    ds_read_b64 v[76:77], v124 offset:1856
    ds_read_b64 v[78:79], v124 offset:1864
    s_waitcnt lgkmcnt(7)
    v_mfma_f32_16x16x32_bf16 v[48:51], v[68:71], v[112:115], v[48:51]
    ds_read_b64 v[80:81], v124 offset:1344
    s_waitcnt lgkmcnt(7)
    v_mfma_f32_16x16x32_bf16 v[44:47], v[68:71], v[108:111], v[44:47]
    ds_read_b64 v[82:83], v124 offset:1352
    s_waitcnt lgkmcnt(7)
    v_mfma_f32_16x16x32_bf16 v[40:43], v[68:71], v[92:95], v[40:43]
    ds_read_b64 v[84:85], v124 offset:832
    s_waitcnt lgkmcnt(6)
    v_mfma_f32_16x16x32_bf16 v[48:51], v[72:75], v[108:111], v[48:51]
    ds_read_b64 v[86:87], v124 offset:840
    s_waitcnt lgkmcnt(6)
    v_mfma_f32_16x16x32_bf16 v[44:47], v[72:75], v[104:107], v[44:47]
    ds_read_b64 v[88:89], v124 offset:320
    s_waitcnt lgkmcnt(5)
    v_mfma_f32_16x16x32_bf16 v[48:51], v[76:79], v[104:107], v[48:51]
    ds_read_b64 v[90:91], v124 offset:328
    v_mfma_f32_16x16x32_bf16 v[44:47], v[76:79], v[100:103], v[44:47]
    ds_read_b128 v[120:123], v125 offset:3840
    ds_read_b64 v[60:61], v124 offset:3840
    ds_read_b64 v[62:63], v124 offset:3848
    s_waitcnt lgkmcnt(7)
    v_mfma_f32_16x16x32_bf16 v[48:51], v[80:83], v[100:103], v[48:51]
    ds_read_b128 v[116:119], v125 offset:3328
    v_mfma_f32_16x16x32_bf16 v[44:47], v[80:83], v[96:99], v[44:47]
    ds_read_b128 v[100:103], v125 offset:1280
    s_waitcnt lgkmcnt(7)
    v_mfma_f32_16x16x32_bf16 v[48:51], v[84:87], v[96:99], v[48:51]
    ds_read_b64 v[64:65], v124 offset:3328
    ds_read_b64 v[66:67], v124 offset:3336
    v_mfma_f32_16x16x32_bf16 v[44:47], v[84:87], v[92:95], v[44:47]
    ds_read_b128 v[112:115], v125 offset:2816
    s_waitcnt lgkmcnt(8)
    v_mfma_f32_16x16x32_bf16 v[48:51], v[88:91], v[92:95], v[48:51]
    ds_read_b128 v[96:99], v125 offset:768
    s_waitcnt lgkmcnt(6)
    v_mfma_f32_16x16x32_bf16 v[48:51], v[60:63], v[120:123], v[48:51]
    ds_read_b64 v[68:69], v124 offset:2816
    ds_read_b64 v[70:71], v124 offset:2824
    s_waitcnt lgkmcnt(7)
    v_mfma_f32_16x16x32_bf16 v[44:47], v[60:63], v[116:119], v[44:47]
    ds_read_b128 v[108:111], v125 offset:2304
    s_waitcnt lgkmcnt(7)
    v_mfma_f32_16x16x32_bf16 v[40:43], v[60:63], v[100:103], v[40:43]
    ds_read_b128 v[92:95], v125 offset:256
    s_waitcnt lgkmcnt(6)
    v_mfma_f32_16x16x32_bf16 v[48:51], v[64:67], v[116:119], v[48:51]
    ds_read_b64 v[72:73], v124 offset:2304
    ds_read_b64 v[74:75], v124 offset:2312
    s_waitcnt lgkmcnt(7)
    v_mfma_f32_16x16x32_bf16 v[44:47], v[64:67], v[112:115], v[44:47]
    ds_read_b128 v[104:107], v125 offset:1792
    s_waitcnt lgkmcnt(7)
    v_mfma_f32_16x16x32_bf16 v[40:43], v[64:67], v[96:99], v[40:43]
    ds_read_b64 v[76:77], v124 offset:1792
    ds_read_b64 v[78:79], v124 offset:1800
    s_waitcnt lgkmcnt(7)
    v_mfma_f32_16x16x32_bf16 v[48:51], v[68:71], v[112:115], v[48:51]
    ds_read_b64 v[80:81], v124 offset:1280
    s_waitcnt lgkmcnt(7)
    v_mfma_f32_16x16x32_bf16 v[44:47], v[68:71], v[108:111], v[44:47]
    ds_read_b64 v[82:83], v124 offset:1288
    s_waitcnt lgkmcnt(7)
    v_mfma_f32_16x16x32_bf16 v[40:43], v[68:71], v[92:95], v[40:43]
    ds_read_b64 v[84:85], v124 offset:768
    s_waitcnt lgkmcnt(6)
    v_mfma_f32_16x16x32_bf16 v[48:51], v[72:75], v[108:111], v[48:51]
    ds_read_b64 v[86:87], v124 offset:776
    s_waitcnt lgkmcnt(6)
    v_mfma_f32_16x16x32_bf16 v[44:47], v[72:75], v[104:107], v[44:47]
    ds_read_b64 v[88:89], v124 offset:256
    s_waitcnt lgkmcnt(5)
    v_mfma_f32_16x16x32_bf16 v[48:51], v[76:79], v[104:107], v[48:51]
    ds_read_b64 v[90:91], v124 offset:264
    v_mfma_f32_16x16x32_bf16 v[44:47], v[76:79], v[100:103], v[44:47]
    ds_read_b128 v[120:123], v125 offset:3776
    ds_read_b64 v[60:61], v124 offset:3776
    ds_read_b64 v[62:63], v124 offset:3784
    s_waitcnt lgkmcnt(7)
    v_mfma_f32_16x16x32_bf16 v[48:51], v[80:83], v[100:103], v[48:51]
    ds_read_b128 v[116:119], v125 offset:3264
    v_mfma_f32_16x16x32_bf16 v[44:47], v[80:83], v[96:99], v[44:47]
    ds_read_b128 v[100:103], v125 offset:1216
    s_waitcnt lgkmcnt(7)
    v_mfma_f32_16x16x32_bf16 v[48:51], v[84:87], v[96:99], v[48:51]
    ds_read_b64 v[64:65], v124 offset:3264
    ds_read_b64 v[66:67], v124 offset:3272
    v_mfma_f32_16x16x32_bf16 v[44:47], v[84:87], v[92:95], v[44:47]
    ds_read_b128 v[112:115], v125 offset:2752
    s_waitcnt lgkmcnt(8)
    v_mfma_f32_16x16x32_bf16 v[48:51], v[88:91], v[92:95], v[48:51]
    ds_read_b128 v[96:99], v125 offset:704
    s_waitcnt lgkmcnt(6)
    v_mfma_f32_16x16x32_bf16 v[48:51], v[60:63], v[120:123], v[48:51]
    ds_read_b64 v[68:69], v124 offset:2752
    ds_read_b64 v[70:71], v124 offset:2760
    s_waitcnt lgkmcnt(7)
    v_mfma_f32_16x16x32_bf16 v[44:47], v[60:63], v[116:119], v[44:47]
    ds_read_b128 v[108:111], v125 offset:2240
    s_waitcnt lgkmcnt(7)
    v_mfma_f32_16x16x32_bf16 v[40:43], v[60:63], v[100:103], v[40:43]
    ds_read_b128 v[92:95], v125 offset:192
    s_waitcnt lgkmcnt(6)
    v_mfma_f32_16x16x32_bf16 v[48:51], v[64:67], v[116:119], v[48:51]
    ds_read_b64 v[72:73], v124 offset:2240
    ds_read_b64 v[74:75], v124 offset:2248
    s_waitcnt lgkmcnt(7)
    v_mfma_f32_16x16x32_bf16 v[44:47], v[64:67], v[112:115], v[44:47]
    ds_read_b128 v[104:107], v125 offset:1728
    s_waitcnt lgkmcnt(7)
    v_mfma_f32_16x16x32_bf16 v[40:43], v[64:67], v[96:99], v[40:43]
    ds_read_b64 v[76:77], v124 offset:1728
    ds_read_b64 v[78:79], v124 offset:1736
    s_waitcnt lgkmcnt(7)
    v_mfma_f32_16x16x32_bf16 v[48:51], v[68:71], v[112:115], v[48:51]
    ds_read_b64 v[80:81], v124 offset:1216
    s_waitcnt lgkmcnt(7)
    v_mfma_f32_16x16x32_bf16 v[44:47], v[68:71], v[108:111], v[44:47]
    ds_read_b64 v[82:83], v124 offset:1224
    s_waitcnt lgkmcnt(7)
    v_mfma_f32_16x16x32_bf16 v[40:43], v[68:71], v[92:95], v[40:43]
    ds_read_b64 v[84:85], v124 offset:704
    s_waitcnt lgkmcnt(6)
    v_mfma_f32_16x16x32_bf16 v[48:51], v[72:75], v[108:111], v[48:51]
    ds_read_b64 v[86:87], v124 offset:712
    s_waitcnt lgkmcnt(6)
    v_mfma_f32_16x16x32_bf16 v[44:47], v[72:75], v[104:107], v[44:47]
    ds_read_b64 v[88:89], v124 offset:192
    s_waitcnt lgkmcnt(5)
    v_mfma_f32_16x16x32_bf16 v[48:51], v[76:79], v[104:107], v[48:51]
    ds_read_b64 v[90:91], v124 offset:200
    v_mfma_f32_16x16x32_bf16 v[44:47], v[76:79], v[100:103], v[44:47]
    ds_read_b128 v[120:123], v125 offset:3712
    ds_read_b64 v[60:61], v124 offset:3712
    ds_read_b64 v[62:63], v124 offset:3720
    s_waitcnt lgkmcnt(7)
    v_mfma_f32_16x16x32_bf16 v[48:51], v[80:83], v[100:103], v[48:51]
    ds_read_b128 v[116:119], v125 offset:3200
    v_mfma_f32_16x16x32_bf16 v[44:47], v[80:83], v[96:99], v[44:47]
    ds_read_b128 v[100:103], v125 offset:1152
    s_waitcnt lgkmcnt(7)
    v_mfma_f32_16x16x32_bf16 v[48:51], v[84:87], v[96:99], v[48:51]
    ds_read_b64 v[64:65], v124 offset:3200
    ds_read_b64 v[66:67], v124 offset:3208
    v_mfma_f32_16x16x32_bf16 v[44:47], v[84:87], v[92:95], v[44:47]
    ds_read_b128 v[112:115], v125 offset:2688
    s_waitcnt lgkmcnt(8)
    v_mfma_f32_16x16x32_bf16 v[48:51], v[88:91], v[92:95], v[48:51]
    ds_read_b128 v[96:99], v125 offset:640
    s_waitcnt lgkmcnt(6)
    v_mfma_f32_16x16x32_bf16 v[48:51], v[60:63], v[120:123], v[48:51]
    ds_read_b64 v[68:69], v124 offset:2688
    ds_read_b64 v[70:71], v124 offset:2696
    s_waitcnt lgkmcnt(7)
    v_mfma_f32_16x16x32_bf16 v[44:47], v[60:63], v[116:119], v[44:47]
    ds_read_b128 v[108:111], v125 offset:2176
    s_waitcnt lgkmcnt(7)
    v_mfma_f32_16x16x32_bf16 v[40:43], v[60:63], v[100:103], v[40:43]
    ds_read_b128 v[92:95], v125 offset:128
    s_waitcnt lgkmcnt(6)
    v_mfma_f32_16x16x32_bf16 v[48:51], v[64:67], v[116:119], v[48:51]
    ds_read_b64 v[72:73], v124 offset:2176
    ds_read_b64 v[74:75], v124 offset:2184
    s_waitcnt lgkmcnt(7)
    v_mfma_f32_16x16x32_bf16 v[44:47], v[64:67], v[112:115], v[44:47]
    ds_read_b128 v[104:107], v125 offset:1664
    s_waitcnt lgkmcnt(7)
    v_mfma_f32_16x16x32_bf16 v[40:43], v[64:67], v[96:99], v[40:43]
    ds_read_b64 v[76:77], v124 offset:1664
    ds_read_b64 v[78:79], v124 offset:1672
    s_waitcnt lgkmcnt(7)
    v_mfma_f32_16x16x32_bf16 v[48:51], v[68:71], v[112:115], v[48:51]
    ds_read_b64 v[80:81], v124 offset:1152
    s_waitcnt lgkmcnt(7)
    v_mfma_f32_16x16x32_bf16 v[44:47], v[68:71], v[108:111], v[44:47]
    ds_read_b64 v[82:83], v124 offset:1160
    s_waitcnt lgkmcnt(7)
    v_mfma_f32_16x16x32_bf16 v[40:43], v[68:71], v[92:95], v[40:43]
    ds_read_b64 v[84:85], v124 offset:640
    s_waitcnt lgkmcnt(6)
    v_mfma_f32_16x16x32_bf16 v[48:51], v[72:75], v[108:111], v[48:51]
    ds_read_b64 v[86:87], v124 offset:648
    s_waitcnt lgkmcnt(6)
    v_mfma_f32_16x16x32_bf16 v[44:47], v[72:75], v[104:107], v[44:47]
    ds_read_b64 v[88:89], v124 offset:128
    s_waitcnt lgkmcnt(5)
    v_mfma_f32_16x16x32_bf16 v[48:51], v[76:79], v[104:107], v[48:51]
    ds_read_b64 v[90:91], v124 offset:136
    v_mfma_f32_16x16x32_bf16 v[44:47], v[76:79], v[100:103], v[44:47]
    ds_read_b128 v[120:123], v125 offset:3648
    ds_read_b64 v[60:61], v124 offset:3648
    ds_read_b64 v[62:63], v124 offset:3656
    s_waitcnt lgkmcnt(7)
    v_mfma_f32_16x16x32_bf16 v[48:51], v[80:83], v[100:103], v[48:51]
    ds_read_b128 v[116:119], v125 offset:3136
    v_mfma_f32_16x16x32_bf16 v[44:47], v[80:83], v[96:99], v[44:47]
    ds_read_b128 v[100:103], v125 offset:1088
    s_waitcnt lgkmcnt(7)
    v_mfma_f32_16x16x32_bf16 v[48:51], v[84:87], v[96:99], v[48:51]
    ds_read_b64 v[64:65], v124 offset:3136
    ds_read_b64 v[66:67], v124 offset:3144
    v_mfma_f32_16x16x32_bf16 v[44:47], v[84:87], v[92:95], v[44:47]
    ds_read_b128 v[112:115], v125 offset:2624
    s_waitcnt lgkmcnt(8)
    v_mfma_f32_16x16x32_bf16 v[48:51], v[88:91], v[92:95], v[48:51]
    ds_read_b128 v[96:99], v125 offset:576
    s_waitcnt lgkmcnt(6)
    v_mfma_f32_16x16x32_bf16 v[48:51], v[60:63], v[120:123], v[48:51]
    ds_read_b64 v[68:69], v124 offset:2624
    ds_read_b64 v[70:71], v124 offset:2632
    s_waitcnt lgkmcnt(7)
    v_mfma_f32_16x16x32_bf16 v[44:47], v[60:63], v[116:119], v[44:47]
    ds_read_b128 v[108:111], v125 offset:2112
    s_waitcnt lgkmcnt(7)
    v_mfma_f32_16x16x32_bf16 v[40:43], v[60:63], v[100:103], v[40:43]
    ds_read_b128 v[92:95], v125 offset:64
    s_waitcnt lgkmcnt(6)
    v_mfma_f32_16x16x32_bf16 v[48:51], v[64:67], v[116:119], v[48:51]
    ds_read_b64 v[72:73], v124 offset:2112
    ds_read_b64 v[74:75], v124 offset:2120
    s_waitcnt lgkmcnt(7)
    v_mfma_f32_16x16x32_bf16 v[44:47], v[64:67], v[112:115], v[44:47]
    ds_read_b128 v[104:107], v125 offset:1600
    s_waitcnt lgkmcnt(7)
    v_mfma_f32_16x16x32_bf16 v[40:43], v[64:67], v[96:99], v[40:43]
    ds_read_b64 v[76:77], v124 offset:1600
    ds_read_b64 v[78:79], v124 offset:1608
    s_waitcnt lgkmcnt(7)
    v_mfma_f32_16x16x32_bf16 v[48:51], v[68:71], v[112:115], v[48:51]
    ds_read_b64 v[80:81], v124 offset:1088
    s_waitcnt lgkmcnt(7)
    v_mfma_f32_16x16x32_bf16 v[44:47], v[68:71], v[108:111], v[44:47]
    ds_read_b64 v[82:83], v124 offset:1096
    s_waitcnt lgkmcnt(7)
    v_mfma_f32_16x16x32_bf16 v[40:43], v[68:71], v[92:95], v[40:43]
    ds_read_b64 v[84:85], v124 offset:576
    s_waitcnt lgkmcnt(6)
    v_mfma_f32_16x16x32_bf16 v[48:51], v[72:75], v[108:111], v[48:51]
    ds_read_b64 v[86:87], v124 offset:584
    s_waitcnt lgkmcnt(6)
    v_mfma_f32_16x16x32_bf16 v[44:47], v[72:75], v[104:107], v[44:47]
    ds_read_b64 v[88:89], v124 offset:64
    s_waitcnt lgkmcnt(5)
    v_mfma_f32_16x16x32_bf16 v[48:51], v[76:79], v[104:107], v[48:51]
    ds_read_b64 v[90:91], v124 offset:72
    v_mfma_f32_16x16x32_bf16 v[44:47], v[76:79], v[100:103], v[44:47]
    ds_read_b128 v[120:123], v125 offset:3584
    ds_read_b64 v[60:61], v124 offset:3584
    ds_read_b64 v[62:63], v124 offset:3592
    s_waitcnt lgkmcnt(7)
    v_mfma_f32_16x16x32_bf16 v[48:51], v[80:83], v[100:103], v[48:51]
    ds_read_b128 v[116:119], v125 offset:3072
    v_mfma_f32_16x16x32_bf16 v[44:47], v[80:83], v[96:99], v[44:47]
    ds_read_b128 v[100:103], v125 offset:1024
    s_waitcnt lgkmcnt(7)
    v_mfma_f32_16x16x32_bf16 v[48:51], v[84:87], v[96:99], v[48:51]
    ds_read_b64 v[64:65], v124 offset:3072
    ds_read_b64 v[66:67], v124 offset:3080
    v_mfma_f32_16x16x32_bf16 v[44:47], v[84:87], v[92:95], v[44:47]
    ds_read_b128 v[112:115], v125 offset:2560
    s_waitcnt lgkmcnt(8)
    v_mfma_f32_16x16x32_bf16 v[48:51], v[88:91], v[92:95], v[48:51]
    ds_read_b128 v[96:99], v125 offset:512
    s_waitcnt lgkmcnt(6)
    v_mfma_f32_16x16x32_bf16 v[48:51], v[60:63], v[120:123], v[48:51]
    ds_read_b64 v[68:69], v124 offset:2560
    ds_read_b64 v[70:71], v124 offset:2568
    s_waitcnt lgkmcnt(7)
    v_mfma_f32_16x16x32_bf16 v[44:47], v[60:63], v[116:119], v[44:47]
    ds_read_b128 v[108:111], v125 offset:2048
    s_waitcnt lgkmcnt(7)
    v_mfma_f32_16x16x32_bf16 v[40:43], v[60:63], v[100:103], v[40:43]
    ds_read_b128 v[92:95], v125 offset:0
    s_waitcnt lgkmcnt(6)
    v_mfma_f32_16x16x32_bf16 v[48:51], v[64:67], v[116:119], v[48:51]
    ds_read_b64 v[72:73], v124 offset:2048
    ds_read_b64 v[74:75], v124 offset:2056
    s_waitcnt lgkmcnt(7)
    v_mfma_f32_16x16x32_bf16 v[44:47], v[64:67], v[112:115], v[44:47]
    ds_read_b128 v[104:107], v125 offset:1536
    s_waitcnt lgkmcnt(7)
    v_mfma_f32_16x16x32_bf16 v[40:43], v[64:67], v[96:99], v[40:43]
    ds_read_b64 v[76:77], v124 offset:1536
    ds_read_b64 v[78:79], v124 offset:1544
    s_waitcnt lgkmcnt(7)
    v_mfma_f32_16x16x32_bf16 v[48:51], v[68:71], v[112:115], v[48:51]
    ds_read_b64 v[80:81], v124 offset:1024
    s_waitcnt lgkmcnt(7)
    v_mfma_f32_16x16x32_bf16 v[44:47], v[68:71], v[108:111], v[44:47]
    ds_read_b64 v[82:83], v124 offset:1032
    s_waitcnt lgkmcnt(7)
    v_mfma_f32_16x16x32_bf16 v[40:43], v[68:71], v[92:95], v[40:43]
    ds_read_b64 v[84:85], v124 offset:512
    s_waitcnt lgkmcnt(6)
    v_mfma_f32_16x16x32_bf16 v[48:51], v[72:75], v[108:111], v[48:51]
    ds_read_b64 v[86:87], v124 offset:520
    s_waitcnt lgkmcnt(6)
    v_mfma_f32_16x16x32_bf16 v[44:47], v[72:75], v[104:107], v[44:47]
    ds_read_b64 v[88:89], v124 offset:0
    s_waitcnt lgkmcnt(5)
    v_mfma_f32_16x16x32_bf16 v[48:51], v[76:79], v[104:107], v[48:51]
    ds_read_b64 v[90:91], v124 offset:8
    v_mfma_f32_16x16x32_bf16 v[44:47], v[76:79], v[100:103], v[44:47]
    s_waitcnt lgkmcnt(4)
    v_mfma_f32_16x16x32_bf16 v[48:51], v[80:83], v[100:103], v[48:51]
    v_mfma_f32_16x16x32_bf16 v[44:47], v[80:83], v[96:99], v[44:47]
    s_waitcnt lgkmcnt(2)
    v_mfma_f32_16x16x32_bf16 v[48:51], v[84:87], v[96:99], v[48:51]
    v_mfma_f32_16x16x32_bf16 v[44:47], v[84:87], v[92:95], v[44:47]
    s_waitcnt lgkmcnt(0)
    v_mfma_f32_16x16x32_bf16 v[48:51], v[88:91], v[92:95], v[48:51]
    v_cvt_pk_bf16_f32 v40, v40, v41
    v_cvt_pk_bf16_f32 v41, v42, v43
    ds_write_b64 v126, v[40:41] offset:1024
    s_nop 2
    v_cvt_pk_bf16_f32 v44, v44, v45
    v_cvt_pk_bf16_f32 v45, v46, v47
    ds_write_b64 v126, v[44:45] offset:3072
    v_cvt_pk_bf16_f32 v48, v48, v49
    v_cvt_pk_bf16_f32 v49, v50, v51
    ds_write_b64 v126, v[48:49] offset:3584
    s_branch L_c2d_81
L_c2h1_80:
    ds_read_b64 v[60:61], v124 offset:4032
    ds_read_b64 v[62:63], v124 offset:4040
    ds_read_b128 v[104:107], v125 offset:3008
    ds_read_b128 v[100:103], v125 offset:2496
    ds_read_b128 v[96:99], v125 offset:1984
    ds_read_b128 v[88:91], v125 offset:960
    ds_read_b128 v[84:87], v125 offset:448
    ds_read_b64 v[64:65], v124 offset:3520
    ds_read_b64 v[66:67], v124 offset:3528
    ds_read_b128 v[92:95], v125 offset:1472
    ds_read_b64 v[68:69], v124 offset:3008
    ds_read_b64 v[70:71], v124 offset:3016
    ds_read_b64 v[72:73], v124 offset:2496
    ds_read_b64 v[74:75], v124 offset:2504
    ds_read_b64 v[76:77], v124 offset:1984
    ds_read_b64 v[78:79], v124 offset:1992
    ds_read_b64 v[80:81], v124 offset:1472
    ds_read_b64 v[82:83], v124 offset:1480
    s_waitcnt lgkmcnt(15)
    v_mfma_f32_16x16x32_bf16 v[56:59], v[60:63], v[104:107], 0
    ds_read_b128 v[104:107], v125 offset:2944
    s_waitcnt lgkmcnt(15)
    v_mfma_f32_16x16x32_bf16 v[52:55], v[60:63], v[100:103], 0
    s_waitcnt lgkmcnt(14)
    v_mfma_f32_16x16x32_bf16 v[48:51], v[60:63], v[96:99], 0
    s_waitcnt lgkmcnt(13)
    v_mfma_f32_16x16x32_bf16 v[44:47], v[60:63], v[88:91], 0
    s_waitcnt lgkmcnt(12)
    v_mfma_f32_16x16x32_bf16 v[40:43], v[60:63], v[84:87], 0
    ds_read_b64 v[60:61], v124 offset:3968
    s_waitcnt lgkmcnt(11)
    v_mfma_f32_16x16x32_bf16 v[56:59], v[64:67], v[100:103], v[56:59]
    ds_read_b64 v[62:63], v124 offset:3976
    v_mfma_f32_16x16x32_bf16 v[52:55], v[64:67], v[96:99], v[52:55]
    ds_read_b128 v[100:103], v125 offset:2432
    s_waitcnt lgkmcnt(12)
    v_mfma_f32_16x16x32_bf16 v[48:51], v[64:67], v[92:95], v[48:51]
    v_mfma_f32_16x16x32_bf16 v[44:47], v[64:67], v[84:87], v[44:47]
    ds_read_b64 v[64:65], v124 offset:3456
    s_waitcnt lgkmcnt(11)
    v_mfma_f32_16x16x32_bf16 v[56:59], v[68:71], v[96:99], v[56:59]
    ds_read_b128 v[96:99], v125 offset:1920
    v_mfma_f32_16x16x32_bf16 v[52:55], v[68:71], v[92:95], v[52:55]
    ds_read_b64 v[66:67], v124 offset:3464
    v_mfma_f32_16x16x32_bf16 v[48:51], v[68:71], v[88:91], v[48:51]
    ds_read_b64 v[68:69], v124 offset:2944
    s_waitcnt lgkmcnt(12)
    v_mfma_f32_16x16x32_bf16 v[56:59], v[72:75], v[92:95], v[56:59]
    ds_read_b128 v[92:95], v125 offset:1408
    v_mfma_f32_16x16x32_bf16 v[52:55], v[72:75], v[88:91], v[52:55]
    ds_read_b64 v[70:71], v124 offset:2952
    v_mfma_f32_16x16x32_bf16 v[48:51], v[72:75], v[84:87], v[48:51]
    ds_read_b64 v[72:73], v124 offset:2432
    s_waitcnt lgkmcnt(13)
    v_mfma_f32_16x16x32_bf16 v[56:59], v[76:79], v[88:91], v[56:59]
    ds_read_b128 v[88:91], v125 offset:896
    v_mfma_f32_16x16x32_bf16 v[52:55], v[76:79], v[84:87], v[52:55]
    ds_read_b64 v[74:75], v124 offset:2440
    s_waitcnt lgkmcnt(13)
    v_mfma_f32_16x16x32_bf16 v[56:59], v[80:83], v[84:87], v[56:59]
    ds_read_b128 v[84:87], v125 offset:384
    s_waitcnt lgkmcnt(11)
    v_mfma_f32_16x16x32_bf16 v[56:59], v[60:63], v[104:107], v[56:59]
    ds_read_b64 v[76:77], v124 offset:1920
    s_waitcnt lgkmcnt(11)
    v_mfma_f32_16x16x32_bf16 v[52:55], v[60:63], v[100:103], v[52:55]
    ds_read_b64 v[78:79], v124 offset:1928
    s_waitcnt lgkmcnt(10)
    v_mfma_f32_16x16x32_bf16 v[48:51], v[60:63], v[96:99], v[48:51]
    ds_read_b64 v[80:81], v124 offset:1408
    s_waitcnt lgkmcnt(5)
    v_mfma_f32_16x16x32_bf16 v[44:47], v[60:63], v[88:91], v[44:47]
    ds_read_b64 v[82:83], v124 offset:1416
    s_waitcnt lgkmcnt(4)
    v_mfma_f32_16x16x32_bf16 v[40:43], v[60:63], v[84:87], v[40:43]
    ds_read_b128 v[104:107], v125 offset:2880
    v_mfma_f32_16x16x32_bf16 v[56:59], v[64:67], v[100:103], v[56:59]
    ds_read_b64 v[60:61], v124 offset:3904
    v_mfma_f32_16x16x32_bf16 v[52:55], v[64:67], v[96:99], v[52:55]
    ds_read_b64 v[62:63], v124 offset:3912
    v_mfma_f32_16x16x32_bf16 v[48:51], v[64:67], v[92:95], v[48:51]
    ds_read_b128 v[100:103], v125 offset:2368
    v_mfma_f32_16x16x32_bf16 v[44:47], v[64:67], v[84:87], v[44:47]
    ds_read_b64 v[64:65], v124 offset:3392
    v_mfma_f32_16x16x32_bf16 v[56:59], v[68:71], v[96:99], v[56:59]
    ds_read_b128 v[96:99], v125 offset:1856
    v_mfma_f32_16x16x32_bf16 v[52:55], v[68:71], v[92:95], v[52:55]
    ds_read_b64 v[66:67], v124 offset:3400
    v_mfma_f32_16x16x32_bf16 v[48:51], v[68:71], v[88:91], v[48:51]
    ds_read_b64 v[68:69], v124 offset:2880
    v_mfma_f32_16x16x32_bf16 v[56:59], v[72:75], v[92:95], v[56:59]
    ds_read_b128 v[92:95], v125 offset:1344
    v_mfma_f32_16x16x32_bf16 v[52:55], v[72:75], v[88:91], v[52:55]
    ds_read_b64 v[70:71], v124 offset:2888
    v_mfma_f32_16x16x32_bf16 v[48:51], v[72:75], v[84:87], v[48:51]
    ds_read_b64 v[72:73], v124 offset:2368
    s_waitcnt lgkmcnt(13)
    v_mfma_f32_16x16x32_bf16 v[56:59], v[76:79], v[88:91], v[56:59]
    ds_read_b128 v[88:91], v125 offset:832
    v_mfma_f32_16x16x32_bf16 v[52:55], v[76:79], v[84:87], v[52:55]
    ds_read_b64 v[74:75], v124 offset:2376
    s_waitcnt lgkmcnt(13)
    v_mfma_f32_16x16x32_bf16 v[56:59], v[80:83], v[84:87], v[56:59]
    ds_read_b128 v[84:87], v125 offset:320
    s_waitcnt lgkmcnt(11)
    v_mfma_f32_16x16x32_bf16 v[56:59], v[60:63], v[104:107], v[56:59]
    ds_read_b64 v[76:77], v124 offset:1856
    s_waitcnt lgkmcnt(11)
    v_mfma_f32_16x16x32_bf16 v[52:55], v[60:63], v[100:103], v[52:55]
    ds_read_b64 v[78:79], v124 offset:1864
    s_waitcnt lgkmcnt(10)
    v_mfma_f32_16x16x32_bf16 v[48:51], v[60:63], v[96:99], v[48:51]
    ds_read_b64 v[80:81], v124 offset:1344
    s_waitcnt lgkmcnt(5)
    v_mfma_f32_16x16x32_bf16 v[44:47], v[60:63], v[88:91], v[44:47]
    ds_read_b64 v[82:83], v124 offset:1352
    s_waitcnt lgkmcnt(4)
    v_mfma_f32_16x16x32_bf16 v[40:43], v[60:63], v[84:87], v[40:43]
    ds_read_b128 v[104:107], v125 offset:2816
    v_mfma_f32_16x16x32_bf16 v[56:59], v[64:67], v[100:103], v[56:59]
    ds_read_b64 v[60:61], v124 offset:3840
    v_mfma_f32_16x16x32_bf16 v[52:55], v[64:67], v[96:99], v[52:55]
    ds_read_b64 v[62:63], v124 offset:3848
    v_mfma_f32_16x16x32_bf16 v[48:51], v[64:67], v[92:95], v[48:51]
    ds_read_b128 v[100:103], v125 offset:2304
    v_mfma_f32_16x16x32_bf16 v[44:47], v[64:67], v[84:87], v[44:47]
    ds_read_b64 v[64:65], v124 offset:3328
    v_mfma_f32_16x16x32_bf16 v[56:59], v[68:71], v[96:99], v[56:59]
    ds_read_b128 v[96:99], v125 offset:1792
    v_mfma_f32_16x16x32_bf16 v[52:55], v[68:71], v[92:95], v[52:55]
    ds_read_b64 v[66:67], v124 offset:3336
    v_mfma_f32_16x16x32_bf16 v[48:51], v[68:71], v[88:91], v[48:51]
    ds_read_b64 v[68:69], v124 offset:2816
    v_mfma_f32_16x16x32_bf16 v[56:59], v[72:75], v[92:95], v[56:59]
    ds_read_b128 v[92:95], v125 offset:1280
    v_mfma_f32_16x16x32_bf16 v[52:55], v[72:75], v[88:91], v[52:55]
    ds_read_b64 v[70:71], v124 offset:2824
    v_mfma_f32_16x16x32_bf16 v[48:51], v[72:75], v[84:87], v[48:51]
    ds_read_b64 v[72:73], v124 offset:2304
    s_waitcnt lgkmcnt(13)
    v_mfma_f32_16x16x32_bf16 v[56:59], v[76:79], v[88:91], v[56:59]
    ds_read_b128 v[88:91], v125 offset:768
    v_mfma_f32_16x16x32_bf16 v[52:55], v[76:79], v[84:87], v[52:55]
    ds_read_b64 v[74:75], v124 offset:2312
    s_waitcnt lgkmcnt(13)
    v_mfma_f32_16x16x32_bf16 v[56:59], v[80:83], v[84:87], v[56:59]
    ds_read_b128 v[84:87], v125 offset:256
    s_waitcnt lgkmcnt(11)
    v_mfma_f32_16x16x32_bf16 v[56:59], v[60:63], v[104:107], v[56:59]
    ds_read_b64 v[76:77], v124 offset:1792
    s_waitcnt lgkmcnt(11)
    v_mfma_f32_16x16x32_bf16 v[52:55], v[60:63], v[100:103], v[52:55]
    ds_read_b64 v[78:79], v124 offset:1800
    s_waitcnt lgkmcnt(10)
    v_mfma_f32_16x16x32_bf16 v[48:51], v[60:63], v[96:99], v[48:51]
    ds_read_b64 v[80:81], v124 offset:1280
    s_waitcnt lgkmcnt(5)
    v_mfma_f32_16x16x32_bf16 v[44:47], v[60:63], v[88:91], v[44:47]
    ds_read_b64 v[82:83], v124 offset:1288
    s_waitcnt lgkmcnt(4)
    v_mfma_f32_16x16x32_bf16 v[40:43], v[60:63], v[84:87], v[40:43]
    ds_read_b128 v[104:107], v125 offset:2752
    v_mfma_f32_16x16x32_bf16 v[56:59], v[64:67], v[100:103], v[56:59]
    ds_read_b64 v[60:61], v124 offset:3776
    v_mfma_f32_16x16x32_bf16 v[52:55], v[64:67], v[96:99], v[52:55]
    ds_read_b64 v[62:63], v124 offset:3784
    v_mfma_f32_16x16x32_bf16 v[48:51], v[64:67], v[92:95], v[48:51]
    ds_read_b128 v[100:103], v125 offset:2240
    v_mfma_f32_16x16x32_bf16 v[44:47], v[64:67], v[84:87], v[44:47]
    ds_read_b64 v[64:65], v124 offset:3264
    v_mfma_f32_16x16x32_bf16 v[56:59], v[68:71], v[96:99], v[56:59]
    ds_read_b128 v[96:99], v125 offset:1728
    v_mfma_f32_16x16x32_bf16 v[52:55], v[68:71], v[92:95], v[52:55]
    ds_read_b64 v[66:67], v124 offset:3272
    v_mfma_f32_16x16x32_bf16 v[48:51], v[68:71], v[88:91], v[48:51]
    ds_read_b64 v[68:69], v124 offset:2752
    v_mfma_f32_16x16x32_bf16 v[56:59], v[72:75], v[92:95], v[56:59]
    ds_read_b128 v[92:95], v125 offset:1216
    v_mfma_f32_16x16x32_bf16 v[52:55], v[72:75], v[88:91], v[52:55]
    ds_read_b64 v[70:71], v124 offset:2760
    v_mfma_f32_16x16x32_bf16 v[48:51], v[72:75], v[84:87], v[48:51]
    ds_read_b64 v[72:73], v124 offset:2240
    s_waitcnt lgkmcnt(13)
    v_mfma_f32_16x16x32_bf16 v[56:59], v[76:79], v[88:91], v[56:59]
    ds_read_b128 v[88:91], v125 offset:704
    v_mfma_f32_16x16x32_bf16 v[52:55], v[76:79], v[84:87], v[52:55]
    ds_read_b64 v[74:75], v124 offset:2248
    s_waitcnt lgkmcnt(13)
    v_mfma_f32_16x16x32_bf16 v[56:59], v[80:83], v[84:87], v[56:59]
    ds_read_b128 v[84:87], v125 offset:192
    s_waitcnt lgkmcnt(11)
    v_mfma_f32_16x16x32_bf16 v[56:59], v[60:63], v[104:107], v[56:59]
    ds_read_b64 v[76:77], v124 offset:1728
    s_waitcnt lgkmcnt(11)
    v_mfma_f32_16x16x32_bf16 v[52:55], v[60:63], v[100:103], v[52:55]
    ds_read_b64 v[78:79], v124 offset:1736
    s_waitcnt lgkmcnt(10)
    v_mfma_f32_16x16x32_bf16 v[48:51], v[60:63], v[96:99], v[48:51]
    ds_read_b64 v[80:81], v124 offset:1216
    s_waitcnt lgkmcnt(5)
    v_mfma_f32_16x16x32_bf16 v[44:47], v[60:63], v[88:91], v[44:47]
    ds_read_b64 v[82:83], v124 offset:1224
    s_waitcnt lgkmcnt(4)
    v_mfma_f32_16x16x32_bf16 v[40:43], v[60:63], v[84:87], v[40:43]
    ds_read_b128 v[104:107], v125 offset:2688
    v_mfma_f32_16x16x32_bf16 v[56:59], v[64:67], v[100:103], v[56:59]
    ds_read_b64 v[60:61], v124 offset:3712
    v_mfma_f32_16x16x32_bf16 v[52:55], v[64:67], v[96:99], v[52:55]
    ds_read_b64 v[62:63], v124 offset:3720
    v_mfma_f32_16x16x32_bf16 v[48:51], v[64:67], v[92:95], v[48:51]
    ds_read_b128 v[100:103], v125 offset:2176
    v_mfma_f32_16x16x32_bf16 v[44:47], v[64:67], v[84:87], v[44:47]
    ds_read_b64 v[64:65], v124 offset:3200
    v_mfma_f32_16x16x32_bf16 v[56:59], v[68:71], v[96:99], v[56:59]
    ds_read_b128 v[96:99], v125 offset:1664
    v_mfma_f32_16x16x32_bf16 v[52:55], v[68:71], v[92:95], v[52:55]
    ds_read_b64 v[66:67], v124 offset:3208
    v_mfma_f32_16x16x32_bf16 v[48:51], v[68:71], v[88:91], v[48:51]
    ds_read_b64 v[68:69], v124 offset:2688
    v_mfma_f32_16x16x32_bf16 v[56:59], v[72:75], v[92:95], v[56:59]
    ds_read_b128 v[92:95], v125 offset:1152
    v_mfma_f32_16x16x32_bf16 v[52:55], v[72:75], v[88:91], v[52:55]
    ds_read_b64 v[70:71], v124 offset:2696
    v_mfma_f32_16x16x32_bf16 v[48:51], v[72:75], v[84:87], v[48:51]
    ds_read_b64 v[72:73], v124 offset:2176
    s_waitcnt lgkmcnt(13)
    v_mfma_f32_16x16x32_bf16 v[56:59], v[76:79], v[88:91], v[56:59]
    ds_read_b128 v[88:91], v125 offset:640
    v_mfma_f32_16x16x32_bf16 v[52:55], v[76:79], v[84:87], v[52:55]
    ds_read_b64 v[74:75], v124 offset:2184
    s_waitcnt lgkmcnt(13)
    v_mfma_f32_16x16x32_bf16 v[56:59], v[80:83], v[84:87], v[56:59]
    ds_read_b128 v[84:87], v125 offset:128
    s_waitcnt lgkmcnt(11)
    v_mfma_f32_16x16x32_bf16 v[56:59], v[60:63], v[104:107], v[56:59]
    ds_read_b64 v[76:77], v124 offset:1664
    s_waitcnt lgkmcnt(11)
    v_mfma_f32_16x16x32_bf16 v[52:55], v[60:63], v[100:103], v[52:55]
    ds_read_b64 v[78:79], v124 offset:1672
    s_waitcnt lgkmcnt(10)
    v_mfma_f32_16x16x32_bf16 v[48:51], v[60:63], v[96:99], v[48:51]
    ds_read_b64 v[80:81], v124 offset:1152
    s_waitcnt lgkmcnt(5)
    v_mfma_f32_16x16x32_bf16 v[44:47], v[60:63], v[88:91], v[44:47]
    ds_read_b64 v[82:83], v124 offset:1160
    s_waitcnt lgkmcnt(4)
    v_mfma_f32_16x16x32_bf16 v[40:43], v[60:63], v[84:87], v[40:43]
    ds_read_b128 v[104:107], v125 offset:2624
    v_mfma_f32_16x16x32_bf16 v[56:59], v[64:67], v[100:103], v[56:59]
    ds_read_b64 v[60:61], v124 offset:3648
    v_mfma_f32_16x16x32_bf16 v[52:55], v[64:67], v[96:99], v[52:55]
    ds_read_b64 v[62:63], v124 offset:3656
    v_mfma_f32_16x16x32_bf16 v[48:51], v[64:67], v[92:95], v[48:51]
    ds_read_b128 v[100:103], v125 offset:2112
    v_mfma_f32_16x16x32_bf16 v[44:47], v[64:67], v[84:87], v[44:47]
    ds_read_b64 v[64:65], v124 offset:3136
    v_mfma_f32_16x16x32_bf16 v[56:59], v[68:71], v[96:99], v[56:59]
    ds_read_b128 v[96:99], v125 offset:1600
    v_mfma_f32_16x16x32_bf16 v[52:55], v[68:71], v[92:95], v[52:55]
    ds_read_b64 v[66:67], v124 offset:3144
    v_mfma_f32_16x16x32_bf16 v[48:51], v[68:71], v[88:91], v[48:51]
    ds_read_b64 v[68:69], v124 offset:2624
    v_mfma_f32_16x16x32_bf16 v[56:59], v[72:75], v[92:95], v[56:59]
    ds_read_b128 v[92:95], v125 offset:1088
    v_mfma_f32_16x16x32_bf16 v[52:55], v[72:75], v[88:91], v[52:55]
    ds_read_b64 v[70:71], v124 offset:2632
    v_mfma_f32_16x16x32_bf16 v[48:51], v[72:75], v[84:87], v[48:51]
    ds_read_b64 v[72:73], v124 offset:2112
    s_waitcnt lgkmcnt(13)
    v_mfma_f32_16x16x32_bf16 v[56:59], v[76:79], v[88:91], v[56:59]
    ds_read_b128 v[88:91], v125 offset:576
    v_mfma_f32_16x16x32_bf16 v[52:55], v[76:79], v[84:87], v[52:55]
    ds_read_b64 v[74:75], v124 offset:2120
    s_waitcnt lgkmcnt(13)
    v_mfma_f32_16x16x32_bf16 v[56:59], v[80:83], v[84:87], v[56:59]
    ds_read_b128 v[84:87], v125 offset:64
    s_waitcnt lgkmcnt(11)
    v_mfma_f32_16x16x32_bf16 v[56:59], v[60:63], v[104:107], v[56:59]
    ds_read_b64 v[76:77], v124 offset:1600
    s_waitcnt lgkmcnt(11)
    v_mfma_f32_16x16x32_bf16 v[52:55], v[60:63], v[100:103], v[52:55]
    ds_read_b64 v[78:79], v124 offset:1608
    s_waitcnt lgkmcnt(10)
    v_mfma_f32_16x16x32_bf16 v[48:51], v[60:63], v[96:99], v[48:51]
    ds_read_b64 v[80:81], v124 offset:1088
    s_waitcnt lgkmcnt(5)
    v_mfma_f32_16x16x32_bf16 v[44:47], v[60:63], v[88:91], v[44:47]
    ds_read_b64 v[82:83], v124 offset:1096
    s_waitcnt lgkmcnt(4)
    v_mfma_f32_16x16x32_bf16 v[40:43], v[60:63], v[84:87], v[40:43]
    ds_read_b128 v[104:107], v125 offset:2560
    v_mfma_f32_16x16x32_bf16 v[56:59], v[64:67], v[100:103], v[56:59]
    ds_read_b64 v[60:61], v124 offset:3584
    v_mfma_f32_16x16x32_bf16 v[52:55], v[64:67], v[96:99], v[52:55]
    ds_read_b64 v[62:63], v124 offset:3592
    v_mfma_f32_16x16x32_bf16 v[48:51], v[64:67], v[92:95], v[48:51]
    ds_read_b128 v[100:103], v125 offset:2048
    v_mfma_f32_16x16x32_bf16 v[44:47], v[64:67], v[84:87], v[44:47]
    ds_read_b64 v[64:65], v124 offset:3072
    v_mfma_f32_16x16x32_bf16 v[56:59], v[68:71], v[96:99], v[56:59]
    ds_read_b128 v[96:99], v125 offset:1536
    v_mfma_f32_16x16x32_bf16 v[52:55], v[68:71], v[92:95], v[52:55]
    ds_read_b64 v[66:67], v124 offset:3080
    v_mfma_f32_16x16x32_bf16 v[48:51], v[68:71], v[88:91], v[48:51]
    ds_read_b64 v[68:69], v124 offset:2560
    v_mfma_f32_16x16x32_bf16 v[56:59], v[72:75], v[92:95], v[56:59]
    ds_read_b128 v[92:95], v125 offset:1024
    v_mfma_f32_16x16x32_bf16 v[52:55], v[72:75], v[88:91], v[52:55]
    ds_read_b64 v[70:71], v124 offset:2568
    v_mfma_f32_16x16x32_bf16 v[48:51], v[72:75], v[84:87], v[48:51]
    ds_read_b64 v[72:73], v124 offset:2048
    s_waitcnt lgkmcnt(13)
    v_mfma_f32_16x16x32_bf16 v[56:59], v[76:79], v[88:91], v[56:59]
    ds_read_b128 v[88:91], v125 offset:512
    v_mfma_f32_16x16x32_bf16 v[52:55], v[76:79], v[84:87], v[52:55]
    ds_read_b64 v[74:75], v124 offset:2056
    s_waitcnt lgkmcnt(13)
    v_mfma_f32_16x16x32_bf16 v[56:59], v[80:83], v[84:87], v[56:59]
    ds_read_b128 v[84:87], v125 offset:0
    s_waitcnt lgkmcnt(11)
    v_mfma_f32_16x16x32_bf16 v[56:59], v[60:63], v[104:107], v[56:59]
    ds_read_b64 v[76:77], v124 offset:1536
    s_waitcnt lgkmcnt(11)
    v_mfma_f32_16x16x32_bf16 v[52:55], v[60:63], v[100:103], v[52:55]
    ds_read_b64 v[78:79], v124 offset:1544
    s_waitcnt lgkmcnt(10)
    v_mfma_f32_16x16x32_bf16 v[48:51], v[60:63], v[96:99], v[48:51]
    ds_read_b64 v[80:81], v124 offset:1024
    s_waitcnt lgkmcnt(5)
    v_mfma_f32_16x16x32_bf16 v[44:47], v[60:63], v[88:91], v[44:47]
    ds_read_b64 v[82:83], v124 offset:1032
    s_waitcnt lgkmcnt(4)
    v_mfma_f32_16x16x32_bf16 v[40:43], v[60:63], v[84:87], v[40:43]
    v_mfma_f32_16x16x32_bf16 v[56:59], v[64:67], v[100:103], v[56:59]
    v_mfma_f32_16x16x32_bf16 v[52:55], v[64:67], v[96:99], v[52:55]
    v_mfma_f32_16x16x32_bf16 v[48:51], v[64:67], v[92:95], v[48:51]
    v_mfma_f32_16x16x32_bf16 v[44:47], v[64:67], v[84:87], v[44:47]
    v_mfma_f32_16x16x32_bf16 v[56:59], v[68:71], v[96:99], v[56:59]
    v_mfma_f32_16x16x32_bf16 v[52:55], v[68:71], v[92:95], v[52:55]
    v_mfma_f32_16x16x32_bf16 v[48:51], v[68:71], v[88:91], v[48:51]
    v_mfma_f32_16x16x32_bf16 v[56:59], v[72:75], v[92:95], v[56:59]
    v_mfma_f32_16x16x32_bf16 v[52:55], v[72:75], v[88:91], v[52:55]
    v_mfma_f32_16x16x32_bf16 v[48:51], v[72:75], v[84:87], v[48:51]
    s_waitcnt lgkmcnt(2)
    v_mfma_f32_16x16x32_bf16 v[56:59], v[76:79], v[88:91], v[56:59]
    v_mfma_f32_16x16x32_bf16 v[52:55], v[76:79], v[84:87], v[52:55]
    s_waitcnt lgkmcnt(0)
    v_mfma_f32_16x16x32_bf16 v[56:59], v[80:83], v[84:87], v[56:59]
    v_cvt_pk_bf16_f32 v40, v40, v41
    v_cvt_pk_bf16_f32 v41, v42, v43
    ds_write_b64 v126, v[40:41] offset:0
    v_cvt_pk_bf16_f32 v44, v44, v45
    v_cvt_pk_bf16_f32 v45, v46, v47
    ds_write_b64 v126, v[44:45] offset:512
    v_cvt_pk_bf16_f32 v48, v48, v49
    v_cvt_pk_bf16_f32 v49, v50, v51
    ds_write_b64 v126, v[48:49] offset:1536
    v_cvt_pk_bf16_f32 v52, v52, v53
    v_cvt_pk_bf16_f32 v53, v54, v55
    ds_write_b64 v126, v[52:53] offset:2048
    v_cvt_pk_bf16_f32 v56, v56, v57
    v_cvt_pk_bf16_f32 v57, v58, v59
    ds_write_b64 v126, v[56:57] offset:2560
L_c2d_81:
    s_waitcnt lgkmcnt(0)
    s_barrier
    s_xor_b32 s60, s60, 0x80000000
    s_cmp_ge_u32 s61, 6
    s_cbranch_scc1 L_ytd_82
    v_add_u32 v5, 63872, v36
    ds_read_b32 v60, v5 offset:0
    ds_read_b32 v61, v5 offset:4
    ds_read_b32 v62, v5 offset:8
    ds_read_b32 v64, v5 offset:4128
    ds_read_b32 v65, v5 offset:4132
    ds_read_b32 v66, v5 offset:4136
    v_lshlrev_b32 v4, 4, v0
    s_mul_i32 s88, s62, 5504
    s_add_u32 s88, s88, 9437184
    s_add_u32 s89, s88, 5504
    s_add_u32 s90, s89, 5504
    v_mov_b32 v63, s60
    v_mov_b32 v67, s60
    s_cmp_eq_u32 s61, 5
    s_cselect_b32 exec_lo, 0xffffff, -1
    s_cselect_b32 exec_hi, 0, -1
    s_waitcnt lgkmcnt(3)
    buffer_store_dwordx4 v[60:63], v4, s[52:55], s88 offen sc0 sc1
    s_waitcnt lgkmcnt(0)
    buffer_store_dwordx4 v[64:67], v4, s[52:55], s89 offen sc0 sc1
    s_mov_b64 exec, -1
L_ytd_82:
    s_cmp_lg_u32 s61, 0
    s_cbranch_scc1 L_nofl_83
    s_lshl_b32 s75, s3, 7
    s_add_u32 s75, s75, 196608
    v_mov_b32 v7, 0
    v_mov_b32 v8, s60
    s_waitcnt vmcnt(2)
    s_mov_b64 exec, 1
    buffer_store_dword v8, v7, s[52:55], s75 offen sc0 sc1
    s_mov_b64 exec, -1
L_nofl_83:
    s_branch L_bt2_66
L_b3_67:
    s_and_b32 s75, s61, 1
    s_lshl_b32 s75, s75, 8
    s_add_u32 m0, s75, 0
    s_lshr_b32 s75, s61, 1
    s_cmp_eq_u32 s75, 1
    s_cbranch_scc1 L_kg_85
    s_cmp_eq_u32 s75, 2
    s_cbranch_scc1 L_kg_86
    s_cmp_eq_u32 s75, 3
    s_cbranch_scc1 L_kg_87
L_kg_84:
    v_lshlrev_b32 v24, 16, v52
    v_lshlrev_b32 v25, 16, v53
    v_mul_f32 v24, v24, v39
    v_mul_f32 v25, v25, v39
    v_mul_f32 v30, 0x4138aa3b, v24
    v_mul_f32 v31, 0x3fa2f983, v25
    v_fract_f32 v31, v31
    v_exp_f32 v30, v30
    v_cos_f32 v66, v31
    v_sin_f32 v67, v31
    v_lshlrev_b32 v72, 16, v54
    v_lshlrev_b32 v73, 16, v55
    v_lshlrev_b32 v70, 16, v56
    v_lshlrev_b32 v71, 16, v57
    v_mul_f32 v72, v72, v39
    v_mul_f32 v73, v73, v39
    v_mul_f32 v66, v66, v30
    v_mul_f32 v67, v67, v30
    v_mul_f32 v74, v71, v73
    v_mul_f32 v75, v71, v72
    v_mul_f32 v68, v67, v67
    v_mul_f32 v69, v67, v66
    v_fma_f32 v74, v70, v72, -v74
    v_fmac_f32 v75, v70, v73
    v_fma_f32 v68, v66, v66, -v68
    v_fmac_f32 v69, v66, v67
    v_mul_f32 v76, v75, v67
    v_mul_f32 v77, v75, v66
    v_fma_f32 v76, v74, v66, -v76
    v_fmac_f32 v77, v74, v67
    v_mul_f32 v78, v75, v69
    v_mul_f32 v79, v75, v68
    v_mul_f32 v80, v77, v69
    v_mul_f32 v81, v77, v68
    v_fma_f32 v78, v74, v68, -v78
    v_fmac_f32 v79, v74, v69
    v_fma_f32 v80, v76, v68, -v80
    v_fmac_f32 v81, v76, v69
    v_cvt_pk_bf16_f32 v26, v74, -v75
    v_cvt_pk_bf16_f32 v27, v76, -v77
    ds_write_addtid_b32 v26 offset:21648
    s_cmp_ge_u32 s61, 3
    s_cbranch_scc1 L_jp_89
    v_add_u32 v5, 30096, v16
    s_mul_i32 s78, s61, 8448
    v_add_u32 v4, s78, v5
    ds_read_b128 v[92:95], v4 offset:0
    ds_read_b128 v[108:111], v5 offset:21648
    ds_read_b128 v[96:99], v4 offset:64
    ds_read_b128 v[112:115], v5 offset:21712
    ds_read_b128 v[100:103], v4 offset:128
    ds_read_b128 v[116:119], v5 offset:21776
    ds_read_b128 v[104:107], v4 offset:192
    ds_read_b128 v[120:123], v5 offset:21840
    s_lshr_b64 s[82:83], s[72:73], 16
    s_lshl_b32 s78, s82, 16
    s_cmp_eq_u32 s61, 0
    s_cselect_b32 s78, s78, 0
    v_mov_b32 v124, 0
    v_mov_b32 v125, 0
    v_mov_b32 v126, 0
    v_mov_b32 v127, 0
    v_writelane_b32 v124, s78, 0
L_jp_89:
    ds_write_addtid_b32 v27 offset:22176
    v_mul_f32 v74, v79, v69
    v_mul_f32 v75, v79, v68
    v_mul_f32 v76, v81, v69
    v_mul_f32 v77, v81, v68
    v_fma_f32 v74, v78, v68, -v74
    v_fmac_f32 v75, v78, v69
    v_fma_f32 v76, v80, v68, -v76
    v_fmac_f32 v77, v80, v69
    v_cvt_pk_bf16_f32 v28, v78, -v79
    v_cvt_pk_bf16_f32 v29, v80, -v81
    ds_write_addtid_b32 v28 offset:22704
    ds_write_addtid_b32 v29 offset:23232
    v_mul_f32 v78, v75, v69
    v_mul_f32 v79, v75, v68
    v_mul_f32 v80, v77, v69
    v_mul_f32 v81, v77, v68
    v_fma_f32 v78, v74, v68, -v78
    v_fmac_f32 v79, v74, v69
    v_fma_f32 v80, v76, v68, -v80
    v_fmac_f32 v81, v76, v69
    v_cvt_pk_bf16_f32 v26, v74, -v75
    v_cvt_pk_bf16_f32 v27, v76, -v77
    ds_write_addtid_b32 v26 offset:23760
    s_cmp_ge_u32 s61, 3
    s_cbranch_scc1 L_jp_90
    s_waitcnt lgkmcnt(0)
    v_mfma_f32_16x16x32_bf16 v[124:127], v[92:95], v[108:111], v[124:127]
    v_mfma_f32_16x16x32_bf16 v[124:127], v[96:99], v[112:115], v[124:127]
    v_mfma_f32_16x16x32_bf16 v[124:127], v[100:103], v[116:119], v[124:127]
    v_mfma_f32_16x16x32_bf16 v[124:127], v[104:107], v[120:123], v[124:127]
    ds_read_b128 v[92:95], v4 offset:256
    ds_read_b128 v[108:111], v5 offset:21904
    ds_read_b128 v[96:99], v4 offset:320
    ds_read_b128 v[112:115], v5 offset:21968
    ds_read_b128 v[100:103], v4 offset:384
    ds_read_b128 v[116:119], v5 offset:22032
    ds_read_b128 v[104:107], v4 offset:448
    ds_read_b128 v[120:123], v5 offset:22096
L_jp_90:
    ds_write_addtid_b32 v27 offset:24288
    v_mul_f32 v74, v79, v69
    v_mul_f32 v75, v79, v68
    v_mul_f32 v76, v81, v69
    v_mul_f32 v77, v81, v68
    v_fma_f32 v74, v78, v68, -v74
    v_fmac_f32 v75, v78, v69
    v_fma_f32 v76, v80, v68, -v76
    v_fmac_f32 v77, v80, v69
    v_cvt_pk_bf16_f32 v28, v78, -v79
    v_cvt_pk_bf16_f32 v29, v80, -v81
    ds_write_addtid_b32 v28 offset:24816
    ds_write_addtid_b32 v29 offset:25344
    v_mul_f32 v78, v75, v69
    v_mul_f32 v79, v75, v68
    v_mul_f32 v80, v77, v69
    v_mul_f32 v81, v77, v68
    v_fma_f32 v78, v74, v68, -v78
    v_fmac_f32 v79, v74, v69
    v_fma_f32 v80, v76, v68, -v80
    v_fmac_f32 v81, v76, v69
    v_cvt_pk_bf16_f32 v26, v74, -v75
    v_cvt_pk_bf16_f32 v27, v76, -v77
    ds_write_addtid_b32 v26 offset:25872
    ds_write_addtid_b32 v27 offset:26400
    s_cmp_ge_u32 s61, 3
    s_cbranch_scc1 L_jp_91
    s_waitcnt lgkmcnt(0)
    v_mfma_f32_16x16x32_bf16 v[124:127], v[92:95], v[108:111], v[124:127]
    v_mfma_f32_16x16x32_bf16 v[124:127], v[96:99], v[112:115], v[124:127]
    v_mfma_f32_16x16x32_bf16 v[124:127], v[100:103], v[116:119], v[124:127]
    v_mfma_f32_16x16x32_bf16 v[124:127], v[104:107], v[120:123], v[124:127]
    s_cmp_eq_u32 s61, 0
    s_cselect_b64 s[84:85], -1, 0
    v_add_u32 v6, 4, v17
    v_cndmask_b32_e64 v7, v19, v6, s[84:85]
    v_cndmask_b32_e64 v6, v18, v17, s[84:85]
    s_nop 2
    v_cvt_pk_bf16_f32 v124, v124, v125
    v_cvt_pk_bf16_f32 v126, v126, v127
    s_cmp_eq_u32 s61, 2
    s_cbranch_scc1 L_jp_92
    ds_write_b32 v6, v124 offset:1552
    ds_write_b32 v7, v126 offset:1552
    s_branch L_jp_91
L_jp_92:
    ds_write_b16 v20, v124 offset:1552
    ds_write_b16_d16_hi v20, v124 offset:1584
    ds_write_b16 v20, v126 offset:1616
    ds_write_b16_d16_hi v20, v126 offset:1648
L_jp_91:
    v_mul_f32 v74, v79, v69
    v_mul_f32 v75, v79, v68
    v_mul_f32 v76, v81, v69
    v_mul_f32 v77, v81, v68
    v_fma_f32 v74, v78, v68, -v74
    v_fmac_f32 v75, v78, v69
    v_fma_f32 v76, v80, v68, -v76
    v_fmac_f32 v77, v80, v69
    v_cvt_pk_bf16_f32 v28, v78, -v79
    v_cvt_pk_bf16_f32 v29, v80, -v81
    ds_write_addtid_b32 v28 offset:26928
    ds_write_addtid_b32 v29 offset:27456
    v_mul_f32 v78, v75, v69
    v_mul_f32 v79, v75, v68
    v_mul_f32 v80, v77, v69
    v_mul_f32 v81, v77, v68
    v_fma_f32 v78, v74, v68, -v78
    v_fmac_f32 v79, v74, v69
    v_fma_f32 v80, v76, v68, -v80
    v_fmac_f32 v81, v76, v69
    v_cvt_pk_bf16_f32 v26, v74, -v75
    v_cvt_pk_bf16_f32 v27, v76, -v77
    ds_write_addtid_b32 v26 offset:27984
    ds_write_addtid_b32 v27 offset:28512
    v_cvt_pk_bf16_f32 v28, v78, -v79
    v_cvt_pk_bf16_f32 v29, v80, -v81
    ds_write_addtid_b32 v28 offset:29040
    ds_write_addtid_b32 v29 offset:29568
    s_branch L_kg_done_88
L_kg_85:
    v_lshlrev_b32 v24, 16, v52
    v_lshlrev_b32 v25, 16, v53
    v_mul_f32 v24, v24, v39
    v_mul_f32 v25, v25, v39
    v_mul_f32 v30, 0x3fb8aa3b, v24
    v_mul_f32 v31, 0x3e22f983, v25
    v_mul_f32 v32, 0x4338aa3b, v24
    v_mul_f32 v33, 0x41a2f983, v25
    v_fract_f32 v31, v31
    v_exp_f32 v30, v30
    v_fract_f32 v33, v33
    v_exp_f32 v32, v32
    v_cos_f32 v68, v31
    v_sin_f32 v69, v31
    v_cos_f32 v82, v33
    v_sin_f32 v83, v33
    v_mov_b32 v29, 0x3f80
    ds_write_addtid_b32 v29 offset:0
    v_mul_f32 v68, v68, v30
    v_mul_f32 v69, v69, v30
    v_mul_f32 v82, v82, v32
    v_mul_f32 v83, v83, v32
    v_mul_f32 v70, v69, v69
    v_mul_f32 v71, v69, v68
    v_mul_f32 v84, v83, v69
    v_mul_f32 v85, v83, v68
    v_fma_f32 v70, v68, v68, -v70
    v_fmac_f32 v71, v68, v69
    v_fma_f32 v84, v82, v68, -v84
    v_fmac_f32 v85, v82, v69
    v_cvt_pk_bf16_f32 v26, v68, v69
    v_cvt_pk_bf16_f32 v27, v82, v83
    ds_write_addtid_b32 v26 offset:528
    s_cmp_ge_u32 s61, 3
    s_cbranch_scc1 L_jp_94
    v_add_u32 v5, 30096, v16
    s_mul_i32 s78, s61, 8448
    v_add_u32 v4, s78, v5
    ds_read_b128 v[92:95], v4 offset:0
    ds_read_b128 v[108:111], v5 offset:21648
    ds_read_b128 v[96:99], v4 offset:64
    ds_read_b128 v[112:115], v5 offset:21712
    ds_read_b128 v[100:103], v4 offset:128
    ds_read_b128 v[116:119], v5 offset:21776
    ds_read_b128 v[104:107], v4 offset:192
    ds_read_b128 v[120:123], v5 offset:21840
    s_lshr_b64 s[82:83], s[72:73], 16
    s_lshl_b32 s78, s82, 16
    s_cmp_eq_u32 s61, 0
    s_cselect_b32 s78, s78, 0
    v_mov_b32 v124, 0
    v_mov_b32 v125, 0
    v_mov_b32 v126, 0
    v_mov_b32 v127, 0
    v_writelane_b32 v124, s78, 0
L_jp_94:
    ds_write_addtid_b32 v27 offset:4224
    v_mul_f32 v72, v71, v69
    v_mul_f32 v73, v71, v68
    v_mul_f32 v74, v71, v71
    v_mul_f32 v75, v71, v70
    v_mul_f32 v86, v83, v71
    v_mul_f32 v87, v83, v70
    v_fma_f32 v72, v70, v68, -v72
    v_fmac_f32 v73, v70, v69
    v_fma_f32 v74, v70, v70, -v74
    v_fmac_f32 v75, v70, v71
    v_fma_f32 v86, v82, v70, -v86
    v_fmac_f32 v87, v82, v71
    v_cvt_pk_bf16_f32 v28, v70, v71
    v_cvt_pk_bf16_f32 v29, v84, v85
    ds_write_addtid_b32 v28 offset:1056
    ds_write_addtid_b32 v29 offset:4752
    v_mul_f32 v76, v75, v69
    v_mul_f32 v77, v75, v68
    v_mul_f32 v78, v75, v71
    v_mul_f32 v79, v75, v70
    v_mul_f32 v80, v75, v73
    v_mul_f32 v81, v75, v72
    v_mul_f32 v88, v83, v73
    v_mul_f32 v89, v83, v72
    v_mul_f32 v90, v83, v75
    v_mul_f32 v91, v83, v74
    v_fma_f32 v76, v74, v68, -v76
    v_fmac_f32 v77, v74, v69
    v_fma_f32 v78, v74, v70, -v78
    v_fmac_f32 v79, v74, v71
    v_fma_f32 v80, v74, v72, -v80
    v_fmac_f32 v81, v74, v73
    v_fma_f32 v88, v82, v72, -v88
    v_fmac_f32 v89, v82, v73
    v_fma_f32 v90, v82, v74, -v90
    v_fmac_f32 v91, v82, v75
    v_cvt_pk_bf16_f32 v26, v72, v73
    v_cvt_pk_bf16_f32 v27, v74, v75
    v_cvt_pk_bf16_f32 v28, v86, v87
    ds_write_addtid_b32 v26 offset:1584
    s_cmp_ge_u32 s61, 3
    s_cbranch_scc1 L_jp_95
    s_waitcnt lgkmcnt(0)
    v_mfma_f32_16x16x32_bf16 v[124:127], v[92:95], v[108:111], v[124:127]
    v_mfma_f32_16x16x32_bf16 v[124:127], v[96:99], v[112:115], v[124:127]
    v_mfma_f32_16x16x32_bf16 v[124:127], v[100:103], v[116:119], v[124:127]
    v_mfma_f32_16x16x32_bf16 v[124:127], v[104:107], v[120:123], v[124:127]
    ds_read_b128 v[92:95], v4 offset:256
    ds_read_b128 v[108:111], v5 offset:21904
    ds_read_b128 v[96:99], v4 offset:320
    ds_read_b128 v[112:115], v5 offset:21968
    ds_read_b128 v[100:103], v4 offset:384
    ds_read_b128 v[116:119], v5 offset:22032
    ds_read_b128 v[104:107], v4 offset:448
    ds_read_b128 v[120:123], v5 offset:22096
L_jp_95:
    ds_write_addtid_b32 v27 offset:2112
    ds_write_addtid_b32 v28 offset:5280
    v_mul_f32 v84, v83, v77
    v_mul_f32 v85, v83, v76
    v_mul_f32 v86, v83, v79
    v_mul_f32 v87, v83, v78
    v_fma_f32 v84, v82, v76, -v84
    v_fmac_f32 v85, v82, v77
    v_fma_f32 v86, v82, v78, -v86
    v_fmac_f32 v87, v82, v79
    v_cvt_pk_bf16_f32 v29, v88, v89
    v_cvt_pk_bf16_f32 v26, v90, v91
    v_cvt_pk_bf16_f32 v27, v76, v77
    ds_write_addtid_b32 v29 offset:5808
    ds_write_addtid_b32 v26 offset:6336
    ds_write_addtid_b32 v27 offset:2640
    s_cmp_ge_u32 s61, 3
    s_cbranch_scc1 L_jp_96
    s_waitcnt lgkmcnt(0)
    v_mfma_f32_16x16x32_bf16 v[124:127], v[92:95], v[108:111], v[124:127]
    v_mfma_f32_16x16x32_bf16 v[124:127], v[96:99], v[112:115], v[124:127]
    v_mfma_f32_16x16x32_bf16 v[124:127], v[100:103], v[116:119], v[124:127]
    v_mfma_f32_16x16x32_bf16 v[124:127], v[104:107], v[120:123], v[124:127]
    s_cmp_eq_u32 s61, 0
    s_cselect_b64 s[84:85], -1, 0
    v_add_u32 v6, 4, v17
    v_cndmask_b32_e64 v7, v19, v6, s[84:85]
    v_cndmask_b32_e64 v6, v18, v17, s[84:85]
    s_nop 2
    v_cvt_pk_bf16_f32 v124, v124, v125
    v_cvt_pk_bf16_f32 v126, v126, v127
    s_cmp_eq_u32 s61, 2
    s_cbranch_scc1 L_jp_97
    ds_write_b32 v6, v124 offset:1552
    ds_write_b32 v7, v126 offset:1552
    s_branch L_jp_96
L_jp_97:
    ds_write_b16 v20, v124 offset:1552
    ds_write_b16_d16_hi v20, v124 offset:1584
    ds_write_b16 v20, v126 offset:1616
    ds_write_b16_d16_hi v20, v126 offset:1648
L_jp_96:
    v_mul_f32 v88, v83, v81
    v_mul_f32 v89, v83, v80
    v_fma_f32 v88, v82, v80, -v88
    v_fmac_f32 v89, v82, v81
    v_cvt_pk_bf16_f32 v28, v78, v79
    v_cvt_pk_bf16_f32 v29, v80, v81
    v_cvt_pk_bf16_f32 v26, v84, v85
    ds_write_addtid_b32 v28 offset:3168
    ds_write_addtid_b32 v29 offset:3696
    ds_write_addtid_b32 v26 offset:6864
    v_cvt_pk_bf16_f32 v27, v86, v87
    v_cvt_pk_bf16_f32 v28, v88, v89
    ds_write_addtid_b32 v27 offset:7392
    ds_write_addtid_b32 v28 offset:7920
    s_branch L_kg_done_88
L_kg_86:
    v_lshlrev_b32 v24, 16, v52
    v_lshlrev_b32 v25, 16, v53
    v_mul_f32 v24, v24, v39
    v_mul_f32 v25, v25, v39
    v_mul_f32 v30, 0x4038aa3b, v24
    v_mul_f32 v31, 0x3ea2f983, v25
    v_mul_f32 v32, 0x4338aa3b, v24
    v_mul_f32 v33, 0x41a2f983, v25
    v_fract_f32 v31, v31
    v_exp_f32 v30, v30
    v_fract_f32 v33, v33
    v_exp_f32 v32, v32
    v_cos_f32 v66, v31
    v_sin_f32 v67, v31
    v_cos_f32 v72, v33
    v_sin_f32 v73, v33
    s_nop 0
    v_mul_f32 v66, v66, v30
    v_mul_f32 v67, v67, v30
    v_mul_f32 v72, v72, v32
    v_mul_f32 v73, v73, v32
    v_mul_f32 v68, v67, v67
    v_mul_f32 v69, v67, v66
    v_mul_f32 v74, v73, v73
    v_mul_f32 v75, v73, v72
    v_fma_f32 v68, v66, v66, -v68
    v_fmac_f32 v69, v66, v67
    v_fma_f32 v74, v72, v72, -v74
    v_fmac_f32 v75, v72, v73
    v_mul_f32 v70, v69, v67
    v_mul_f32 v71, v69, v66
    v_mul_f32 v76, v75, v73
    v_mul_f32 v77, v75, v72
    v_mul_f32 v78, v75, v75
    v_mul_f32 v79, v75, v74
    v_mul_f32 v82, v75, v67
    v_mul_f32 v83, v75, v66
    v_mul_f32 v84, v75, v69
    v_mul_f32 v85, v75, v68
    v_fma_f32 v70, v68, v66, -v70
    v_fmac_f32 v71, v68, v67
    v_fma_f32 v76, v74, v72, -v76
    v_fmac_f32 v77, v74, v73
    v_fma_f32 v78, v74, v74, -v78
    v_fmac_f32 v79, v74, v75
    v_fma_f32 v82, v74, v66, -v82
    v_fmac_f32 v83, v74, v67
    v_fma_f32 v84, v74, v68, -v84
    v_fmac_f32 v85, v74, v69
    v_cvt_pk_bf16_f32 v29, v74, v75
    ds_write_addtid_b32 v29 offset:8448
    s_cmp_ge_u32 s61, 3
    s_cbranch_scc1 L_jp_99
    v_add_u32 v5, 30096, v16
    s_mul_i32 s78, s61, 8448
    v_add_u32 v4, s78, v5
    ds_read_b128 v[92:95], v4 offset:0
    ds_read_b128 v[108:111], v5 offset:21648
    ds_read_b128 v[96:99], v4 offset:64
    ds_read_b128 v[112:115], v5 offset:21712
    ds_read_b128 v[100:103], v4 offset:128
    ds_read_b128 v[116:119], v5 offset:21776
    ds_read_b128 v[104:107], v4 offset:192
    ds_read_b128 v[120:123], v5 offset:21840
    s_lshr_b64 s[82:83], s[72:73], 16
    s_lshl_b32 s78, s82, 16
    s_cmp_eq_u32 s61, 0
    s_cselect_b32 s78, s78, 0
    v_mov_b32 v124, 0
    v_mov_b32 v125, 0
    v_mov_b32 v126, 0
    v_mov_b32 v127, 0
    v_writelane_b32 v124, s78, 0
L_jp_99:
    v_mul_f32 v86, v75, v71
    v_mul_f32 v87, v75, v70
    v_mul_f32 v88, v77, v67
    v_mul_f32 v89, v77, v66
    v_mul_f32 v80, v79, v73
    v_mul_f32 v81, v79, v72
    v_fma_f32 v86, v74, v70, -v86
    v_fmac_f32 v87, v74, v71
    v_fma_f32 v88, v76, v66, -v88
    v_fmac_f32 v89, v76, v67
    v_fma_f32 v80, v78, v72, -v80
    v_fmac_f32 v81, v78, v73
    v_cvt_pk_bf16_f32 v26, v82, v83
    v_cvt_pk_bf16_f32 v27, v84, v85
    v_cvt_pk_bf16_f32 v28, v76, v77
    v_cvt_pk_bf16_f32 v29, v78, v79
    ds_write_addtid_b32 v26 offset:8976
    ds_write_addtid_b32 v27 offset:9504
    ds_write_addtid_b32 v28 offset:10560
    ds_write_addtid_b32 v29 offset:12672
    s_cmp_ge_u32 s61, 3
    s_cbranch_scc1 L_jp_100
    s_waitcnt lgkmcnt(0)
    v_mfma_f32_16x16x32_bf16 v[124:127], v[92:95], v[108:111], v[124:127]
    v_mfma_f32_16x16x32_bf16 v[124:127], v[96:99], v[112:115], v[124:127]
    v_mfma_f32_16x16x32_bf16 v[124:127], v[100:103], v[116:119], v[124:127]
    v_mfma_f32_16x16x32_bf16 v[124:127], v[104:107], v[120:123], v[124:127]
    ds_read_b128 v[92:95], v4 offset:256
    ds_read_b128 v[108:111], v5 offset:21904
    ds_read_b128 v[96:99], v4 offset:320
    ds_read_b128 v[112:115], v5 offset:21968
    ds_read_b128 v[100:103], v4 offset:384
    ds_read_b128 v[116:119], v5 offset:22032
    ds_read_b128 v[104:107], v4 offset:448
    ds_read_b128 v[120:123], v5 offset:22096
L_jp_100:
    v_mul_f32 v82, v77, v69
    v_mul_f32 v83, v77, v68
    v_mul_f32 v84, v77, v71
    v_mul_f32 v85, v77, v70
    v_mul_f32 v66, v79, v69
    v_mul_f32 v67, v79, v68
    v_mul_f32 v72, v81, v69
    v_mul_f32 v73, v81, v68
    v_fma_f32 v82, v76, v68, -v82
    v_fmac_f32 v83, v76, v69
    v_fma_f32 v84, v76, v70, -v84
    v_fmac_f32 v85, v76, v71
    v_fma_f32 v66, v78, v68, -v66
    v_fmac_f32 v67, v78, v69
    v_fma_f32 v72, v80, v68, -v72
    v_fmac_f32 v73, v80, v69
    v_cvt_pk_bf16_f32 v26, v86, v87
    v_cvt_pk_bf16_f32 v27, v88, v89
    v_cvt_pk_bf16_f32 v28, v80, v81
    ds_write_addtid_b32 v26 offset:10032
    ds_write_addtid_b32 v27 offset:11088
    ds_write_addtid_b32 v28 offset:13728
    v_cvt_pk_bf16_f32 v29, v82, v83
    v_cvt_pk_bf16_f32 v26, v84, v85
    v_cvt_pk_bf16_f32 v27, v66, v67
    v_cvt_pk_bf16_f32 v28, v72, v73
    ds_write_addtid_b32 v29 offset:11616
    ds_write_addtid_b32 v26 offset:12144
    s_cmp_ge_u32 s61, 3
    s_cbranch_scc1 L_jp_101
    s_waitcnt lgkmcnt(0)
    v_mfma_f32_16x16x32_bf16 v[124:127], v[92:95], v[108:111], v[124:127]
    v_mfma_f32_16x16x32_bf16 v[124:127], v[96:99], v[112:115], v[124:127]
    v_mfma_f32_16x16x32_bf16 v[124:127], v[100:103], v[116:119], v[124:127]
    v_mfma_f32_16x16x32_bf16 v[124:127], v[104:107], v[120:123], v[124:127]
    s_cmp_eq_u32 s61, 0
    s_cselect_b64 s[84:85], -1, 0
    v_add_u32 v6, 4, v17
    v_cndmask_b32_e64 v7, v19, v6, s[84:85]
    v_cndmask_b32_e64 v6, v18, v17, s[84:85]
    s_nop 2
    v_cvt_pk_bf16_f32 v124, v124, v125
    v_cvt_pk_bf16_f32 v126, v126, v127
    s_cmp_eq_u32 s61, 2
    s_cbranch_scc1 L_jp_102
    ds_write_b32 v6, v124 offset:1552
    ds_write_b32 v7, v126 offset:1552
    s_branch L_jp_101
L_jp_102:
    ds_write_b16 v20, v124 offset:1552
    ds_write_b16_d16_hi v20, v124 offset:1584
    ds_write_b16 v20, v126 offset:1616
    ds_write_b16_d16_hi v20, v126 offset:1648
L_jp_101:
    ds_write_addtid_b32 v27 offset:13200
    ds_write_addtid_b32 v28 offset:14256
    s_branch L_kg_done_88
L_kg_87:
    v_lshlrev_b32 v24, 16, v52
    v_lshlrev_b32 v25, 16, v53
    v_mul_f32 v24, v24, v39
    v_mul_f32 v25, v25, v39
    v_mul_f32 v30, 0x40b8aa3b, v24
    v_mul_f32 v31, 0x3f22f983, v25
    v_mul_f32 v32, 0x4338aa3b, v24
    v_mul_f32 v33, 0x41a2f983, v25
    v_mul_f32 v34, 0x44b8aa3b, v24
    v_mul_f32 v35, 0x4322f983, v25
    v_fract_f32 v31, v31
    v_exp_f32 v30, v30
    v_fract_f32 v33, v33
    v_exp_f32 v32, v32
    v_fract_f32 v35, v35
    v_exp_f32 v34, v34
    v_cos_f32 v66, v31
    v_sin_f32 v67, v31
    v_cos_f32 v68, v33
    v_sin_f32 v69, v33
    v_cos_f32 v72, v35
    v_sin_f32 v73, v35
    v_mul_f32 v66, v66, v30
    v_mul_f32 v67, v67, v30
    v_mul_f32 v68, v68, v32
    v_mul_f32 v69, v69, v32
    v_mul_f32 v72, v72, v34
    v_mul_f32 v73, v73, v34
    v_mul_f32 v70, v69, v69
    v_mul_f32 v71, v69, v68
    v_mul_f32 v74, v73, v69
    v_mul_f32 v75, v73, v68
    v_mul_f32 v78, v73, v73
    v_mul_f32 v79, v73, v72
    v_fma_f32 v70, v68, v68, -v70
    v_fmac_f32 v71, v68, v69
    v_fma_f32 v74, v72, v68, -v74
    v_fmac_f32 v75, v72, v69
    v_fma_f32 v78, v72, v72, -v78
    v_fmac_f32 v79, v72, v73
    v_cvt_pk_bf16_f32 v29, v72, v73
    ds_write_addtid_b32 v29 offset:16896
    s_cmp_ge_u32 s61, 3
    s_cbranch_scc1 L_jp_104
    v_add_u32 v5, 30096, v16
    s_mul_i32 s78, s61, 8448
    v_add_u32 v4, s78, v5
    ds_read_b128 v[92:95], v4 offset:0
    ds_read_b128 v[108:111], v5 offset:21648
    ds_read_b128 v[96:99], v4 offset:64
    ds_read_b128 v[112:115], v5 offset:21712
    ds_read_b128 v[100:103], v4 offset:128
    ds_read_b128 v[116:119], v5 offset:21776
    ds_read_b128 v[104:107], v4 offset:192
    ds_read_b128 v[120:123], v5 offset:21840
    s_lshr_b64 s[82:83], s[72:73], 16
    s_lshl_b32 s78, s82, 16
    s_cmp_eq_u32 s61, 0
    s_cselect_b32 s78, s78, 0
    v_mov_b32 v124, 0
    v_mov_b32 v125, 0
    v_mov_b32 v126, 0
    v_mov_b32 v127, 0
    v_writelane_b32 v124, s78, 0
L_jp_104:
    v_mul_f32 v76, v73, v71
    v_mul_f32 v77, v73, v70
    v_mul_f32 v80, v75, v71
    v_mul_f32 v81, v75, v70
    v_mul_f32 v82, v71, v71
    v_mul_f32 v83, v71, v70
    v_fma_f32 v76, v72, v70, -v76
    v_fmac_f32 v77, v72, v71
    v_fma_f32 v80, v74, v70, -v80
    v_fmac_f32 v81, v74, v71
    v_fma_f32 v82, v70, v70, -v82
    v_fmac_f32 v83, v70, v71
    v_cvt_pk_bf16_f32 v26, v74, v75
    v_cvt_pk_bf16_f32 v27, v78, v79
    ds_write_addtid_b32 v26 offset:17424
    ds_write_addtid_b32 v27 offset:21120
    v_mul_f32 v84, v83, v71
    v_mul_f32 v85, v83, v70
    v_mul_f32 v78, v77, v71
    v_mul_f32 v79, v77, v70
    v_mul_f32 v74, v81, v71
    v_mul_f32 v75, v81, v70
    v_fma_f32 v84, v82, v70, -v84
    v_fmac_f32 v85, v82, v71
    v_fma_f32 v78, v76, v70, -v78
    v_fmac_f32 v79, v76, v71
    v_fma_f32 v74, v80, v70, -v74
    v_fmac_f32 v75, v80, v71
    v_cvt_pk_bf16_f32 v28, v76, v77
    v_cvt_pk_bf16_f32 v29, v80, v81
    ds_write_addtid_b32 v28 offset:17952
    ds_write_addtid_b32 v29 offset:18480
    s_cmp_ge_u32 s61, 3
    s_cbranch_scc1 L_jp_105
    s_waitcnt lgkmcnt(0)
    v_mfma_f32_16x16x32_bf16 v[124:127], v[92:95], v[108:111], v[124:127]
    v_mfma_f32_16x16x32_bf16 v[124:127], v[96:99], v[112:115], v[124:127]
    v_mfma_f32_16x16x32_bf16 v[124:127], v[100:103], v[116:119], v[124:127]
    v_mfma_f32_16x16x32_bf16 v[124:127], v[104:107], v[120:123], v[124:127]
    ds_read_b128 v[92:95], v4 offset:256
    ds_read_b128 v[108:111], v5 offset:21904
    ds_read_b128 v[96:99], v4 offset:320
    ds_read_b128 v[112:115], v5 offset:21968
    ds_read_b128 v[100:103], v4 offset:384
    ds_read_b128 v[116:119], v5 offset:22032
    ds_read_b128 v[104:107], v4 offset:448
    ds_read_b128 v[120:123], v5 offset:22096
L_jp_105:
    v_mul_f32 v86, v85, v69
    v_mul_f32 v87, v85, v68
    v_mul_f32 v82, v85, v67
    v_mul_f32 v83, v85, v66
    v_mul_f32 v76, v79, v71
    v_mul_f32 v77, v79, v70
    v_mul_f32 v80, v75, v71
    v_mul_f32 v81, v75, v70
    v_fma_f32 v86, v84, v68, -v86
    v_fmac_f32 v87, v84, v69
    v_fma_f32 v82, v84, v66, -v82
    v_fmac_f32 v83, v84, v67
    v_fma_f32 v76, v78, v70, -v76
    v_fmac_f32 v77, v78, v71
    v_fma_f32 v80, v74, v70, -v80
    v_fmac_f32 v81, v74, v71
    v_cvt_pk_bf16_f32 v26, v78, v79
    v_cvt_pk_bf16_f32 v27, v74, v75
    v_cvt_pk_bf16_f32 v28, v84, v85
    ds_write_addtid_b32 v26 offset:19008
    ds_write_addtid_b32 v27 offset:19536
    ds_write_addtid_b32 v28 offset:14784
    v_mul_f32 v78, v87, v67
    v_mul_f32 v79, v87, v66
    v_fma_f32 v78, v86, v66, -v78
    v_fmac_f32 v79, v86, v67
    v_cvt_pk_bf16_f32 v29, v82, v83
    v_cvt_pk_bf16_f32 v26, v76, v77
    v_cvt_pk_bf16_f32 v27, v80, v81
    v_cvt_pk_bf16_f32 v28, v86, v87
    ds_write_addtid_b32 v29 offset:15312
    ds_write_addtid_b32 v26 offset:20064
    s_cmp_ge_u32 s61, 3
    s_cbranch_scc1 L_jp_106
    s_waitcnt lgkmcnt(0)
    v_mfma_f32_16x16x32_bf16 v[124:127], v[92:95], v[108:111], v[124:127]
    v_mfma_f32_16x16x32_bf16 v[124:127], v[96:99], v[112:115], v[124:127]
    v_mfma_f32_16x16x32_bf16 v[124:127], v[100:103], v[116:119], v[124:127]
    v_mfma_f32_16x16x32_bf16 v[124:127], v[104:107], v[120:123], v[124:127]
    s_cmp_eq_u32 s61, 0
    s_cselect_b64 s[84:85], -1, 0
    v_add_u32 v6, 4, v17
    v_cndmask_b32_e64 v7, v19, v6, s[84:85]
    v_cndmask_b32_e64 v6, v18, v17, s[84:85]
    s_nop 2
    v_cvt_pk_bf16_f32 v124, v124, v125
    v_cvt_pk_bf16_f32 v126, v126, v127
    s_cmp_eq_u32 s61, 2
    s_cbranch_scc1 L_jp_107
    ds_write_b32 v6, v124 offset:1552
    ds_write_b32 v7, v126 offset:1552
    s_branch L_jp_106
L_jp_107:
    ds_write_b16 v20, v124 offset:1552
    ds_write_b16_d16_hi v20, v124 offset:1584
    ds_write_b16 v20, v126 offset:1616
    ds_write_b16_d16_hi v20, v126 offset:1648
L_jp_106:
    ds_write_addtid_b32 v27 offset:20592
    ds_write_addtid_b32 v28 offset:15840
    v_cvt_pk_bf16_f32 v29, v78, v79
    ds_write_addtid_b32 v29 offset:16368
L_kg_done_88:
    s_waitcnt vmcnt(0)
    s_waitcnt lgkmcnt(0)
    s_barrier
    s_cmp_ge_u32 s61, 4
    s_cbranch_scc1 L_j2_109
    s_cmp_ge_u32 s61, 3
    s_cbranch_scc1 L_jp_112
    v_add_u32 v5, 0, v16
    s_mul_i32 s78, s61, 8448
    v_add_u32 v4, s78, v5
    ds_read_b128 v[92:95], v4 offset:0
    ds_read_b128 v[108:111], v5 offset:21648
    ds_read_b128 v[96:99], v4 offset:64
    ds_read_b128 v[112:115], v5 offset:21712
    ds_read_b128 v[100:103], v4 offset:128
    ds_read_b128 v[116:119], v5 offset:21776
    ds_read_b128 v[104:107], v4 offset:192
    ds_read_b128 v[120:123], v5 offset:21840
    s_lshr_b64 s[82:83], s[72:73], 32
    s_lshl_b32 s78, s82, 16
    s_cmp_eq_u32 s61, 0
    s_cselect_b32 s78, s78, 0
    v_mov_b32 v124, 0
    v_mov_b32 v125, 0
    v_mov_b32 v126, 0
    v_mov_b32 v127, 0
    v_writelane_b32 v124, s78, 0
L_jp_112:
    s_cmp_ge_u32 s61, 3
    s_cbranch_scc1 L_jp_113
    s_waitcnt lgkmcnt(0)
    v_mfma_f32_16x16x32_bf16 v[124:127], v[92:95], v[108:111], v[124:127]
    v_mfma_f32_16x16x32_bf16 v[124:127], v[96:99], v[112:115], v[124:127]
    v_mfma_f32_16x16x32_bf16 v[124:127], v[100:103], v[116:119], v[124:127]
    v_mfma_f32_16x16x32_bf16 v[124:127], v[104:107], v[120:123], v[124:127]
    ds_read_b128 v[92:95], v4 offset:256
    ds_read_b128 v[108:111], v5 offset:21904
    ds_read_b128 v[96:99], v4 offset:320
    ds_read_b128 v[112:115], v5 offset:21968
    ds_read_b128 v[100:103], v4 offset:384
    ds_read_b128 v[116:119], v5 offset:22032
    ds_read_b128 v[104:107], v4 offset:448
    ds_read_b128 v[120:123], v5 offset:22096
L_jp_113:
    s_cmp_ge_u32 s61, 3
    s_cbranch_scc1 L_jp_114
    s_waitcnt lgkmcnt(0)
    v_mfma_f32_16x16x32_bf16 v[124:127], v[92:95], v[108:111], v[124:127]
    v_mfma_f32_16x16x32_bf16 v[124:127], v[96:99], v[112:115], v[124:127]
    v_mfma_f32_16x16x32_bf16 v[124:127], v[100:103], v[116:119], v[124:127]
    v_mfma_f32_16x16x32_bf16 v[124:127], v[104:107], v[120:123], v[124:127]
    s_cmp_eq_u32 s61, 0
    s_cselect_b64 s[84:85], -1, 0
    v_add_u32 v6, 4, v17
    v_cndmask_b32_e64 v7, v19, v6, s[84:85]
    v_cndmask_b32_e64 v6, v18, v17, s[84:85]
    s_nop 2
    v_cvt_pk_bf16_f32 v124, v124, v125
    v_cvt_pk_bf16_f32 v126, v126, v127
    s_cmp_eq_u32 s61, 2
    s_cbranch_scc1 L_jp_115
    ds_write_b32 v6, v124 offset:3104
    ds_write_b32 v7, v126 offset:3104
    s_branch L_jp_114
L_jp_115:
    ds_write_b16 v20, v124 offset:3104
    ds_write_b16_d16_hi v20, v124 offset:3136
    ds_write_b16 v20, v126 offset:3168
    ds_write_b16_d16_hi v20, v126 offset:3200
L_jp_114:
    s_branch L_jx_111
L_j2_109:
    ds_read_u16 v75, v40 offset:0
    ds_read_u16 v76, v41 offset:0
    ds_read_u16 v77, v42 offset:0
    ds_read_u16 v78, v43 offset:0
    ds_read_u16 v79, v44 offset:0
    ds_read_u16 v80, v45 offset:0
    ds_read_u16 v81, v46 offset:0
    ds_read_u16 v82, v47 offset:0
    ds_read_u16 v83, v48 offset:0
    ds_read_u16 v84, v49 offset:0
    ds_read_u16 v85, v50 offset:0
    ds_read_u16 v103, v40 offset:1552
    ds_read_u16 v104, v41 offset:1552
    ds_read_u16 v105, v42 offset:1552
    ds_read_u16 v106, v43 offset:1552
    ds_read_u16 v107, v44 offset:1552
    ds_read_u16 v108, v45 offset:1552
    ds_read_u16 v109, v46 offset:1552
    ds_read_u16 v110, v47 offset:1552
    ds_read_u16 v111, v48 offset:1552
    ds_read_u16 v112, v49 offset:1552
    ds_read_u16 v113, v50 offset:1552
    s_waitcnt lgkmcnt(15)
    v_lshl_or_b32 v70, v76, 16, v75
    v_lshl_or_b32 v71, v78, 16, v77
    v_lshl_or_b32 v72, v80, 16, v79
    s_waitcnt lgkmcnt(14)
    v_lshl_or_b32 v73, v82, 16, v81
    ds_write_b128 v51, v[70:73] offset:43056
    v_lshl_or_b32 v66, v77, 16, v76
    v_lshl_or_b32 v67, v79, 16, v78
    v_lshl_or_b32 v68, v81, 16, v80
    s_waitcnt lgkmcnt(14)
    v_lshl_or_b32 v69, v83, 16, v82
    ds_write_b128 v51, v[66:69] offset:38896
    v_mov_b32 v62, v71
    v_mov_b32 v63, v72
    v_mov_b32 v64, v73
    s_waitcnt lgkmcnt(14)
    v_lshl_or_b32 v65, v84, 16, v83
    ds_write_b128 v51, v[62:65] offset:34736
    v_mov_b32 v58, v67
    v_mov_b32 v59, v68
    v_mov_b32 v60, v69
    s_waitcnt lgkmcnt(14)
    v_lshl_or_b32 v61, v85, 16, v84
    ds_write_b128 v51, v[58:61] offset:30576
    s_waitcnt lgkmcnt(13)
    v_lshl_or_b32 v98, v104, 16, v103
    s_waitcnt lgkmcnt(11)
    v_lshl_or_b32 v99, v106, 16, v105
    s_waitcnt lgkmcnt(9)
    v_lshl_or_b32 v100, v108, 16, v107
    s_waitcnt lgkmcnt(7)
    v_lshl_or_b32 v101, v110, 16, v109
    ds_write_b128 v51, v[98:101] offset:59696
    v_lshl_or_b32 v94, v105, 16, v104
    v_lshl_or_b32 v95, v107, 16, v106
    v_lshl_or_b32 v96, v109, 16, v108
    s_waitcnt lgkmcnt(7)
    v_lshl_or_b32 v97, v111, 16, v110
    ds_write_b128 v51, v[94:97] offset:55536
    v_mov_b32 v90, v99
    v_mov_b32 v91, v100
    v_mov_b32 v92, v101
    s_waitcnt lgkmcnt(7)
    v_lshl_or_b32 v93, v112, 16, v111
    ds_write_b128 v51, v[90:93] offset:51376
    v_mov_b32 v86, v95
    v_mov_b32 v87, v96
    v_mov_b32 v88, v97
    s_waitcnt lgkmcnt(7)
    v_lshl_or_b32 v89, v113, 16, v112
    ds_write_b128 v51, v[86:89] offset:47216
L_jx_111:
    s_cmp_ge_u32 s61, 6
    s_cbranch_scc1 L_uti_117
    v_lshlrev_b32 v9, 4, v0
    s_mul_i32 s88, s62, 5504
    s_add_u32 s88, s88, 9437184
    s_add_u32 s89, s88, 5504
    s_add_u32 s90, s89, 5504
    s_cmp_eq_u32 s61, 5
    s_cselect_b32 exec_lo, 0xffffff, -1
    s_cselect_b32 exec_hi, 0, -1
    buffer_load_dwordx4 v[116:119], v9, s[52:55], s88 offen sc0 sc1
    buffer_load_dwordx4 v[120:123], v9, s[52:55], s89 offen sc0 sc1
    buffer_load_dwordx4 v[124:127], v9, s[52:55], s90 offen sc0 sc1
    s_mov_b64 exec, -1
L_uti_117:
    s_waitcnt lgkmcnt(0)
    s_barrier
    s_cmp_ge_u32 s61, 4
    s_cbranch_scc1 L_zf_110
    ds_read_u16 v75, v40 offset:3104
    ds_read_u16 v76, v41 offset:3104
    ds_read_u16 v77, v42 offset:3104
    ds_read_u16 v78, v43 offset:3104
    ds_read_u16 v79, v44 offset:3104
    ds_read_u16 v80, v45 offset:3104
    ds_read_u16 v81, v46 offset:3104
    ds_read_u16 v82, v47 offset:3104
    ds_read_u16 v83, v48 offset:3104
    ds_read_u16 v84, v49 offset:3104
    ds_read_u16 v85, v50 offset:3104
    s_waitcnt lgkmcnt(9)
    v_lshl_or_b32 v70, v76, 16, v75
    s_waitcnt lgkmcnt(7)
    v_lshl_or_b32 v71, v78, 16, v77
    s_waitcnt lgkmcnt(5)
    v_lshl_or_b32 v72, v80, 16, v79
    s_waitcnt lgkmcnt(3)
    v_lshl_or_b32 v73, v82, 16, v81
    ds_write_b128 v51, v[70:73] offset:12480
    v_lshl_or_b32 v66, v77, 16, v76
    v_lshl_or_b32 v67, v79, 16, v78
    v_lshl_or_b32 v68, v81, 16, v80
    s_waitcnt lgkmcnt(3)
    v_lshl_or_b32 v69, v83, 16, v82
    ds_write_b128 v51, v[66:69] offset:8320
    v_mov_b32 v62, v71
    v_mov_b32 v63, v72
    v_mov_b32 v64, v73
    s_waitcnt lgkmcnt(3)
    v_lshl_or_b32 v65, v84, 16, v83
    ds_write_b128 v51, v[62:65] offset:4160
    v_mov_b32 v58, v67
    v_mov_b32 v59, v68
    v_mov_b32 v60, v69
    s_waitcnt lgkmcnt(3)
    v_lshl_or_b32 v61, v85, 16, v84
    ds_write_b128 v51, v[58:61] offset:0
    s_branch L_jx_118
L_zf_110:
    s_cmp_lg_u32 s61, 7
    s_cbranch_scc1 L_jx_118
    v_mov_b32 v110, 0
    v_mov_b32 v111, 0
    v_mov_b32 v112, 0
    v_mov_b32 v113, 0
    v_mul_u32_u24 v4, 4160, v1
    v_lshlrev_b32 v5, 4, v1
    s_mov_b32 exec_lo, 0xff
    s_mov_b32 exec_hi, 0x0
    ds_write_b128 v4, v[110:113] offset:34672
    ds_write_b64 v4, v[110:111] offset:34688
    s_mov_b64 exec, 15
    ds_write_b128 v4, v[110:113] offset:4096
    ds_write_b64 v4, v[110:111] offset:4112
    s_mov_b32 exec_lo, 0xffffffff
    s_mov_b32 exec_hi, 0x0
    ds_write_b128 v5, v[110:113] offset:16640
    ds_write_b128 v5, v[110:113] offset:21280
    ds_write_b128 v5, v[110:113] offset:25920
    s_mov_b64 exec, -1
L_jx_118:
    s_cmp_ge_u32 s61, 6
    s_cbranch_scc1 L_utd_119
    s_cmp_eq_u32 s61, 5
    s_cselect_b32 exec_lo, 0xffffff, -1
    s_cselect_b32 exec_hi, 0, -1
    s_mov_b32 s79, 0
L_poll_120:
    s_waitcnt vmcnt(0)
    v_cmp_ne_u32 vcc, s60, v119
    v_cmp_ne_u32 s[82:83], s60, v123
    s_nop 0
    s_or_b64 vcc, vcc, s[82:83]
    v_cmp_ne_u32 s[82:83], s60, v127
    s_nop 0
    s_or_b64 vcc, vcc, s[82:83]
    s_and_b64 exec, exec, vcc
    s_cbranch_execz L_polld_121
    s_add_u32 s79, s79, 1
    s_cmp_gt_u32 s79, 200000
    s_cbranch_scc1 L_polld_121
    s_sleep 4
    buffer_load_dwordx4 v[116:119], v9, s[52:55], s88 offen sc0 sc1
    buffer_load_dwordx4 v[120:123], v9, s[52:55], s89 offen sc0 sc1
    buffer_load_dwordx4 v[124:127], v9, s[52:55], s90 offen sc0 sc1
    s_branch L_poll_120
L_polld_121:
    s_cmp_eq_u32 s61, 5
    s_cselect_b32 exec_lo, 0xffffff, -1
    s_cselect_b32 exec_hi, 0, -1
    v_add_u32 v6, 17152, v36
    ds_write2_b32 v6, v116, v117 offset0:0 offset1:1
    ds_write_b32 v6, v118 offset:8
    v_add_u32 v6, 4640, v6
    ds_write2_b32 v6, v120, v121 offset0:0 offset1:1
    ds_write_b32 v6, v122 offset:8
    v_add_u32 v6, 4640, v6
    ds_write2_b32 v6, v124, v125 offset0:0 offset1:1
    ds_write_b32 v6, v126 offset:8
    s_mov_b64 exec, -1
L_utd_119:
    s_waitcnt lgkmcnt(0)
    s_barrier
    s_setprio 1
    s_cmp_eq_u32 s61, 7
    s_cbranch_scc1 L_c37_123
    s_cmp_eq_u32 s61, 3
    s_cbranch_scc1 L_c3s_122
    s_cmp_ge_u32 s61, 4
    s_cbranch_scc1 L_c30_124
    s_mul_i32 s75, s61, 16640
    s_add_u32 s75, s75, 30576
    s_cmp_eq_u32 s61, 2
    s_cselect_b32 s75, 0, s75
    s_mul_i32 s76, s61, 4640
    s_mul_i32 s77, s61, 4128
    v_add_u32 v124, s75, v21
    v_add_u32 v125, s76, v22
    v_add_u32 v126, s77, v23
    ds_read_b64 v[60:61], v124 offset:4032
    ds_read_b64 v[62:63], v124 offset:4040
    ds_read_b128 v[120:123], v125 offset:4032
    ds_read_b128 v[116:119], v125 offset:3520
    ds_read_b128 v[112:115], v125 offset:3008
    ds_read_b128 v[108:111], v125 offset:2496
    ds_read_b64 v[64:65], v124 offset:3520
    ds_read_b64 v[66:67], v124 offset:3528
    ds_read_b128 v[104:107], v125 offset:1984
    ds_read_b64 v[68:69], v124 offset:3008
    ds_read_b64 v[70:71], v124 offset:3016
    ds_read_b128 v[100:103], v125 offset:1472
    ds_read_b64 v[72:73], v124 offset:2496
    ds_read_b64 v[74:75], v124 offset:2504
    ds_read_b128 v[96:99], v125 offset:960
    ds_read_b64 v[76:77], v124 offset:1984
    ds_read_b64 v[78:79], v124 offset:1992
    ds_read_b128 v[92:95], v125 offset:448
    ds_read_b64 v[80:81], v124 offset:1472
    ds_read_b64 v[82:83], v124 offset:1480
    ds_read_b64 v[84:85], v124 offset:960
    ds_read_b64 v[86:87], v124 offset:968
    ds_read_b64 v[88:89], v124 offset:448
    ds_read_b64 v[90:91], v124 offset:456
    s_waitcnt lgkmcnt(15)
    v_mfma_f32_16x16x32_bf16 v[52:55], v[60:63], v[120:123], 0
    ds_read_b128 v[120:123], v125 offset:3968
    v_mfma_f32_16x16x32_bf16 v[48:51], v[60:63], v[116:119], 0
    v_mfma_f32_16x16x32_bf16 v[44:47], v[60:63], v[112:115], 0
    v_mfma_f32_16x16x32_bf16 v[40:43], v[60:63], v[108:111], 0
    ds_read_b64 v[60:61], v124 offset:3968
    v_mfma_f32_16x16x32_bf16 v[52:55], v[64:67], v[116:119], v[52:55]
    ds_read_b64 v[62:63], v124 offset:3976
    v_mfma_f32_16x16x32_bf16 v[48:51], v[64:67], v[112:115], v[48:51]
    ds_read_b128 v[116:119], v125 offset:3456
    v_mfma_f32_16x16x32_bf16 v[44:47], v[64:67], v[108:111], v[44:47]
    v_mfma_f32_16x16x32_bf16 v[40:43], v[64:67], v[104:107], v[40:43]
    ds_read_b64 v[64:65], v124 offset:3456
    s_waitcnt lgkmcnt(15)
    v_mfma_f32_16x16x32_bf16 v[52:55], v[68:71], v[112:115], v[52:55]
    ds_read_b128 v[112:115], v125 offset:2944
    v_mfma_f32_16x16x32_bf16 v[48:51], v[68:71], v[108:111], v[48:51]
    ds_read_b64 v[66:67], v124 offset:3464
    v_mfma_f32_16x16x32_bf16 v[44:47], v[68:71], v[104:107], v[44:47]
    v_mfma_f32_16x16x32_bf16 v[40:43], v[68:71], v[100:103], v[40:43]
    ds_read_b64 v[68:69], v124 offset:2944
    v_mfma_f32_16x16x32_bf16 v[52:55], v[72:75], v[108:111], v[52:55]
    ds_read_b128 v[108:111], v125 offset:2432
    v_mfma_f32_16x16x32_bf16 v[48:51], v[72:75], v[104:107], v[48:51]
    ds_read_b64 v[70:71], v124 offset:2952
    v_mfma_f32_16x16x32_bf16 v[44:47], v[72:75], v[100:103], v[44:47]
    s_waitcnt lgkmcnt(15)
    v_mfma_f32_16x16x32_bf16 v[40:43], v[72:75], v[96:99], v[40:43]
    ds_read_b64 v[72:73], v124 offset:2432
    v_mfma_f32_16x16x32_bf16 v[52:55], v[76:79], v[104:107], v[52:55]
    ds_read_b128 v[104:107], v125 offset:1920
    v_mfma_f32_16x16x32_bf16 v[48:51], v[76:79], v[100:103], v[48:51]
    ds_read_b64 v[74:75], v124 offset:2440
    v_mfma_f32_16x16x32_bf16 v[44:47], v[76:79], v[96:99], v[44:47]
    v_mfma_f32_16x16x32_bf16 v[40:43], v[76:79], v[92:95], v[40:43]
    ds_read_b64 v[76:77], v124 offset:1920
    s_waitcnt lgkmcnt(15)
    v_mfma_f32_16x16x32_bf16 v[52:55], v[80:83], v[100:103], v[52:55]
    ds_read_b128 v[100:103], v125 offset:1408
    v_mfma_f32_16x16x32_bf16 v[48:51], v[80:83], v[96:99], v[48:51]
    ds_read_b64 v[78:79], v124 offset:1928
    v_mfma_f32_16x16x32_bf16 v[44:47], v[80:83], v[92:95], v[44:47]
    ds_read_b64 v[80:81], v124 offset:1408
    v_mfma_f32_16x16x32_bf16 v[52:55], v[84:87], v[96:99], v[52:55]
    ds_read_b128 v[96:99], v125 offset:896
    v_mfma_f32_16x16x32_bf16 v[48:51], v[84:87], v[92:95], v[48:51]
    ds_read_b64 v[82:83], v124 offset:1416
    s_waitcnt lgkmcnt(15)
    v_mfma_f32_16x16x32_bf16 v[52:55], v[88:91], v[92:95], v[52:55]
    ds_read_b128 v[92:95], v125 offset:384
    v_mfma_f32_16x16x32_bf16 v[52:55], v[60:63], v[120:123], v[52:55]
    ds_read_b64 v[84:85], v124 offset:896
    v_mfma_f32_16x16x32_bf16 v[48:51], v[60:63], v[116:119], v[48:51]
    ds_read_b64 v[86:87], v124 offset:904
    s_waitcnt lgkmcnt(15)
    v_mfma_f32_16x16x32_bf16 v[44:47], v[60:63], v[112:115], v[44:47]
    ds_read_b64 v[88:89], v124 offset:384
    s_waitcnt lgkmcnt(14)
    v_mfma_f32_16x16x32_bf16 v[40:43], v[60:63], v[108:111], v[40:43]
    ds_read_b64 v[90:91], v124 offset:392
    v_mfma_f32_16x16x32_bf16 v[52:55], v[64:67], v[116:119], v[52:55]
    ds_read_b128 v[120:123], v125 offset:3904
    v_mfma_f32_16x16x32_bf16 v[48:51], v[64:67], v[112:115], v[48:51]
    ds_read_b64 v[60:61], v124 offset:3904
    v_mfma_f32_16x16x32_bf16 v[44:47], v[64:67], v[108:111], v[44:47]
    ds_read_b64 v[62:63], v124 offset:3912
    s_waitcnt lgkmcnt(15)
    v_mfma_f32_16x16x32_bf16 v[40:43], v[64:67], v[104:107], v[40:43]
    ds_read_b128 v[116:119], v125 offset:3392
    v_mfma_f32_16x16x32_bf16 v[52:55], v[68:71], v[112:115], v[52:55]
    ds_read_b128 v[112:115], v125 offset:2880
    v_mfma_f32_16x16x32_bf16 v[48:51], v[68:71], v[108:111], v[48:51]
    ds_read_b64 v[64:65], v124 offset:3392
    v_mfma_f32_16x16x32_bf16 v[44:47], v[68:71], v[104:107], v[44:47]
    ds_read_b64 v[66:67], v124 offset:3400
    s_waitcnt lgkmcnt(15)
    v_mfma_f32_16x16x32_bf16 v[40:43], v[68:71], v[100:103], v[40:43]
    ds_read_b64 v[68:69], v124 offset:2880
    v_mfma_f32_16x16x32_bf16 v[52:55], v[72:75], v[108:111], v[52:55]
    ds_read_b128 v[108:111], v125 offset:2368
    v_mfma_f32_16x16x32_bf16 v[48:51], v[72:75], v[104:107], v[48:51]
    ds_read_b64 v[70:71], v124 offset:2888
    v_mfma_f32_16x16x32_bf16 v[44:47], v[72:75], v[100:103], v[44:47]
    s_waitcnt lgkmcnt(15)
    v_mfma_f32_16x16x32_bf16 v[40:43], v[72:75], v[96:99], v[40:43]
    ds_read_b64 v[72:73], v124 offset:2368
    v_mfma_f32_16x16x32_bf16 v[52:55], v[76:79], v[104:107], v[52:55]
    ds_read_b128 v[104:107], v125 offset:1856
    v_mfma_f32_16x16x32_bf16 v[48:51], v[76:79], v[100:103], v[48:51]
    ds_read_b64 v[74:75], v124 offset:2376
    v_mfma_f32_16x16x32_bf16 v[44:47], v[76:79], v[96:99], v[44:47]
    s_waitcnt lgkmcnt(15)
    v_mfma_f32_16x16x32_bf16 v[40:43], v[76:79], v[92:95], v[40:43]
    ds_read_b64 v[76:77], v124 offset:1856
    v_mfma_f32_16x16x32_bf16 v[52:55], v[80:83], v[100:103], v[52:55]
    ds_read_b128 v[100:103], v125 offset:1344
    v_mfma_f32_16x16x32_bf16 v[48:51], v[80:83], v[96:99], v[48:51]
    ds_read_b64 v[78:79], v124 offset:1864
    v_mfma_f32_16x16x32_bf16 v[44:47], v[80:83], v[92:95], v[44:47]
    ds_read_b64 v[80:81], v124 offset:1344
    v_mfma_f32_16x16x32_bf16 v[52:55], v[84:87], v[96:99], v[52:55]
    ds_read_b128 v[96:99], v125 offset:832
    v_mfma_f32_16x16x32_bf16 v[48:51], v[84:87], v[92:95], v[48:51]
    ds_read_b64 v[82:83], v124 offset:1352
    s_waitcnt lgkmcnt(15)
    v_mfma_f32_16x16x32_bf16 v[52:55], v[88:91], v[92:95], v[52:55]
    ds_read_b128 v[92:95], v125 offset:320
    v_mfma_f32_16x16x32_bf16 v[52:55], v[60:63], v[120:123], v[52:55]
    ds_read_b64 v[84:85], v124 offset:832
    v_mfma_f32_16x16x32_bf16 v[48:51], v[60:63], v[116:119], v[48:51]
    ds_read_b64 v[86:87], v124 offset:840
    s_waitcnt lgkmcnt(15)
    v_mfma_f32_16x16x32_bf16 v[44:47], v[60:63], v[112:115], v[44:47]
    ds_read_b64 v[88:89], v124 offset:320
    s_waitcnt lgkmcnt(14)
    v_mfma_f32_16x16x32_bf16 v[40:43], v[60:63], v[108:111], v[40:43]
    ds_read_b64 v[90:91], v124 offset:328
    v_mfma_f32_16x16x32_bf16 v[52:55], v[64:67], v[116:119], v[52:55]
    ds_read_b128 v[120:123], v125 offset:3840
    v_mfma_f32_16x16x32_bf16 v[48:51], v[64:67], v[112:115], v[48:51]
    ds_read_b64 v[60:61], v124 offset:3840
    v_mfma_f32_16x16x32_bf16 v[44:47], v[64:67], v[108:111], v[44:47]
    ds_read_b64 v[62:63], v124 offset:3848
    s_waitcnt lgkmcnt(15)
    v_mfma_f32_16x16x32_bf16 v[40:43], v[64:67], v[104:107], v[40:43]
    ds_read_b128 v[116:119], v125 offset:3328
    v_mfma_f32_16x16x32_bf16 v[52:55], v[68:71], v[112:115], v[52:55]
    ds_read_b128 v[112:115], v125 offset:2816
    v_mfma_f32_16x16x32_bf16 v[48:51], v[68:71], v[108:111], v[48:51]
    ds_read_b64 v[64:65], v124 offset:3328
    v_mfma_f32_16x16x32_bf16 v[44:47], v[68:71], v[104:107], v[44:47]
    ds_read_b64 v[66:67], v124 offset:3336
    s_waitcnt lgkmcnt(15)
    v_mfma_f32_16x16x32_bf16 v[40:43], v[68:71], v[100:103], v[40:43]
    ds_read_b64 v[68:69], v124 offset:2816
    v_mfma_f32_16x16x32_bf16 v[52:55], v[72:75], v[108:111], v[52:55]
    ds_read_b128 v[108:111], v125 offset:2304
    v_mfma_f32_16x16x32_bf16 v[48:51], v[72:75], v[104:107], v[48:51]
    ds_read_b64 v[70:71], v124 offset:2824
    v_mfma_f32_16x16x32_bf16 v[44:47], v[72:75], v[100:103], v[44:47]
    s_waitcnt lgkmcnt(15)
    v_mfma_f32_16x16x32_bf16 v[40:43], v[72:75], v[96:99], v[40:43]
    ds_read_b64 v[72:73], v124 offset:2304
    v_mfma_f32_16x16x32_bf16 v[52:55], v[76:79], v[104:107], v[52:55]
    ds_read_b128 v[104:107], v125 offset:1792
    v_mfma_f32_16x16x32_bf16 v[48:51], v[76:79], v[100:103], v[48:51]
    ds_read_b64 v[74:75], v124 offset:2312
    v_mfma_f32_16x16x32_bf16 v[44:47], v[76:79], v[96:99], v[44:47]
    s_waitcnt lgkmcnt(15)
    v_mfma_f32_16x16x32_bf16 v[40:43], v[76:79], v[92:95], v[40:43]
    ds_read_b64 v[76:77], v124 offset:1792
    v_mfma_f32_16x16x32_bf16 v[52:55], v[80:83], v[100:103], v[52:55]
    ds_read_b128 v[100:103], v125 offset:1280
    v_mfma_f32_16x16x32_bf16 v[48:51], v[80:83], v[96:99], v[48:51]
    ds_read_b64 v[78:79], v124 offset:1800
    v_mfma_f32_16x16x32_bf16 v[44:47], v[80:83], v[92:95], v[44:47]
    ds_read_b64 v[80:81], v124 offset:1280
    v_mfma_f32_16x16x32_bf16 v[52:55], v[84:87], v[96:99], v[52:55]
    ds_read_b128 v[96:99], v125 offset:768
    v_mfma_f32_16x16x32_bf16 v[48:51], v[84:87], v[92:95], v[48:51]
    ds_read_b64 v[82:83], v124 offset:1288
    s_waitcnt lgkmcnt(15)
    v_mfma_f32_16x16x32_bf16 v[52:55], v[88:91], v[92:95], v[52:55]
    ds_read_b128 v[92:95], v125 offset:256
    v_mfma_f32_16x16x32_bf16 v[52:55], v[60:63], v[120:123], v[52:55]
    ds_read_b64 v[84:85], v124 offset:768
    v_mfma_f32_16x16x32_bf16 v[48:51], v[60:63], v[116:119], v[48:51]
    ds_read_b64 v[86:87], v124 offset:776
    s_waitcnt lgkmcnt(15)
    v_mfma_f32_16x16x32_bf16 v[44:47], v[60:63], v[112:115], v[44:47]
    ds_read_b64 v[88:89], v124 offset:256
    s_waitcnt lgkmcnt(14)
    v_mfma_f32_16x16x32_bf16 v[40:43], v[60:63], v[108:111], v[40:43]
    ds_read_b64 v[90:91], v124 offset:264
    v_mfma_f32_16x16x32_bf16 v[52:55], v[64:67], v[116:119], v[52:55]
    ds_read_b128 v[120:123], v125 offset:3776
    v_mfma_f32_16x16x32_bf16 v[48:51], v[64:67], v[112:115], v[48:51]
    ds_read_b64 v[60:61], v124 offset:3776
    v_mfma_f32_16x16x32_bf16 v[44:47], v[64:67], v[108:111], v[44:47]
    ds_read_b64 v[62:63], v124 offset:3784
    s_waitcnt lgkmcnt(15)
    v_mfma_f32_16x16x32_bf16 v[40:43], v[64:67], v[104:107], v[40:43]
    ds_read_b128 v[116:119], v125 offset:3264
    v_mfma_f32_16x16x32_bf16 v[52:55], v[68:71], v[112:115], v[52:55]
    ds_read_b128 v[112:115], v125 offset:2752
    v_mfma_f32_16x16x32_bf16 v[48:51], v[68:71], v[108:111], v[48:51]
    ds_read_b64 v[64:65], v124 offset:3264
    v_mfma_f32_16x16x32_bf16 v[44:47], v[68:71], v[104:107], v[44:47]
    ds_read_b64 v[66:67], v124 offset:3272
    s_waitcnt lgkmcnt(15)
    v_mfma_f32_16x16x32_bf16 v[40:43], v[68:71], v[100:103], v[40:43]
    ds_read_b64 v[68:69], v124 offset:2752
    v_mfma_f32_16x16x32_bf16 v[52:55], v[72:75], v[108:111], v[52:55]
    ds_read_b128 v[108:111], v125 offset:2240
    v_mfma_f32_16x16x32_bf16 v[48:51], v[72:75], v[104:107], v[48:51]
    ds_read_b64 v[70:71], v124 offset:2760
    v_mfma_f32_16x16x32_bf16 v[44:47], v[72:75], v[100:103], v[44:47]
    s_waitcnt lgkmcnt(15)
    v_mfma_f32_16x16x32_bf16 v[40:43], v[72:75], v[96:99], v[40:43]
    ds_read_b64 v[72:73], v124 offset:2240
    v_mfma_f32_16x16x32_bf16 v[52:55], v[76:79], v[104:107], v[52:55]
    ds_read_b128 v[104:107], v125 offset:1728
    v_mfma_f32_16x16x32_bf16 v[48:51], v[76:79], v[100:103], v[48:51]
    ds_read_b64 v[74:75], v124 offset:2248
    v_mfma_f32_16x16x32_bf16 v[44:47], v[76:79], v[96:99], v[44:47]
    s_waitcnt lgkmcnt(15)
    v_mfma_f32_16x16x32_bf16 v[40:43], v[76:79], v[92:95], v[40:43]
    ds_read_b64 v[76:77], v124 offset:1728
    v_mfma_f32_16x16x32_bf16 v[52:55], v[80:83], v[100:103], v[52:55]
    ds_read_b128 v[100:103], v125 offset:1216
    v_mfma_f32_16x16x32_bf16 v[48:51], v[80:83], v[96:99], v[48:51]
    ds_read_b64 v[78:79], v124 offset:1736
    v_mfma_f32_16x16x32_bf16 v[44:47], v[80:83], v[92:95], v[44:47]
    ds_read_b64 v[80:81], v124 offset:1216
    v_mfma_f32_16x16x32_bf16 v[52:55], v[84:87], v[96:99], v[52:55]
    ds_read_b128 v[96:99], v125 offset:704
    v_mfma_f32_16x16x32_bf16 v[48:51], v[84:87], v[92:95], v[48:51]
    ds_read_b64 v[82:83], v124 offset:1224
    s_waitcnt lgkmcnt(15)
    v_mfma_f32_16x16x32_bf16 v[52:55], v[88:91], v[92:95], v[52:55]
    ds_read_b128 v[92:95], v125 offset:192
    v_mfma_f32_16x16x32_bf16 v[52:55], v[60:63], v[120:123], v[52:55]
    ds_read_b64 v[84:85], v124 offset:704
    v_mfma_f32_16x16x32_bf16 v[48:51], v[60:63], v[116:119], v[48:51]
    ds_read_b64 v[86:87], v124 offset:712
    s_waitcnt lgkmcnt(15)
    v_mfma_f32_16x16x32_bf16 v[44:47], v[60:63], v[112:115], v[44:47]
    ds_read_b64 v[88:89], v124 offset:192
    s_waitcnt lgkmcnt(14)
    v_mfma_f32_16x16x32_bf16 v[40:43], v[60:63], v[108:111], v[40:43]
    ds_read_b64 v[90:91], v124 offset:200
    v_mfma_f32_16x16x32_bf16 v[52:55], v[64:67], v[116:119], v[52:55]
    ds_read_b128 v[120:123], v125 offset:3712
    v_mfma_f32_16x16x32_bf16 v[48:51], v[64:67], v[112:115], v[48:51]
    ds_read_b64 v[60:61], v124 offset:3712
    v_mfma_f32_16x16x32_bf16 v[44:47], v[64:67], v[108:111], v[44:47]
    ds_read_b64 v[62:63], v124 offset:3720
    s_waitcnt lgkmcnt(15)
    v_mfma_f32_16x16x32_bf16 v[40:43], v[64:67], v[104:107], v[40:43]
    ds_read_b128 v[116:119], v125 offset:3200
    v_mfma_f32_16x16x32_bf16 v[52:55], v[68:71], v[112:115], v[52:55]
    ds_read_b128 v[112:115], v125 offset:2688
    v_mfma_f32_16x16x32_bf16 v[48:51], v[68:71], v[108:111], v[48:51]
    ds_read_b64 v[64:65], v124 offset:3200
    v_mfma_f32_16x16x32_bf16 v[44:47], v[68:71], v[104:107], v[44:47]
    ds_read_b64 v[66:67], v124 offset:3208
    s_waitcnt lgkmcnt(15)
    v_mfma_f32_16x16x32_bf16 v[40:43], v[68:71], v[100:103], v[40:43]
    ds_read_b64 v[68:69], v124 offset:2688
    v_mfma_f32_16x16x32_bf16 v[52:55], v[72:75], v[108:111], v[52:55]
    ds_read_b128 v[108:111], v125 offset:2176
    v_mfma_f32_16x16x32_bf16 v[48:51], v[72:75], v[104:107], v[48:51]
    ds_read_b64 v[70:71], v124 offset:2696
    v_mfma_f32_16x16x32_bf16 v[44:47], v[72:75], v[100:103], v[44:47]
    s_waitcnt lgkmcnt(15)
    v_mfma_f32_16x16x32_bf16 v[40:43], v[72:75], v[96:99], v[40:43]
    ds_read_b64 v[72:73], v124 offset:2176
    v_mfma_f32_16x16x32_bf16 v[52:55], v[76:79], v[104:107], v[52:55]
    ds_read_b128 v[104:107], v125 offset:1664
    v_mfma_f32_16x16x32_bf16 v[48:51], v[76:79], v[100:103], v[48:51]
    ds_read_b64 v[74:75], v124 offset:2184
    v_mfma_f32_16x16x32_bf16 v[44:47], v[76:79], v[96:99], v[44:47]
    s_waitcnt lgkmcnt(15)
    v_mfma_f32_16x16x32_bf16 v[40:43], v[76:79], v[92:95], v[40:43]
    ds_read_b64 v[76:77], v124 offset:1664
    v_mfma_f32_16x16x32_bf16 v[52:55], v[80:83], v[100:103], v[52:55]
    ds_read_b128 v[100:103], v125 offset:1152
    v_mfma_f32_16x16x32_bf16 v[48:51], v[80:83], v[96:99], v[48:51]
    ds_read_b64 v[78:79], v124 offset:1672
    v_mfma_f32_16x16x32_bf16 v[44:47], v[80:83], v[92:95], v[44:47]
    ds_read_b64 v[80:81], v124 offset:1152
    v_mfma_f32_16x16x32_bf16 v[52:55], v[84:87], v[96:99], v[52:55]
    ds_read_b128 v[96:99], v125 offset:640
    v_mfma_f32_16x16x32_bf16 v[48:51], v[84:87], v[92:95], v[48:51]
    ds_read_b64 v[82:83], v124 offset:1160
    s_waitcnt lgkmcnt(15)
    v_mfma_f32_16x16x32_bf16 v[52:55], v[88:91], v[92:95], v[52:55]
    ds_read_b128 v[92:95], v125 offset:128
    v_mfma_f32_16x16x32_bf16 v[52:55], v[60:63], v[120:123], v[52:55]
    ds_read_b64 v[84:85], v124 offset:640
    v_mfma_f32_16x16x32_bf16 v[48:51], v[60:63], v[116:119], v[48:51]
    ds_read_b64 v[86:87], v124 offset:648
    s_waitcnt lgkmcnt(15)
    v_mfma_f32_16x16x32_bf16 v[44:47], v[60:63], v[112:115], v[44:47]
    ds_read_b64 v[88:89], v124 offset:128
    s_waitcnt lgkmcnt(14)
    v_mfma_f32_16x16x32_bf16 v[40:43], v[60:63], v[108:111], v[40:43]
    ds_read_b64 v[90:91], v124 offset:136
    v_mfma_f32_16x16x32_bf16 v[52:55], v[64:67], v[116:119], v[52:55]
    ds_read_b128 v[120:123], v125 offset:3648
    v_mfma_f32_16x16x32_bf16 v[48:51], v[64:67], v[112:115], v[48:51]
    ds_read_b64 v[60:61], v124 offset:3648
    v_mfma_f32_16x16x32_bf16 v[44:47], v[64:67], v[108:111], v[44:47]
    ds_read_b64 v[62:63], v124 offset:3656
    s_waitcnt lgkmcnt(15)
    v_mfma_f32_16x16x32_bf16 v[40:43], v[64:67], v[104:107], v[40:43]
    ds_read_b128 v[116:119], v125 offset:3136
    v_mfma_f32_16x16x32_bf16 v[52:55], v[68:71], v[112:115], v[52:55]
    ds_read_b128 v[112:115], v125 offset:2624
    v_mfma_f32_16x16x32_bf16 v[48:51], v[68:71], v[108:111], v[48:51]
    ds_read_b64 v[64:65], v124 offset:3136
    v_mfma_f32_16x16x32_bf16 v[44:47], v[68:71], v[104:107], v[44:47]
    ds_read_b64 v[66:67], v124 offset:3144
    s_waitcnt lgkmcnt(15)
    v_mfma_f32_16x16x32_bf16 v[40:43], v[68:71], v[100:103], v[40:43]
    ds_read_b64 v[68:69], v124 offset:2624
    v_mfma_f32_16x16x32_bf16 v[52:55], v[72:75], v[108:111], v[52:55]
    ds_read_b128 v[108:111], v125 offset:2112
    v_mfma_f32_16x16x32_bf16 v[48:51], v[72:75], v[104:107], v[48:51]
    ds_read_b64 v[70:71], v124 offset:2632
    v_mfma_f32_16x16x32_bf16 v[44:47], v[72:75], v[100:103], v[44:47]
    s_waitcnt lgkmcnt(15)
    v_mfma_f32_16x16x32_bf16 v[40:43], v[72:75], v[96:99], v[40:43]
    ds_read_b64 v[72:73], v124 offset:2112
    v_mfma_f32_16x16x32_bf16 v[52:55], v[76:79], v[104:107], v[52:55]
    ds_read_b128 v[104:107], v125 offset:1600
    v_mfma_f32_16x16x32_bf16 v[48:51], v[76:79], v[100:103], v[48:51]
    ds_read_b64 v[74:75], v124 offset:2120
    v_mfma_f32_16x16x32_bf16 v[44:47], v[76:79], v[96:99], v[44:47]
    s_waitcnt lgkmcnt(15)
    v_mfma_f32_16x16x32_bf16 v[40:43], v[76:79], v[92:95], v[40:43]
    ds_read_b64 v[76:77], v124 offset:1600
    v_mfma_f32_16x16x32_bf16 v[52:55], v[80:83], v[100:103], v[52:55]
    ds_read_b128 v[100:103], v125 offset:1088
    v_mfma_f32_16x16x32_bf16 v[48:51], v[80:83], v[96:99], v[48:51]
    ds_read_b64 v[78:79], v124 offset:1608
    v_mfma_f32_16x16x32_bf16 v[44:47], v[80:83], v[92:95], v[44:47]
    ds_read_b64 v[80:81], v124 offset:1088
    v_mfma_f32_16x16x32_bf16 v[52:55], v[84:87], v[96:99], v[52:55]
    ds_read_b128 v[96:99], v125 offset:576
    v_mfma_f32_16x16x32_bf16 v[48:51], v[84:87], v[92:95], v[48:51]
    ds_read_b64 v[82:83], v124 offset:1096
    s_waitcnt lgkmcnt(15)
    v_mfma_f32_16x16x32_bf16 v[52:55], v[88:91], v[92:95], v[52:55]
    ds_read_b128 v[92:95], v125 offset:64
    v_mfma_f32_16x16x32_bf16 v[52:55], v[60:63], v[120:123], v[52:55]
    ds_read_b64 v[84:85], v124 offset:576
    v_mfma_f32_16x16x32_bf16 v[48:51], v[60:63], v[116:119], v[48:51]
    ds_read_b64 v[86:87], v124 offset:584
    s_waitcnt lgkmcnt(15)
    v_mfma_f32_16x16x32_bf16 v[44:47], v[60:63], v[112:115], v[44:47]
    ds_read_b64 v[88:89], v124 offset:64
    s_waitcnt lgkmcnt(14)
    v_mfma_f32_16x16x32_bf16 v[40:43], v[60:63], v[108:111], v[40:43]
    ds_read_b64 v[90:91], v124 offset:72
    v_mfma_f32_16x16x32_bf16 v[52:55], v[64:67], v[116:119], v[52:55]
    ds_read_b128 v[120:123], v125 offset:3584
    v_mfma_f32_16x16x32_bf16 v[48:51], v[64:67], v[112:115], v[48:51]
    ds_read_b64 v[60:61], v124 offset:3584
    v_mfma_f32_16x16x32_bf16 v[44:47], v[64:67], v[108:111], v[44:47]
    ds_read_b64 v[62:63], v124 offset:3592
    s_waitcnt lgkmcnt(15)
    v_mfma_f32_16x16x32_bf16 v[40:43], v[64:67], v[104:107], v[40:43]
    ds_read_b128 v[116:119], v125 offset:3072
    v_mfma_f32_16x16x32_bf16 v[52:55], v[68:71], v[112:115], v[52:55]
    ds_read_b128 v[112:115], v125 offset:2560
    v_mfma_f32_16x16x32_bf16 v[48:51], v[68:71], v[108:111], v[48:51]
    ds_read_b64 v[64:65], v124 offset:3072
    v_mfma_f32_16x16x32_bf16 v[44:47], v[68:71], v[104:107], v[44:47]
    ds_read_b64 v[66:67], v124 offset:3080
    s_waitcnt lgkmcnt(15)
    v_mfma_f32_16x16x32_bf16 v[40:43], v[68:71], v[100:103], v[40:43]
    ds_read_b64 v[68:69], v124 offset:2560
    v_mfma_f32_16x16x32_bf16 v[52:55], v[72:75], v[108:111], v[52:55]
    ds_read_b128 v[108:111], v125 offset:2048
    v_mfma_f32_16x16x32_bf16 v[48:51], v[72:75], v[104:107], v[48:51]
    ds_read_b64 v[70:71], v124 offset:2568
    v_mfma_f32_16x16x32_bf16 v[44:47], v[72:75], v[100:103], v[44:47]
    s_waitcnt lgkmcnt(15)
    v_mfma_f32_16x16x32_bf16 v[40:43], v[72:75], v[96:99], v[40:43]
    ds_read_b64 v[72:73], v124 offset:2048
    v_mfma_f32_16x16x32_bf16 v[52:55], v[76:79], v[104:107], v[52:55]
    ds_read_b128 v[104:107], v125 offset:1536
    v_mfma_f32_16x16x32_bf16 v[48:51], v[76:79], v[100:103], v[48:51]
    ds_read_b64 v[74:75], v124 offset:2056
    v_mfma_f32_16x16x32_bf16 v[44:47], v[76:79], v[96:99], v[44:47]
    s_waitcnt lgkmcnt(15)
    v_mfma_f32_16x16x32_bf16 v[40:43], v[76:79], v[92:95], v[40:43]
    ds_read_b64 v[76:77], v124 offset:1536
    v_mfma_f32_16x16x32_bf16 v[52:55], v[80:83], v[100:103], v[52:55]
    ds_read_b128 v[100:103], v125 offset:1024
    v_mfma_f32_16x16x32_bf16 v[48:51], v[80:83], v[96:99], v[48:51]
    ds_read_b64 v[78:79], v124 offset:1544
    v_mfma_f32_16x16x32_bf16 v[44:47], v[80:83], v[92:95], v[44:47]
    ds_read_b64 v[80:81], v124 offset:1024
    v_mfma_f32_16x16x32_bf16 v[52:55], v[84:87], v[96:99], v[52:55]
    ds_read_b128 v[96:99], v125 offset:512
    v_mfma_f32_16x16x32_bf16 v[48:51], v[84:87], v[92:95], v[48:51]
    ds_read_b64 v[82:83], v124 offset:1032
    s_waitcnt lgkmcnt(15)
    v_mfma_f32_16x16x32_bf16 v[52:55], v[88:91], v[92:95], v[52:55]
    ds_read_b128 v[92:95], v125 offset:0
    v_mfma_f32_16x16x32_bf16 v[52:55], v[60:63], v[120:123], v[52:55]
    ds_read_b64 v[84:85], v124 offset:512
    v_mfma_f32_16x16x32_bf16 v[48:51], v[60:63], v[116:119], v[48:51]
    ds_read_b64 v[86:87], v124 offset:520
    s_waitcnt lgkmcnt(15)
    v_mfma_f32_16x16x32_bf16 v[44:47], v[60:63], v[112:115], v[44:47]
    ds_read_b64 v[88:89], v124 offset:0
    s_waitcnt lgkmcnt(14)
    v_mfma_f32_16x16x32_bf16 v[40:43], v[60:63], v[108:111], v[40:43]
    ds_read_b64 v[90:91], v124 offset:8
    v_mfma_f32_16x16x32_bf16 v[52:55], v[64:67], v[116:119], v[52:55]
    v_mfma_f32_16x16x32_bf16 v[48:51], v[64:67], v[112:115], v[48:51]
    v_mfma_f32_16x16x32_bf16 v[44:47], v[64:67], v[108:111], v[44:47]
    s_waitcnt lgkmcnt(12)
    v_mfma_f32_16x16x32_bf16 v[40:43], v[64:67], v[104:107], v[40:43]
    v_mfma_f32_16x16x32_bf16 v[52:55], v[68:71], v[112:115], v[52:55]
    v_mfma_f32_16x16x32_bf16 v[48:51], v[68:71], v[108:111], v[48:51]
    v_mfma_f32_16x16x32_bf16 v[44:47], v[68:71], v[104:107], v[44:47]
    s_waitcnt lgkmcnt(9)
    v_mfma_f32_16x16x32_bf16 v[40:43], v[68:71], v[100:103], v[40:43]
    v_mfma_f32_16x16x32_bf16 v[52:55], v[72:75], v[108:111], v[52:55]
    v_mfma_f32_16x16x32_bf16 v[48:51], v[72:75], v[104:107], v[48:51]
    v_mfma_f32_16x16x32_bf16 v[44:47], v[72:75], v[100:103], v[44:47]
    s_waitcnt lgkmcnt(6)
    v_mfma_f32_16x16x32_bf16 v[40:43], v[72:75], v[96:99], v[40:43]
    v_mfma_f32_16x16x32_bf16 v[52:55], v[76:79], v[104:107], v[52:55]
    v_mfma_f32_16x16x32_bf16 v[48:51], v[76:79], v[100:103], v[48:51]
    v_mfma_f32_16x16x32_bf16 v[44:47], v[76:79], v[96:99], v[44:47]
    s_waitcnt lgkmcnt(4)
    v_mfma_f32_16x16x32_bf16 v[40:43], v[76:79], v[92:95], v[40:43]
    v_mfma_f32_16x16x32_bf16 v[52:55], v[80:83], v[100:103], v[52:55]
    v_mfma_f32_16x16x32_bf16 v[48:51], v[80:83], v[96:99], v[48:51]
    v_mfma_f32_16x16x32_bf16 v[44:47], v[80:83], v[92:95], v[44:47]
    s_waitcnt lgkmcnt(2)
    v_mfma_f32_16x16x32_bf16 v[52:55], v[84:87], v[96:99], v[52:55]
    v_mfma_f32_16x16x32_bf16 v[48:51], v[84:87], v[92:95], v[48:51]
    s_waitcnt lgkmcnt(0)
    v_mfma_f32_16x16x32_bf16 v[52:55], v[88:91], v[92:95], v[52:55]
    v_cvt_pk_bf16_f32 v40, v40, v41
    v_cvt_pk_bf16_f32 v41, v42, v43
    ds_write_b64 v126, v[40:41] offset:2048
    v_cvt_pk_bf16_f32 v44, v44, v45
    v_cvt_pk_bf16_f32 v45, v46, v47
    ds_write_b64 v126, v[44:45] offset:2560
    v_cvt_pk_bf16_f32 v48, v48, v49
    v_cvt_pk_bf16_f32 v49, v50, v51
    ds_write_b64 v126, v[48:49] offset:3072
    v_cvt_pk_bf16_f32 v52, v52, v53
    v_cvt_pk_bf16_f32 v53, v54, v55
    ds_write_b64 v126, v[52:53] offset:3584
    s_branch L_c3d_125
L_c30_124:
    s_setprio 3
    s_sub_u32 s74, s61, 4
    s_mul_i32 s75, s74, 16640
    s_add_u32 s75, s75, 30576
    s_cmp_eq_u32 s74, 2
    s_cselect_b32 s75, 0, s75
    s_mul_i32 s76, s74, 4640
    s_mul_i32 s77, s74, 4128
    v_add_u32 v124, s75, v21
    v_add_u32 v125, s76, v22
    v_add_u32 v126, s77, v23
    ds_read_b64 v[60:61], v124 offset:4032
    ds_read_b64 v[62:63], v124 offset:4040
    ds_read_b128 v[64:67], v125 offset:448
    ds_read_b64 v[68:69], v124 offset:3968
    ds_read_b64 v[70:71], v124 offset:3976
    ds_read_b128 v[72:75], v125 offset:384
    ds_read_b64 v[76:77], v124 offset:3904
    ds_read_b64 v[78:79], v124 offset:3912
    ds_read_b128 v[80:83], v125 offset:320
    ds_read_b64 v[84:85], v124 offset:3840
    ds_read_b64 v[86:87], v124 offset:3848
    ds_read_b128 v[88:91], v125 offset:256
    ds_read_b64 v[92:93], v124 offset:3776
    ds_read_b64 v[94:95], v124 offset:3784
    ds_read_b128 v[96:99], v125 offset:192
    ds_read_b64 v[100:101], v124 offset:3712
    ds_read_b64 v[102:103], v124 offset:3720
    ds_read_b128 v[104:107], v125 offset:128
    ds_read_b64 v[108:109], v124 offset:3648
    ds_read_b64 v[110:111], v124 offset:3656
    ds_read_b128 v[112:115], v125 offset:64
    ds_read_b64 v[116:117], v124 offset:3584
    ds_read_b64 v[118:119], v124 offset:3592
    ds_read_b128 v[120:123], v125 offset:0
    s_waitcnt lgkmcnt(15)
    v_mfma_f32_16x16x32_bf16 v[40:43], v[60:63], v[64:67], 0
    v_mfma_f32_16x16x32_bf16 v[40:43], v[68:71], v[72:75], v[40:43]
    v_mfma_f32_16x16x32_bf16 v[40:43], v[76:79], v[80:83], v[40:43]
    s_waitcnt lgkmcnt(12)
    v_mfma_f32_16x16x32_bf16 v[40:43], v[84:87], v[88:91], v[40:43]
    s_waitcnt lgkmcnt(9)
    v_mfma_f32_16x16x32_bf16 v[40:43], v[92:95], v[96:99], v[40:43]
    s_waitcnt lgkmcnt(6)
    v_mfma_f32_16x16x32_bf16 v[40:43], v[100:103], v[104:107], v[40:43]
    s_waitcnt lgkmcnt(3)
    v_mfma_f32_16x16x32_bf16 v[40:43], v[108:111], v[112:115], v[40:43]
    s_waitcnt lgkmcnt(0)
    v_mfma_f32_16x16x32_bf16 v[40:43], v[116:119], v[120:123], v[40:43]
    s_nop 7
    v_cvt_pk_bf16_f32 v40, v40, v41
    v_cvt_pk_bf16_f32 v41, v42, v43
    ds_write_b64 v126, v[40:41]
    s_branch L_c3d_125
L_c3s_122:
    ds_read_b128 v[80:83], v22 offset:448
    ds_read_b64 v[64:65], v21 offset:34608
    ds_read_b64 v[66:67], v21 offset:34616
    ds_read_b128 v[84:87], v22 offset:960
    ds_read_b64 v[68:69], v21 offset:34096
    ds_read_b64 v[70:71], v21 offset:34104
    ds_read_b128 v[88:91], v22 offset:1472
    ds_read_b64 v[72:73], v21 offset:33584
    ds_read_b64 v[74:75], v21 offset:33592
    ds_read_b128 v[92:95], v22 offset:1984
    ds_read_b64 v[76:77], v21 offset:33072
    ds_read_b64 v[78:79], v21 offset:33080
    s_waitcnt lgkmcnt(8)
    v_mfma_f32_16x16x32_bf16 v[40:43], v[64:67], v[84:87], 0
    ds_read_b128 v[112:115], v22 offset:5088
    ds_read_b64 v[96:97], v21 offset:51248
    s_waitcnt lgkmcnt(8)
    v_mfma_f32_16x16x32_bf16 v[40:43], v[68:71], v[80:83], v[40:43]
    ds_read_b64 v[98:99], v21 offset:51256
    ds_read_b128 v[116:119], v22 offset:5600
    v_mfma_f32_16x16x32_bf16 v[44:47], v[68:71], v[84:87], 0
    ds_read_b64 v[100:101], v21 offset:50736
    ds_read_b64 v[102:103], v21 offset:50744
    s_waitcnt lgkmcnt(11)
    v_mfma_f32_16x16x32_bf16 v[44:47], v[64:67], v[88:91], v[44:47]
    ds_read_b128 v[120:123], v22 offset:6112
    s_waitcnt lgkmcnt(10)
    v_mfma_f32_16x16x32_bf16 v[44:47], v[72:75], v[80:83], v[44:47]
    ds_read_b64 v[104:105], v21 offset:50224
    ds_read_b64 v[106:107], v21 offset:50232
    v_mfma_f32_16x16x32_bf16 v[48:51], v[68:71], v[88:91], 0
    ds_read_b128 v[124:127], v22 offset:6624
    ds_read_b64 v[108:109], v21 offset:49712
    v_mfma_f32_16x16x32_bf16 v[48:51], v[72:75], v[84:87], v[48:51]
    ds_read_b64 v[110:111], v21 offset:49720
    s_waitcnt lgkmcnt(14)
    v_mfma_f32_16x16x32_bf16 v[48:51], v[64:67], v[92:95], v[48:51]
    s_waitcnt lgkmcnt(12)
    v_mfma_f32_16x16x32_bf16 v[48:51], v[76:79], v[80:83], v[48:51]
    s_waitcnt lgkmcnt(8)
    v_mfma_f32_16x16x32_bf16 v[52:55], v[96:99], v[116:119], 0
    ds_read_b128 v[80:83], v22 offset:384
    ds_read_b64 v[64:65], v21 offset:34544
    s_waitcnt lgkmcnt(8)
    v_mfma_f32_16x16x32_bf16 v[52:55], v[100:103], v[112:115], v[52:55]
    ds_read_b64 v[66:67], v21 offset:34552
    ds_read_b128 v[84:87], v22 offset:896
    v_mfma_f32_16x16x32_bf16 v[56:59], v[100:103], v[116:119], 0
    ds_read_b64 v[68:69], v21 offset:34032
    ds_read_b64 v[70:71], v21 offset:34040
    s_waitcnt lgkmcnt(11)
    v_mfma_f32_16x16x32_bf16 v[56:59], v[96:99], v[120:123], v[56:59]
    ds_read_b128 v[88:91], v22 offset:1408
    s_waitcnt lgkmcnt(10)
    v_mfma_f32_16x16x32_bf16 v[56:59], v[104:107], v[112:115], v[56:59]
    ds_read_b64 v[72:73], v21 offset:33520
    ds_read_b64 v[74:75], v21 offset:33528
    v_mfma_f32_16x16x32_bf16 v[60:63], v[100:103], v[120:123], 0
    ds_read_b128 v[92:95], v22 offset:1920
    ds_read_b64 v[76:77], v21 offset:33008
    v_mfma_f32_16x16x32_bf16 v[60:63], v[104:107], v[116:119], v[60:63]
    ds_read_b64 v[78:79], v21 offset:33016
    s_waitcnt lgkmcnt(14)
    v_mfma_f32_16x16x32_bf16 v[60:63], v[96:99], v[124:127], v[60:63]
    s_waitcnt lgkmcnt(12)
    v_mfma_f32_16x16x32_bf16 v[60:63], v[108:111], v[112:115], v[60:63]
    s_waitcnt lgkmcnt(8)
    v_mfma_f32_16x16x32_bf16 v[40:43], v[64:67], v[84:87], v[40:43]
    ds_read_b128 v[112:115], v22 offset:5024
    ds_read_b64 v[96:97], v21 offset:51184
    s_waitcnt lgkmcnt(8)
    v_mfma_f32_16x16x32_bf16 v[40:43], v[68:71], v[80:83], v[40:43]
    ds_read_b64 v[98:99], v21 offset:51192
    ds_read_b128 v[116:119], v22 offset:5536
    v_mfma_f32_16x16x32_bf16 v[44:47], v[68:71], v[84:87], v[44:47]
    ds_read_b64 v[100:101], v21 offset:50672
    ds_read_b64 v[102:103], v21 offset:50680
    s_waitcnt lgkmcnt(11)
    v_mfma_f32_16x16x32_bf16 v[44:47], v[64:67], v[88:91], v[44:47]
    ds_read_b128 v[120:123], v22 offset:6048
    s_waitcnt lgkmcnt(10)
    v_mfma_f32_16x16x32_bf16 v[44:47], v[72:75], v[80:83], v[44:47]
    ds_read_b64 v[104:105], v21 offset:50160
    ds_read_b64 v[106:107], v21 offset:50168
    v_mfma_f32_16x16x32_bf16 v[48:51], v[68:71], v[88:91], v[48:51]
    ds_read_b128 v[124:127], v22 offset:6560
    ds_read_b64 v[108:109], v21 offset:49648
    v_mfma_f32_16x16x32_bf16 v[48:51], v[72:75], v[84:87], v[48:51]
    ds_read_b64 v[110:111], v21 offset:49656
    s_waitcnt lgkmcnt(14)
    v_mfma_f32_16x16x32_bf16 v[48:51], v[64:67], v[92:95], v[48:51]
    s_waitcnt lgkmcnt(12)
    v_mfma_f32_16x16x32_bf16 v[48:51], v[76:79], v[80:83], v[48:51]
    s_waitcnt lgkmcnt(8)
    v_mfma_f32_16x16x32_bf16 v[52:55], v[96:99], v[116:119], v[52:55]
    ds_read_b128 v[80:83], v22 offset:320
    ds_read_b64 v[64:65], v21 offset:34480
    s_waitcnt lgkmcnt(8)
    v_mfma_f32_16x16x32_bf16 v[52:55], v[100:103], v[112:115], v[52:55]
    ds_read_b64 v[66:67], v21 offset:34488
    ds_read_b128 v[84:87], v22 offset:832
    v_mfma_f32_16x16x32_bf16 v[56:59], v[100:103], v[116:119], v[56:59]
    ds_read_b64 v[68:69], v21 offset:33968
    ds_read_b64 v[70:71], v21 offset:33976
    s_waitcnt lgkmcnt(11)
    v_mfma_f32_16x16x32_bf16 v[56:59], v[96:99], v[120:123], v[56:59]
    ds_read_b128 v[88:91], v22 offset:1344
    s_waitcnt lgkmcnt(10)
    v_mfma_f32_16x16x32_bf16 v[56:59], v[104:107], v[112:115], v[56:59]
    ds_read_b64 v[72:73], v21 offset:33456
    ds_read_b64 v[74:75], v21 offset:33464
    v_mfma_f32_16x16x32_bf16 v[60:63], v[100:103], v[120:123], v[60:63]
    ds_read_b128 v[92:95], v22 offset:1856
    ds_read_b64 v[76:77], v21 offset:32944
    v_mfma_f32_16x16x32_bf16 v[60:63], v[104:107], v[116:119], v[60:63]
    ds_read_b64 v[78:79], v21 offset:32952
    s_waitcnt lgkmcnt(14)
    v_mfma_f32_16x16x32_bf16 v[60:63], v[96:99], v[124:127], v[60:63]
    s_waitcnt lgkmcnt(12)
    v_mfma_f32_16x16x32_bf16 v[60:63], v[108:111], v[112:115], v[60:63]
    s_waitcnt lgkmcnt(8)
    v_mfma_f32_16x16x32_bf16 v[40:43], v[64:67], v[84:87], v[40:43]
    ds_read_b128 v[112:115], v22 offset:4960
    ds_read_b64 v[96:97], v21 offset:51120
    s_waitcnt lgkmcnt(8)
    v_mfma_f32_16x16x32_bf16 v[40:43], v[68:71], v[80:83], v[40:43]
    ds_read_b64 v[98:99], v21 offset:51128
    ds_read_b128 v[116:119], v22 offset:5472
    v_mfma_f32_16x16x32_bf16 v[44:47], v[68:71], v[84:87], v[44:47]
    ds_read_b64 v[100:101], v21 offset:50608
    ds_read_b64 v[102:103], v21 offset:50616
    s_waitcnt lgkmcnt(11)
    v_mfma_f32_16x16x32_bf16 v[44:47], v[64:67], v[88:91], v[44:47]
    ds_read_b128 v[120:123], v22 offset:5984
    s_waitcnt lgkmcnt(10)
    v_mfma_f32_16x16x32_bf16 v[44:47], v[72:75], v[80:83], v[44:47]
    ds_read_b64 v[104:105], v21 offset:50096
    ds_read_b64 v[106:107], v21 offset:50104
    v_mfma_f32_16x16x32_bf16 v[48:51], v[68:71], v[88:91], v[48:51]
    ds_read_b128 v[124:127], v22 offset:6496
    ds_read_b64 v[108:109], v21 offset:49584
    v_mfma_f32_16x16x32_bf16 v[48:51], v[72:75], v[84:87], v[48:51]
    ds_read_b64 v[110:111], v21 offset:49592
    s_waitcnt lgkmcnt(14)
    v_mfma_f32_16x16x32_bf16 v[48:51], v[64:67], v[92:95], v[48:51]
    s_waitcnt lgkmcnt(12)
    v_mfma_f32_16x16x32_bf16 v[48:51], v[76:79], v[80:83], v[48:51]
    s_waitcnt lgkmcnt(8)
    v_mfma_f32_16x16x32_bf16 v[52:55], v[96:99], v[116:119], v[52:55]
    ds_read_b128 v[80:83], v22 offset:256
    ds_read_b64 v[64:65], v21 offset:34416
    s_waitcnt lgkmcnt(8)
    v_mfma_f32_16x16x32_bf16 v[52:55], v[100:103], v[112:115], v[52:55]
    ds_read_b64 v[66:67], v21 offset:34424
    ds_read_b128 v[84:87], v22 offset:768
    v_mfma_f32_16x16x32_bf16 v[56:59], v[100:103], v[116:119], v[56:59]
    ds_read_b64 v[68:69], v21 offset:33904
    ds_read_b64 v[70:71], v21 offset:33912
    s_waitcnt lgkmcnt(11)
    v_mfma_f32_16x16x32_bf16 v[56:59], v[96:99], v[120:123], v[56:59]
    ds_read_b128 v[88:91], v22 offset:1280
    s_waitcnt lgkmcnt(10)
    v_mfma_f32_16x16x32_bf16 v[56:59], v[104:107], v[112:115], v[56:59]
    ds_read_b64 v[72:73], v21 offset:33392
    ds_read_b64 v[74:75], v21 offset:33400
    v_mfma_f32_16x16x32_bf16 v[60:63], v[100:103], v[120:123], v[60:63]
    ds_read_b128 v[92:95], v22 offset:1792
    ds_read_b64 v[76:77], v21 offset:32880
    v_mfma_f32_16x16x32_bf16 v[60:63], v[104:107], v[116:119], v[60:63]
    ds_read_b64 v[78:79], v21 offset:32888
    s_waitcnt lgkmcnt(14)
    v_mfma_f32_16x16x32_bf16 v[60:63], v[96:99], v[124:127], v[60:63]
    s_waitcnt lgkmcnt(12)
    v_mfma_f32_16x16x32_bf16 v[60:63], v[108:111], v[112:115], v[60:63]
    s_waitcnt lgkmcnt(8)
    v_mfma_f32_16x16x32_bf16 v[40:43], v[64:67], v[84:87], v[40:43]
    ds_read_b128 v[112:115], v22 offset:4896
    ds_read_b64 v[96:97], v21 offset:51056
    s_waitcnt lgkmcnt(8)
    v_mfma_f32_16x16x32_bf16 v[40:43], v[68:71], v[80:83], v[40:43]
    ds_read_b64 v[98:99], v21 offset:51064
    ds_read_b128 v[116:119], v22 offset:5408
    v_mfma_f32_16x16x32_bf16 v[44:47], v[68:71], v[84:87], v[44:47]
    ds_read_b64 v[100:101], v21 offset:50544
    ds_read_b64 v[102:103], v21 offset:50552
    s_waitcnt lgkmcnt(11)
    v_mfma_f32_16x16x32_bf16 v[44:47], v[64:67], v[88:91], v[44:47]
    ds_read_b128 v[120:123], v22 offset:5920
    s_waitcnt lgkmcnt(10)
    v_mfma_f32_16x16x32_bf16 v[44:47], v[72:75], v[80:83], v[44:47]
    ds_read_b64 v[104:105], v21 offset:50032
    ds_read_b64 v[106:107], v21 offset:50040
    v_mfma_f32_16x16x32_bf16 v[48:51], v[68:71], v[88:91], v[48:51]
    ds_read_b128 v[124:127], v22 offset:6432
    ds_read_b64 v[108:109], v21 offset:49520
    v_mfma_f32_16x16x32_bf16 v[48:51], v[72:75], v[84:87], v[48:51]
    ds_read_b64 v[110:111], v21 offset:49528
    s_waitcnt lgkmcnt(14)
    v_mfma_f32_16x16x32_bf16 v[48:51], v[64:67], v[92:95], v[48:51]
    s_waitcnt lgkmcnt(12)
    v_mfma_f32_16x16x32_bf16 v[48:51], v[76:79], v[80:83], v[48:51]
    s_waitcnt lgkmcnt(8)
    v_mfma_f32_16x16x32_bf16 v[52:55], v[96:99], v[116:119], v[52:55]
    ds_read_b128 v[80:83], v22 offset:192
    ds_read_b64 v[64:65], v21 offset:34352
    s_waitcnt lgkmcnt(8)
    v_mfma_f32_16x16x32_bf16 v[52:55], v[100:103], v[112:115], v[52:55]
    ds_read_b64 v[66:67], v21 offset:34360
    ds_read_b128 v[84:87], v22 offset:704
    v_mfma_f32_16x16x32_bf16 v[56:59], v[100:103], v[116:119], v[56:59]
    ds_read_b64 v[68:69], v21 offset:33840
    ds_read_b64 v[70:71], v21 offset:33848
    s_waitcnt lgkmcnt(11)
    v_mfma_f32_16x16x32_bf16 v[56:59], v[96:99], v[120:123], v[56:59]
    ds_read_b128 v[88:91], v22 offset:1216
    s_waitcnt lgkmcnt(10)
    v_mfma_f32_16x16x32_bf16 v[56:59], v[104:107], v[112:115], v[56:59]
    ds_read_b64 v[72:73], v21 offset:33328
    ds_read_b64 v[74:75], v21 offset:33336
    v_mfma_f32_16x16x32_bf16 v[60:63], v[100:103], v[120:123], v[60:63]
    ds_read_b128 v[92:95], v22 offset:1728
    ds_read_b64 v[76:77], v21 offset:32816
    v_mfma_f32_16x16x32_bf16 v[60:63], v[104:107], v[116:119], v[60:63]
    ds_read_b64 v[78:79], v21 offset:32824
    s_waitcnt lgkmcnt(14)
    v_mfma_f32_16x16x32_bf16 v[60:63], v[96:99], v[124:127], v[60:63]
    s_waitcnt lgkmcnt(12)
    v_mfma_f32_16x16x32_bf16 v[60:63], v[108:111], v[112:115], v[60:63]
    s_waitcnt lgkmcnt(8)
    v_mfma_f32_16x16x32_bf16 v[40:43], v[64:67], v[84:87], v[40:43]
    ds_read_b128 v[112:115], v22 offset:4832
    ds_read_b64 v[96:97], v21 offset:50992
    s_waitcnt lgkmcnt(8)
    v_mfma_f32_16x16x32_bf16 v[40:43], v[68:71], v[80:83], v[40:43]
    ds_read_b64 v[98:99], v21 offset:51000
    ds_read_b128 v[116:119], v22 offset:5344
    v_mfma_f32_16x16x32_bf16 v[44:47], v[68:71], v[84:87], v[44:47]
    ds_read_b64 v[100:101], v21 offset:50480
    ds_read_b64 v[102:103], v21 offset:50488
    s_waitcnt lgkmcnt(11)
    v_mfma_f32_16x16x32_bf16 v[44:47], v[64:67], v[88:91], v[44:47]
    ds_read_b128 v[120:123], v22 offset:5856
    s_waitcnt lgkmcnt(10)
    v_mfma_f32_16x16x32_bf16 v[44:47], v[72:75], v[80:83], v[44:47]
    ds_read_b64 v[104:105], v21 offset:49968
    ds_read_b64 v[106:107], v21 offset:49976
    v_mfma_f32_16x16x32_bf16 v[48:51], v[68:71], v[88:91], v[48:51]
    ds_read_b128 v[124:127], v22 offset:6368
    ds_read_b64 v[108:109], v21 offset:49456
    v_mfma_f32_16x16x32_bf16 v[48:51], v[72:75], v[84:87], v[48:51]
    ds_read_b64 v[110:111], v21 offset:49464
    s_waitcnt lgkmcnt(14)
    v_mfma_f32_16x16x32_bf16 v[48:51], v[64:67], v[92:95], v[48:51]
    s_waitcnt lgkmcnt(12)
    v_mfma_f32_16x16x32_bf16 v[48:51], v[76:79], v[80:83], v[48:51]
    s_waitcnt lgkmcnt(8)
    v_mfma_f32_16x16x32_bf16 v[52:55], v[96:99], v[116:119], v[52:55]
    ds_read_b128 v[80:83], v22 offset:128
    ds_read_b64 v[64:65], v21 offset:34288
    s_waitcnt lgkmcnt(8)
    v_mfma_f32_16x16x32_bf16 v[52:55], v[100:103], v[112:115], v[52:55]
    ds_read_b64 v[66:67], v21 offset:34296
    ds_read_b128 v[84:87], v22 offset:640
    v_mfma_f32_16x16x32_bf16 v[56:59], v[100:103], v[116:119], v[56:59]
    ds_read_b64 v[68:69], v21 offset:33776
    ds_read_b64 v[70:71], v21 offset:33784
    s_waitcnt lgkmcnt(11)
    v_mfma_f32_16x16x32_bf16 v[56:59], v[96:99], v[120:123], v[56:59]
    ds_read_b128 v[88:91], v22 offset:1152
    s_waitcnt lgkmcnt(10)
    v_mfma_f32_16x16x32_bf16 v[56:59], v[104:107], v[112:115], v[56:59]
    ds_read_b64 v[72:73], v21 offset:33264
    ds_read_b64 v[74:75], v21 offset:33272
    v_mfma_f32_16x16x32_bf16 v[60:63], v[100:103], v[120:123], v[60:63]
    ds_read_b128 v[92:95], v22 offset:1664
    ds_read_b64 v[76:77], v21 offset:32752
    v_mfma_f32_16x16x32_bf16 v[60:63], v[104:107], v[116:119], v[60:63]
    ds_read_b64 v[78:79], v21 offset:32760
    s_waitcnt lgkmcnt(14)
    v_mfma_f32_16x16x32_bf16 v[60:63], v[96:99], v[124:127], v[60:63]
    s_waitcnt lgkmcnt(12)
    v_mfma_f32_16x16x32_bf16 v[60:63], v[108:111], v[112:115], v[60:63]
    s_waitcnt lgkmcnt(8)
    v_mfma_f32_16x16x32_bf16 v[40:43], v[64:67], v[84:87], v[40:43]
    ds_read_b128 v[112:115], v22 offset:4768
    ds_read_b64 v[96:97], v21 offset:50928
    s_waitcnt lgkmcnt(8)
    v_mfma_f32_16x16x32_bf16 v[40:43], v[68:71], v[80:83], v[40:43]
    ds_read_b64 v[98:99], v21 offset:50936
    ds_read_b128 v[116:119], v22 offset:5280
    v_mfma_f32_16x16x32_bf16 v[44:47], v[68:71], v[84:87], v[44:47]
    ds_read_b64 v[100:101], v21 offset:50416
    ds_read_b64 v[102:103], v21 offset:50424
    s_waitcnt lgkmcnt(11)
    v_mfma_f32_16x16x32_bf16 v[44:47], v[64:67], v[88:91], v[44:47]
    ds_read_b128 v[120:123], v22 offset:5792
    s_waitcnt lgkmcnt(10)
    v_mfma_f32_16x16x32_bf16 v[44:47], v[72:75], v[80:83], v[44:47]
    ds_read_b64 v[104:105], v21 offset:49904
    ds_read_b64 v[106:107], v21 offset:49912
    v_mfma_f32_16x16x32_bf16 v[48:51], v[68:71], v[88:91], v[48:51]
    ds_read_b128 v[124:127], v22 offset:6304
    ds_read_b64 v[108:109], v21 offset:49392
    v_mfma_f32_16x16x32_bf16 v[48:51], v[72:75], v[84:87], v[48:51]
    ds_read_b64 v[110:111], v21 offset:49400
    s_waitcnt lgkmcnt(14)
    v_mfma_f32_16x16x32_bf16 v[48:51], v[64:67], v[92:95], v[48:51]
    s_waitcnt lgkmcnt(12)
    v_mfma_f32_16x16x32_bf16 v[48:51], v[76:79], v[80:83], v[48:51]
    s_waitcnt lgkmcnt(8)
    v_mfma_f32_16x16x32_bf16 v[52:55], v[96:99], v[116:119], v[52:55]
    ds_read_b128 v[80:83], v22 offset:64
    ds_read_b64 v[64:65], v21 offset:34224
    s_waitcnt lgkmcnt(8)
    v_mfma_f32_16x16x32_bf16 v[52:55], v[100:103], v[112:115], v[52:55]
    ds_read_b64 v[66:67], v21 offset:34232
    ds_read_b128 v[84:87], v22 offset:576
    v_mfma_f32_16x16x32_bf16 v[56:59], v[100:103], v[116:119], v[56:59]
    ds_read_b64 v[68:69], v21 offset:33712
    ds_read_b64 v[70:71], v21 offset:33720
    s_waitcnt lgkmcnt(11)
    v_mfma_f32_16x16x32_bf16 v[56:59], v[96:99], v[120:123], v[56:59]
    ds_read_b128 v[88:91], v22 offset:1088
    s_waitcnt lgkmcnt(10)
    v_mfma_f32_16x16x32_bf16 v[56:59], v[104:107], v[112:115], v[56:59]
    ds_read_b64 v[72:73], v21 offset:33200
    ds_read_b64 v[74:75], v21 offset:33208
    v_mfma_f32_16x16x32_bf16 v[60:63], v[100:103], v[120:123], v[60:63]
    ds_read_b128 v[92:95], v22 offset:1600
    ds_read_b64 v[76:77], v21 offset:32688
    v_mfma_f32_16x16x32_bf16 v[60:63], v[104:107], v[116:119], v[60:63]
    ds_read_b64 v[78:79], v21 offset:32696
    s_waitcnt lgkmcnt(14)
    v_mfma_f32_16x16x32_bf16 v[60:63], v[96:99], v[124:127], v[60:63]
    s_waitcnt lgkmcnt(12)
    v_mfma_f32_16x16x32_bf16 v[60:63], v[108:111], v[112:115], v[60:63]
    s_waitcnt lgkmcnt(8)
    v_mfma_f32_16x16x32_bf16 v[40:43], v[64:67], v[84:87], v[40:43]
    ds_read_b128 v[112:115], v22 offset:4704
    ds_read_b64 v[96:97], v21 offset:50864
    s_waitcnt lgkmcnt(8)
    v_mfma_f32_16x16x32_bf16 v[40:43], v[68:71], v[80:83], v[40:43]
    ds_read_b64 v[98:99], v21 offset:50872
    ds_read_b128 v[116:119], v22 offset:5216
    v_mfma_f32_16x16x32_bf16 v[44:47], v[68:71], v[84:87], v[44:47]
    ds_read_b64 v[100:101], v21 offset:50352
    ds_read_b64 v[102:103], v21 offset:50360
    s_waitcnt lgkmcnt(11)
    v_mfma_f32_16x16x32_bf16 v[44:47], v[64:67], v[88:91], v[44:47]
    ds_read_b128 v[120:123], v22 offset:5728
    s_waitcnt lgkmcnt(10)
    v_mfma_f32_16x16x32_bf16 v[44:47], v[72:75], v[80:83], v[44:47]
    ds_read_b64 v[104:105], v21 offset:49840
    ds_read_b64 v[106:107], v21 offset:49848
    v_mfma_f32_16x16x32_bf16 v[48:51], v[68:71], v[88:91], v[48:51]
    ds_read_b128 v[124:127], v22 offset:6240
    ds_read_b64 v[108:109], v21 offset:49328
    v_mfma_f32_16x16x32_bf16 v[48:51], v[72:75], v[84:87], v[48:51]
    ds_read_b64 v[110:111], v21 offset:49336
    s_waitcnt lgkmcnt(14)
    v_mfma_f32_16x16x32_bf16 v[48:51], v[64:67], v[92:95], v[48:51]
    s_waitcnt lgkmcnt(12)
    v_mfma_f32_16x16x32_bf16 v[48:51], v[76:79], v[80:83], v[48:51]
    s_waitcnt lgkmcnt(8)
    v_mfma_f32_16x16x32_bf16 v[52:55], v[96:99], v[116:119], v[52:55]
    ds_read_b128 v[80:83], v22 offset:0
    ds_read_b64 v[64:65], v21 offset:34160
    s_waitcnt lgkmcnt(8)
    v_mfma_f32_16x16x32_bf16 v[52:55], v[100:103], v[112:115], v[52:55]
    ds_read_b64 v[66:67], v21 offset:34168
    ds_read_b128 v[84:87], v22 offset:512
    v_mfma_f32_16x16x32_bf16 v[56:59], v[100:103], v[116:119], v[56:59]
    ds_read_b64 v[68:69], v21 offset:33648
    ds_read_b64 v[70:71], v21 offset:33656
    s_waitcnt lgkmcnt(11)
    v_mfma_f32_16x16x32_bf16 v[56:59], v[96:99], v[120:123], v[56:59]
    ds_read_b128 v[88:91], v22 offset:1024
    s_waitcnt lgkmcnt(10)
    v_mfma_f32_16x16x32_bf16 v[56:59], v[104:107], v[112:115], v[56:59]
    ds_read_b64 v[72:73], v21 offset:33136
    ds_read_b64 v[74:75], v21 offset:33144
    v_mfma_f32_16x16x32_bf16 v[60:63], v[100:103], v[120:123], v[60:63]
    ds_read_b128 v[92:95], v22 offset:1536
    ds_read_b64 v[76:77], v21 offset:32624
    v_mfma_f32_16x16x32_bf16 v[60:63], v[104:107], v[116:119], v[60:63]
    ds_read_b64 v[78:79], v21 offset:32632
    s_waitcnt lgkmcnt(14)
    v_mfma_f32_16x16x32_bf16 v[60:63], v[96:99], v[124:127], v[60:63]
    s_waitcnt lgkmcnt(12)
    v_mfma_f32_16x16x32_bf16 v[60:63], v[108:111], v[112:115], v[60:63]
    s_waitcnt lgkmcnt(8)
    v_mfma_f32_16x16x32_bf16 v[40:43], v[64:67], v[84:87], v[40:43]
    ds_read_b128 v[112:115], v22 offset:4640
    ds_read_b64 v[96:97], v21 offset:50800
    s_waitcnt lgkmcnt(8)
    v_mfma_f32_16x16x32_bf16 v[40:43], v[68:71], v[80:83], v[40:43]
    ds_read_b64 v[98:99], v21 offset:50808
    ds_read_b128 v[116:119], v22 offset:5152
    v_mfma_f32_16x16x32_bf16 v[44:47], v[68:71], v[84:87], v[44:47]
    ds_read_b64 v[100:101], v21 offset:50288
    ds_read_b64 v[102:103], v21 offset:50296
    s_waitcnt lgkmcnt(11)
    v_mfma_f32_16x16x32_bf16 v[44:47], v[64:67], v[88:91], v[44:47]
    ds_read_b128 v[120:123], v22 offset:5664
    s_waitcnt lgkmcnt(10)
    v_mfma_f32_16x16x32_bf16 v[44:47], v[72:75], v[80:83], v[44:47]
    ds_read_b64 v[104:105], v21 offset:49776
    ds_read_b64 v[106:107], v21 offset:49784
    v_mfma_f32_16x16x32_bf16 v[48:51], v[68:71], v[88:91], v[48:51]
    ds_read_b128 v[124:127], v22 offset:6176
    ds_read_b64 v[108:109], v21 offset:49264
    v_mfma_f32_16x16x32_bf16 v[48:51], v[72:75], v[84:87], v[48:51]
    ds_read_b64 v[110:111], v21 offset:49272
    s_waitcnt lgkmcnt(14)
    v_mfma_f32_16x16x32_bf16 v[48:51], v[64:67], v[92:95], v[48:51]
    s_waitcnt lgkmcnt(12)
    v_mfma_f32_16x16x32_bf16 v[48:51], v[76:79], v[80:83], v[48:51]
    s_waitcnt lgkmcnt(8)
    v_mfma_f32_16x16x32_bf16 v[52:55], v[96:99], v[116:119], v[52:55]
    s_waitcnt lgkmcnt(6)
    v_mfma_f32_16x16x32_bf16 v[52:55], v[100:103], v[112:115], v[52:55]
    v_mfma_f32_16x16x32_bf16 v[56:59], v[100:103], v[116:119], v[56:59]
    s_waitcnt lgkmcnt(5)
    v_mfma_f32_16x16x32_bf16 v[56:59], v[96:99], v[120:123], v[56:59]
    s_waitcnt lgkmcnt(3)
    v_mfma_f32_16x16x32_bf16 v[56:59], v[104:107], v[112:115], v[56:59]
    v_mfma_f32_16x16x32_bf16 v[60:63], v[100:103], v[120:123], v[60:63]
    v_mfma_f32_16x16x32_bf16 v[60:63], v[104:107], v[116:119], v[60:63]
    s_waitcnt lgkmcnt(2)
    v_mfma_f32_16x16x32_bf16 v[60:63], v[96:99], v[124:127], v[60:63]
    s_waitcnt lgkmcnt(0)
    v_mfma_f32_16x16x32_bf16 v[60:63], v[108:111], v[112:115], v[60:63]
    v_cvt_pk_bf16_f32 v40, v40, v41
    v_cvt_pk_bf16_f32 v41, v42, v43
    ds_write_b64 v23, v[40:41] offset:512
    v_cvt_pk_bf16_f32 v44, v44, v45
    v_cvt_pk_bf16_f32 v45, v46, v47
    ds_write_b64 v23, v[44:45] offset:1024
    v_cvt_pk_bf16_f32 v48, v48, v49
    v_cvt_pk_bf16_f32 v49, v50, v51
    ds_write_b64 v23, v[48:49] offset:1536
    v_cvt_pk_bf16_f32 v52, v52, v53
    v_cvt_pk_bf16_f32 v53, v54, v55
    ds_write_b64 v23, v[52:53] offset:4640
    v_cvt_pk_bf16_f32 v56, v56, v57
    v_cvt_pk_bf16_f32 v57, v58, v59
    ds_write_b64 v23, v[56:57] offset:5152
    v_cvt_pk_bf16_f32 v60, v60, v61
    v_cvt_pk_bf16_f32 v61, v62, v63
    ds_write_b64 v23, v[60:61] offset:5664
    s_branch L_c3d_125
L_c37_123:
    s_setprio 3
    ds_read_b128 v[80:83], v22 offset:9728
    ds_read_b64 v[64:65], v21 offset:4032
    ds_read_b64 v[66:67], v21 offset:4040
    ds_read_b128 v[84:87], v22 offset:10240
    ds_read_b64 v[68:69], v21 offset:3520
    ds_read_b64 v[70:71], v21 offset:3528
    ds_read_b128 v[88:91], v22 offset:10752
    ds_read_b64 v[72:73], v21 offset:3008
    ds_read_b64 v[74:75], v21 offset:3016
    ds_read_b128 v[92:95], v22 offset:11264
    ds_read_b64 v[76:77], v21 offset:2496
    ds_read_b64 v[78:79], v21 offset:2504
    s_waitcnt lgkmcnt(8)
    v_mfma_f32_16x16x32_bf16 v[40:43], v[64:67], v[84:87], 0
    ds_read_b128 v[112:115], v22 offset:9664
    ds_read_b64 v[96:97], v21 offset:3968
    s_waitcnt lgkmcnt(8)
    v_mfma_f32_16x16x32_bf16 v[40:43], v[68:71], v[80:83], v[40:43]
    ds_read_b64 v[98:99], v21 offset:3976
    ds_read_b128 v[116:119], v22 offset:10176
    v_mfma_f32_16x16x32_bf16 v[44:47], v[68:71], v[84:87], 0
    ds_read_b64 v[100:101], v21 offset:3456
    ds_read_b64 v[102:103], v21 offset:3464
    s_waitcnt lgkmcnt(11)
    v_mfma_f32_16x16x32_bf16 v[44:47], v[64:67], v[88:91], v[44:47]
    ds_read_b128 v[120:123], v22 offset:10688
    s_waitcnt lgkmcnt(10)
    v_mfma_f32_16x16x32_bf16 v[44:47], v[72:75], v[80:83], v[44:47]
    ds_read_b64 v[104:105], v21 offset:2944
    ds_read_b64 v[106:107], v21 offset:2952
    v_mfma_f32_16x16x32_bf16 v[48:51], v[68:71], v[88:91], 0
    ds_read_b128 v[124:127], v22 offset:11200
    ds_read_b64 v[108:109], v21 offset:2432
    v_mfma_f32_16x16x32_bf16 v[48:51], v[72:75], v[84:87], v[48:51]
    ds_read_b64 v[110:111], v21 offset:2440
    s_waitcnt lgkmcnt(14)
    v_mfma_f32_16x16x32_bf16 v[48:51], v[64:67], v[92:95], v[48:51]
    s_waitcnt lgkmcnt(12)
    v_mfma_f32_16x16x32_bf16 v[48:51], v[76:79], v[80:83], v[48:51]
    s_waitcnt lgkmcnt(8)
    v_mfma_f32_16x16x32_bf16 v[40:43], v[96:99], v[116:119], v[40:43]
    ds_read_b128 v[80:83], v22 offset:9600
    ds_read_b64 v[64:65], v21 offset:3904
    s_waitcnt lgkmcnt(8)
    v_mfma_f32_16x16x32_bf16 v[40:43], v[100:103], v[112:115], v[40:43]
    ds_read_b64 v[66:67], v21 offset:3912
    ds_read_b128 v[84:87], v22 offset:10112
    v_mfma_f32_16x16x32_bf16 v[44:47], v[100:103], v[116:119], v[44:47]
    ds_read_b64 v[68:69], v21 offset:3392
    ds_read_b64 v[70:71], v21 offset:3400
    s_waitcnt lgkmcnt(11)
    v_mfma_f32_16x16x32_bf16 v[44:47], v[96:99], v[120:123], v[44:47]
    ds_read_b128 v[88:91], v22 offset:10624
    s_waitcnt lgkmcnt(10)
    v_mfma_f32_16x16x32_bf16 v[44:47], v[104:107], v[112:115], v[44:47]
    ds_read_b64 v[72:73], v21 offset:2880
    ds_read_b64 v[74:75], v21 offset:2888
    v_mfma_f32_16x16x32_bf16 v[48:51], v[100:103], v[120:123], v[48:51]
    ds_read_b128 v[92:95], v22 offset:11136
    ds_read_b64 v[76:77], v21 offset:2368
    v_mfma_f32_16x16x32_bf16 v[48:51], v[104:107], v[116:119], v[48:51]
    ds_read_b64 v[78:79], v21 offset:2376
    s_waitcnt lgkmcnt(14)
    v_mfma_f32_16x16x32_bf16 v[48:51], v[96:99], v[124:127], v[48:51]
    s_waitcnt lgkmcnt(12)
    v_mfma_f32_16x16x32_bf16 v[48:51], v[108:111], v[112:115], v[48:51]
    s_waitcnt lgkmcnt(8)
    v_mfma_f32_16x16x32_bf16 v[40:43], v[64:67], v[84:87], v[40:43]
    ds_read_b128 v[112:115], v22 offset:9536
    ds_read_b64 v[96:97], v21 offset:3840
    s_waitcnt lgkmcnt(8)
    v_mfma_f32_16x16x32_bf16 v[40:43], v[68:71], v[80:83], v[40:43]
    ds_read_b64 v[98:99], v21 offset:3848
    ds_read_b128 v[116:119], v22 offset:10048
    v_mfma_f32_16x16x32_bf16 v[44:47], v[68:71], v[84:87], v[44:47]
    ds_read_b64 v[100:101], v21 offset:3328
    ds_read_b64 v[102:103], v21 offset:3336
    s_waitcnt lgkmcnt(11)
    v_mfma_f32_16x16x32_bf16 v[44:47], v[64:67], v[88:91], v[44:47]
    ds_read_b128 v[120:123], v22 offset:10560
    s_waitcnt lgkmcnt(10)
    v_mfma_f32_16x16x32_bf16 v[44:47], v[72:75], v[80:83], v[44:47]
    ds_read_b64 v[104:105], v21 offset:2816
    ds_read_b64 v[106:107], v21 offset:2824
    v_mfma_f32_16x16x32_bf16 v[48:51], v[68:71], v[88:91], v[48:51]
    ds_read_b128 v[124:127], v22 offset:11072
    ds_read_b64 v[108:109], v21 offset:2304
    v_mfma_f32_16x16x32_bf16 v[48:51], v[72:75], v[84:87], v[48:51]
    ds_read_b64 v[110:111], v21 offset:2312
    s_waitcnt lgkmcnt(14)
    v_mfma_f32_16x16x32_bf16 v[48:51], v[64:67], v[92:95], v[48:51]
    s_waitcnt lgkmcnt(12)
    v_mfma_f32_16x16x32_bf16 v[48:51], v[76:79], v[80:83], v[48:51]
    s_waitcnt lgkmcnt(8)
    v_mfma_f32_16x16x32_bf16 v[40:43], v[96:99], v[116:119], v[40:43]
    ds_read_b128 v[80:83], v22 offset:9472
    ds_read_b64 v[64:65], v21 offset:3776
    s_waitcnt lgkmcnt(8)
    v_mfma_f32_16x16x32_bf16 v[40:43], v[100:103], v[112:115], v[40:43]
    ds_read_b64 v[66:67], v21 offset:3784
    ds_read_b128 v[84:87], v22 offset:9984
    v_mfma_f32_16x16x32_bf16 v[44:47], v[100:103], v[116:119], v[44:47]
    ds_read_b64 v[68:69], v21 offset:3264
    ds_read_b64 v[70:71], v21 offset:3272
    s_waitcnt lgkmcnt(11)
    v_mfma_f32_16x16x32_bf16 v[44:47], v[96:99], v[120:123], v[44:47]
    ds_read_b128 v[88:91], v22 offset:10496
    s_waitcnt lgkmcnt(10)
    v_mfma_f32_16x16x32_bf16 v[44:47], v[104:107], v[112:115], v[44:47]
    ds_read_b64 v[72:73], v21 offset:2752
    ds_read_b64 v[74:75], v21 offset:2760
    v_mfma_f32_16x16x32_bf16 v[48:51], v[100:103], v[120:123], v[48:51]
    ds_read_b128 v[92:95], v22 offset:11008
    ds_read_b64 v[76:77], v21 offset:2240
    v_mfma_f32_16x16x32_bf16 v[48:51], v[104:107], v[116:119], v[48:51]
    ds_read_b64 v[78:79], v21 offset:2248
    s_waitcnt lgkmcnt(14)
    v_mfma_f32_16x16x32_bf16 v[48:51], v[96:99], v[124:127], v[48:51]
    s_waitcnt lgkmcnt(12)
    v_mfma_f32_16x16x32_bf16 v[48:51], v[108:111], v[112:115], v[48:51]
    s_waitcnt lgkmcnt(8)
    v_mfma_f32_16x16x32_bf16 v[40:43], v[64:67], v[84:87], v[40:43]
    ds_read_b128 v[112:115], v22 offset:9408
    ds_read_b64 v[96:97], v21 offset:3712
    s_waitcnt lgkmcnt(8)
    v_mfma_f32_16x16x32_bf16 v[40:43], v[68:71], v[80:83], v[40:43]
    ds_read_b64 v[98:99], v21 offset:3720
    ds_read_b128 v[116:119], v22 offset:9920
    v_mfma_f32_16x16x32_bf16 v[44:47], v[68:71], v[84:87], v[44:47]
    ds_read_b64 v[100:101], v21 offset:3200
    ds_read_b64 v[102:103], v21 offset:3208
    s_waitcnt lgkmcnt(11)
    v_mfma_f32_16x16x32_bf16 v[44:47], v[64:67], v[88:91], v[44:47]
    ds_read_b128 v[120:123], v22 offset:10432
    s_waitcnt lgkmcnt(10)
    v_mfma_f32_16x16x32_bf16 v[44:47], v[72:75], v[80:83], v[44:47]
    ds_read_b64 v[104:105], v21 offset:2688
    ds_read_b64 v[106:107], v21 offset:2696
    v_mfma_f32_16x16x32_bf16 v[48:51], v[68:71], v[88:91], v[48:51]
    ds_read_b128 v[124:127], v22 offset:10944
    ds_read_b64 v[108:109], v21 offset:2176
    v_mfma_f32_16x16x32_bf16 v[48:51], v[72:75], v[84:87], v[48:51]
    ds_read_b64 v[110:111], v21 offset:2184
    s_waitcnt lgkmcnt(14)
    v_mfma_f32_16x16x32_bf16 v[48:51], v[64:67], v[92:95], v[48:51]
    s_waitcnt lgkmcnt(12)
    v_mfma_f32_16x16x32_bf16 v[48:51], v[76:79], v[80:83], v[48:51]
    s_waitcnt lgkmcnt(8)
    v_mfma_f32_16x16x32_bf16 v[40:43], v[96:99], v[116:119], v[40:43]
    ds_read_b128 v[80:83], v22 offset:9344
    ds_read_b64 v[64:65], v21 offset:3648
    s_waitcnt lgkmcnt(8)
    v_mfma_f32_16x16x32_bf16 v[40:43], v[100:103], v[112:115], v[40:43]
    ds_read_b64 v[66:67], v21 offset:3656
    ds_read_b128 v[84:87], v22 offset:9856
    v_mfma_f32_16x16x32_bf16 v[44:47], v[100:103], v[116:119], v[44:47]
    ds_read_b64 v[68:69], v21 offset:3136
    ds_read_b64 v[70:71], v21 offset:3144
    s_waitcnt lgkmcnt(11)
    v_mfma_f32_16x16x32_bf16 v[44:47], v[96:99], v[120:123], v[44:47]
    ds_read_b128 v[88:91], v22 offset:10368
    s_waitcnt lgkmcnt(10)
    v_mfma_f32_16x16x32_bf16 v[44:47], v[104:107], v[112:115], v[44:47]
    ds_read_b64 v[72:73], v21 offset:2624
    ds_read_b64 v[74:75], v21 offset:2632
    v_mfma_f32_16x16x32_bf16 v[48:51], v[100:103], v[120:123], v[48:51]
    ds_read_b128 v[92:95], v22 offset:10880
    ds_read_b64 v[76:77], v21 offset:2112
    v_mfma_f32_16x16x32_bf16 v[48:51], v[104:107], v[116:119], v[48:51]
    ds_read_b64 v[78:79], v21 offset:2120
    s_waitcnt lgkmcnt(14)
    v_mfma_f32_16x16x32_bf16 v[48:51], v[96:99], v[124:127], v[48:51]
    s_waitcnt lgkmcnt(12)
    v_mfma_f32_16x16x32_bf16 v[48:51], v[108:111], v[112:115], v[48:51]
    s_waitcnt lgkmcnt(8)
    v_mfma_f32_16x16x32_bf16 v[40:43], v[64:67], v[84:87], v[40:43]
    ds_read_b128 v[112:115], v22 offset:9280
    ds_read_b64 v[96:97], v21 offset:3584
    s_waitcnt lgkmcnt(8)
    v_mfma_f32_16x16x32_bf16 v[40:43], v[68:71], v[80:83], v[40:43]
    ds_read_b64 v[98:99], v21 offset:3592
    ds_read_b128 v[116:119], v22 offset:9792
    v_mfma_f32_16x16x32_bf16 v[44:47], v[68:71], v[84:87], v[44:47]
    ds_read_b64 v[100:101], v21 offset:3072
    ds_read_b64 v[102:103], v21 offset:3080
    s_waitcnt lgkmcnt(11)
    v_mfma_f32_16x16x32_bf16 v[44:47], v[64:67], v[88:91], v[44:47]
    ds_read_b128 v[120:123], v22 offset:10304
    s_waitcnt lgkmcnt(10)
    v_mfma_f32_16x16x32_bf16 v[44:47], v[72:75], v[80:83], v[44:47]
    ds_read_b64 v[104:105], v21 offset:2560
    ds_read_b64 v[106:107], v21 offset:2568
    v_mfma_f32_16x16x32_bf16 v[48:51], v[68:71], v[88:91], v[48:51]
    ds_read_b128 v[124:127], v22 offset:10816
    ds_read_b64 v[108:109], v21 offset:2048
    v_mfma_f32_16x16x32_bf16 v[48:51], v[72:75], v[84:87], v[48:51]
    ds_read_b64 v[110:111], v21 offset:2056
    s_waitcnt lgkmcnt(14)
    v_mfma_f32_16x16x32_bf16 v[48:51], v[64:67], v[92:95], v[48:51]
    s_waitcnt lgkmcnt(12)
    v_mfma_f32_16x16x32_bf16 v[48:51], v[76:79], v[80:83], v[48:51]
    s_waitcnt lgkmcnt(8)
    v_mfma_f32_16x16x32_bf16 v[40:43], v[96:99], v[116:119], v[40:43]
    s_waitcnt lgkmcnt(6)
    v_mfma_f32_16x16x32_bf16 v[40:43], v[100:103], v[112:115], v[40:43]
    v_mfma_f32_16x16x32_bf16 v[44:47], v[100:103], v[116:119], v[44:47]
    s_waitcnt lgkmcnt(5)
    v_mfma_f32_16x16x32_bf16 v[44:47], v[96:99], v[120:123], v[44:47]
    s_waitcnt lgkmcnt(3)
    v_mfma_f32_16x16x32_bf16 v[44:47], v[104:107], v[112:115], v[44:47]
    v_mfma_f32_16x16x32_bf16 v[48:51], v[100:103], v[120:123], v[48:51]
    v_mfma_f32_16x16x32_bf16 v[48:51], v[104:107], v[116:119], v[48:51]
    s_waitcnt lgkmcnt(2)
    v_mfma_f32_16x16x32_bf16 v[48:51], v[96:99], v[124:127], v[48:51]
    s_waitcnt lgkmcnt(0)
    v_mfma_f32_16x16x32_bf16 v[48:51], v[108:111], v[112:115], v[48:51]
    v_cvt_pk_bf16_f32 v40, v40, v41
    v_cvt_pk_bf16_f32 v41, v42, v43
    ds_write_b64 v23, v[40:41] offset:8768
    v_cvt_pk_bf16_f32 v44, v44, v45
    v_cvt_pk_bf16_f32 v45, v46, v47
    ds_write_b64 v23, v[44:45] offset:9280
    s_nop 1
    v_cvt_pk_bf16_f32 v48, v48, v49
    v_cvt_pk_bf16_f32 v49, v50, v51
    ds_write_b64 v23, v[48:49] offset:9792
L_c3d_125:
    s_setprio 1
    s_waitcnt lgkmcnt(0)
    s_barrier
    s_xor_b32 s60, s60, 0x80000000
    s_cmp_ge_u32 s61, 6
    s_cbranch_scc1 L_ytd_126
    v_add_u32 v5, 63872, v36
    ds_read_b32 v60, v5 offset:0
    ds_read_b32 v61, v5 offset:4
    ds_read_b32 v62, v5 offset:8
    ds_read_b32 v64, v5 offset:4128
    ds_read_b32 v65, v5 offset:4132
    ds_read_b32 v66, v5 offset:4136
    ds_read_b32 v68, v5 offset:8256
    ds_read_b32 v69, v5 offset:8260
    ds_read_b32 v70, v5 offset:8264
    v_lshlrev_b32 v4, 4, v0
    s_mul_i32 s88, s62, 5504
    s_add_u32 s88, s88, 9437184
    s_add_u32 s89, s88, 5504
    s_add_u32 s90, s89, 5504
    v_mov_b32 v63, s60
    v_mov_b32 v67, s60
    v_mov_b32 v71, s60
    s_cmp_eq_u32 s61, 5
    s_cselect_b32 exec_lo, 0xffffff, -1
    s_cselect_b32 exec_hi, 0, -1
    s_waitcnt lgkmcnt(6)
    buffer_store_dwordx4 v[60:63], v4, s[52:55], s88 offen sc0 sc1
    s_waitcnt lgkmcnt(3)
    buffer_store_dwordx4 v[64:67], v4, s[52:55], s89 offen sc0 sc1
    s_waitcnt lgkmcnt(0)
    buffer_store_dwordx4 v[68:71], v4, s[52:55], s90 offen sc0 sc1
    s_mov_b64 exec, -1
L_ytd_126:
    s_cmp_lg_u32 s61, 0
    s_cbranch_scc1 L_nofl_127
    s_lshl_b32 s75, s3, 7
    s_add_u32 s75, s75, 196608
    v_mov_b32 v7, 0
    v_mov_b32 v8, s60
    s_waitcnt vmcnt(2)
    s_mov_b64 exec, 1
    buffer_store_dword v8, v7, s[52:55], s75 offen sc0 sc1
    s_mov_b64 exec, -1
L_nofl_127:
L_bt2_66:
    s_cmp_ge_u32 s3, 220
    s_cbranch_scc1 L_fin
    v_mul_u32_u24 v24, 768, v2
    v_lshrrev_b32 v5, 7, v0
    v_and_b32 v6, 7, v2
    v_xor_b32 v5, v5, v6
    v_lshl_add_u32 v24, v5, 4, v24
    v_bfe_u32 v5, v0, 4, 3
    v_lshl_add_u32 v24, v5, 1, v24
    v_and_b32 v7, 7, v0
    v_lshrrev_b32 v8, 3, v0
    v_mul_u32_u24 v27, 2560, v8
    v_lshl_add_u32 v27, v7, 4, v27
    v_mul_u32_u24 v9, 43, v8
    v_bfe_u32 v9, v9, 8, 3
    v_xor_b32 v9, v9, v7
    v_lshlrev_b32 v9, 4, v9
    v_lshl_add_u32 v25, v8, 7, v9
    v_add_u32 v8, 64, v8
    v_mul_u32_u24 v9, 43, v8
    v_bfe_u32 v9, v9, 8, 3
    v_xor_b32 v9, v9, v7
    v_lshlrev_b32 v9, 4, v9
    v_lshl_add_u32 v26, v8, 7, v9
    s_lshl_b32 s75, s68, 6
    s_lshl_b32 s76, s61, 3
    s_add_u32 s75, s75, s76
    v_lshl_add_u32 v4, v1, 1, s75
    v_add_u32 v5, 116, v4
    v_mul_u32_u24 v5, 21846, v5
    v_lshrrev_b32 v5, 16, v5
    v_lshrrev_b32 v4, 1, v4
    v_min_u32 v4, v4, v5
    v_lshlrev_b32 v4, 7, v4
    s_add_u32 s88, s69, 9437184
    s_add_u32 s89, s88, 176128
    s_mul_i32 s90, s67, 245760
    s_lshl_b32 s78, s68, 7
    s_add_u32 s90, s90, s78
    s_add_u32 s90, s90, 1280
    s_add_u32 s91, s90, 163840
    s_cmp_ge_u32 s61, 4
    s_cselect_b32 s91, 1073741824, s91
    s_mov_b32 s79, 0
    s_mov_b32 s75, 196608
    s_mov_b64 exec, 15
L_prb_128:
    buffer_load_dword v9, v4, s[52:55], s75 offen sc0 sc1
    s_waitcnt vmcnt(0)
    v_cmp_ne_u32 vcc, s60, v9
    s_nop 0
    s_and_b64 exec, exec, vcc
    s_cbranch_execz L_prbd_129
    s_add_u32 s79, s79, 1
    s_cmp_gt_u32 s79, 200000
    s_cbranch_scc1 L_prbd_129
    s_sleep 3
    s_branch L_prb_128
L_prbd_129:
    s_mov_b64 exec, -1
    s_cmp_ge_u32 s3, 220
    s_cbranch_scc1 L_notile_130
    s_cmp_eq_u32 s67, 21
    s_cselect_b32 exec_lo, 0x00ff00ff, -1
    s_cselect_b32 exec_hi, 0x00ff00ff, -1
    s_mov_b64 s[80:81], exec
    buffer_load_dwordx4 v[80:83], v15, s[52:55], s88 offen sc0 sc1
    buffer_load_dwordx4 v[84:87], v15, s[52:55], s89 offen sc0 sc1
    s_mov_b32 s79, 0
L_poll_131:
    s_waitcnt vmcnt(0)
    v_cmp_ne_u32 vcc, s60, v83
    v_cmp_ne_u32 s[82:83], s60, v87
    s_nop 0
    s_or_b64 vcc, vcc, s[82:83]
    s_and_b64 exec, exec, vcc
    s_cbranch_execz L_polld_132
    s_add_u32 s79, s79, 1
    s_cmp_gt_u32 s79, 200000
    s_cbranch_scc1 L_polld_132
    s_sleep 4
    buffer_load_dwordx4 v[80:83], v15, s[52:55], s88 offen sc0 sc1
    buffer_load_dwordx4 v[84:87], v15, s[52:55], s89 offen sc0 sc1
    s_branch L_poll_131
L_polld_132:
    s_mov_b64 exec, s[80:81]
    v_xor_b32 v5, 64, v24
    ds_write_b16 v24, v80 offset:0
    ds_write_b16_d16_hi v24, v80 offset:128
    ds_write_b16 v24, v81 offset:256
    ds_write_b16_d16_hi v24, v81 offset:384
    ds_write_b16 v24, v82 offset:512
    ds_write_b16_d16_hi v24, v82 offset:640
    ds_write_b16 v5, v84 offset:0
    ds_write_b16_d16_hi v5, v84 offset:128
    ds_write_b16 v5, v85 offset:256
    ds_write_b16_d16_hi v5, v85 offset:384
    ds_write_b16 v5, v86 offset:512
    ds_write_b16_d16_hi v5, v86 offset:640
    s_mov_b64 exec, -1
    s_waitcnt lgkmcnt(0)
    s_barrier
    ds_read_b128 v[80:83], v25
    ds_read_b128 v[84:87], v26
    s_waitcnt lgkmcnt(1)
    buffer_store_dwordx4 v[80:83], v27, s[48:51], s90 offen
    s_waitcnt lgkmcnt(0)
    buffer_store_dwordx4 v[84:87], v27, s[48:51], s91 offen
L_notile_130:
    s_nop 0
    s_branch L_fin
L_epoch:
    s_lshl_b32 s75, s3, 3
    s_add_u32 s75, s75, s61
    s_cmp_lg_u32 s75, 2016
    s_cbranch_scc1 L_fin
    v_lshlrev_b32 v4, 7, v1
    s_mov_b32 s79, 0
    s_xor_b32 s78, s60, 0x80000000
    v_min_u32 v5, 7552, v4
    s_mov_b32 s75, 222208
    s_mov_b64 exec, 1
L_ep0_135:
    s_sleep 24
    buffer_load_dword v20, v4, s[52:55], s75 offen sc0 sc1
    s_waitcnt vmcnt(0)
    v_cmp_ne_u32 vcc, s78, v20
    s_add_u32 s79, s79, 1
    s_cmp_gt_u32 s79, 200000
    s_nop 1
    s_cbranch_scc1 L_epd_134
    s_cbranch_vccnz L_ep0_135
    s_mov_b64 exec, -1
L_ep_133:
    s_sleep 8
    s_mov_b32 s75, 65536
    buffer_load_dword v20, v4, s[52:55], s75 offen sc0 sc1
    s_mov_b32 s75, 196608
    buffer_load_dword v24, v4, s[52:55], s75 offen sc0 sc1
    s_mov_b32 s75, 73728
    buffer_load_dword v21, v4, s[52:55], s75 offen sc0 sc1
    s_mov_b32 s75, 204800
    buffer_load_dword v25, v4, s[52:55], s75 offen sc0 sc1
    s_mov_b32 s75, 81920
    buffer_load_dword v22, v4, s[52:55], s75 offen sc0 sc1
    s_mov_b32 s75, 212992
    buffer_load_dword v26, v4, s[52:55], s75 offen sc0 sc1
    s_mov_b32 s75, 90112
    buffer_load_dword v23, v4, s[52:55], s75 offen sc0 sc1
    s_mov_b32 s75, 221184
    buffer_load_dword v27, v5, s[52:55], s75 offen sc0 sc1
    s_waitcnt vmcnt(0)
    v_xor_b32 v20, s60, v20
    v_xor_b32 v24, s78, v24
    v_xor_b32 v21, s60, v21
    v_xor_b32 v25, s78, v25
    v_xor_b32 v22, s60, v22
    v_xor_b32 v26, s78, v26
    v_xor_b32 v23, s60, v23
    v_xor_b32 v27, s78, v27
    v_or_b32 v20, v20, v21
    v_or_b32 v20, v20, v22
    v_or_b32 v20, v20, v23
    v_or_b32 v20, v20, v24
    v_or_b32 v20, v20, v25
    v_or_b32 v20, v20, v26
    v_or_b32 v20, v20, v27
    v_cmp_ne_u32 vcc, 0, v20
    s_add_u32 s79, s79, 1
    s_cmp_gt_u32 s79, 200000
    s_nop 1
    s_cbranch_scc1 L_epd_134
    s_cbranch_vccnz L_ep_133
L_epd_134:
    v_mov_b32 v6, 0
    v_mov_b32 v7, s60
    s_mov_b64 exec, 1
    buffer_store_dword v7, v6, s[52:55], 0 offen
    s_mov_b64 exec, -1
L_fin:
L_end:
    s_endpgm
.p2align 8
.type L_table,@object
L_table:
.long 40496,41264,40496,41264,40508,41276,40508,41276,40520,41288,40520,41288,40532,41300,40532,41300
.long 40544,41312,40544,41312,40556,41324,40556,41324,40568,41336,40568,41336,40580,41348,40580,41348
.long 32768,33536,32768,33536,32780,33548,32780,33548,32792,33560,32792,33560,32804,33572,32804,33572
.long 32816,33584,32816,33584,32828,33596,32828,33596,32840,33608,32840,33608,32852,33620,32852,33620
.long 35344,36112,35344,36112,35356,36124,35356,36124,35368,36136,35368,36136,35380,36148,35380,36148
.long 35392,36160,35392,36160,35404,36172,35404,36172,35416,36184,35416,36184,35428,36196,35428,36196
.long 37920,38688,37920,38688,37932,38700,37932,38700,37944,38712,37944,38712,37956,38724,37956,38724
.long 37968,38736,37968,38736,37980,38748,37980,38748,37992,38760,37992,38760,38004,38772,38004,38772
.long 42032,42800,42032,42800,42044,42812,42044,42812,42056,42824,42056,42824,42068,42836,42068,42836
.long 42080,42848,42080,42848,42092,42860,42092,42860,42104,42872,42104,42872,42116,42884,42116,42884
.long 39200,39968,39204,39972,39212,39980,39216,39984,39224,39992,39228,39996,39236,40004,39240,40008
.long 39248,40016,39252,40020,39260,40028,39264,40032,39272,40040,39276,40044,39284,40052,39288,40056
.long 36624,37392,36628,37396,36636,37404,36640,37408,36648,37416,36652,37420,36660,37428,36664,37432
.long 36672,37440,36676,37444,36684,37452,36688,37456,36696,37464,36700,37468,36708,37476,36712,37480
.long 34048,34816,34052,34820,34060,34828,34064,34832,34072,34840,34076,34844,34084,34852,34088,34856
.long 34096,34864,34100,34868,34108,34876,34112,34880,34120,34888,34124,34892,34132,34900,34136,34904
.long 40592,41360,40592,41360,40604,41372,40604,41372,40616,41384,40616,41384,40628,41396,40628,41396
.long 40640,41408,40640,41408,40652,41420,40652,41420,40664,41432,40664,41432,40676,41444,40676,41444
.long 32864,33632,32864,33632,32876,33644,32876,33644,32888,33656,32888,33656,32900,33668,32900,33668
.long 32912,33680,32912,33680,32924,33692,32924,33692,32936,33704,32936,33704,32948,33716,32948,33716
.long 35440,36208,35440,36208,35452,36220,35452,36220,35464,36232,35464,36232,35476,36244,35476,36244
.long 35488,36256,35488,36256,35500,36268,35500,36268,35512,36280,35512,36280,35524,36292,35524,36292
.long 38016,38784,38016,38784,38028,38796,38028,38796,38040,38808,38040,38808,38052,38820,38052,38820
.long 38064,38832,38064,38832,38076,38844,38076,38844,38088,38856,38088,38856,38100,38868,38100,38868
.long 42128,42896,42128,42896,42140,42908,42140,42908,42152,42920,42152,42920,42164,42932,42164,42932
.long 42176,42944,42176,42944,42188,42956,42188,42956,42200,42968,42200,42968,42212,42980,42212,42980
.long 39296,40064,39300,40068,39308,40076,39312,40080,39320,40088,39324,40092,39332,40100,39336,40104
.long 39344,40112,39348,40116,39356,40124,39360,40128,39368,40136,39372,40140,39380,40148,39384,40152
.long 36720,37488,36724,37492,36732,37500,36736,37504,36744,37512,36748,37516,36756,37524,36760,37528
.long 36768,37536,36772,37540,36780,37548,36784,37552,36792,37560,36796,37564,36804,37572,36808,37576
.long 34144,34912,34148,34916,34156,34924,34160,34928,34168,34936,34172,34940,34180,34948,34184,34952
.long 34192,34960,34196,34964,34204,34972,34208,34976,34216,34984,34220,34988,34228,34996,34232,35000
.long 40688,41456,40688,41456,40700,41468,40700,41468,40712,41480,40712,41480,40724,41492,40724,41492
.long 40736,41504,40736,41504,40748,41516,40748,41516,40760,41528,40760,41528,40772,41540,40772,41540
.long 32960,33728,32960,33728,32972,33740,32972,33740,32984,33752,32984,33752,32996,33764,32996,33764
.long 33008,33776,33008,33776,33020,33788,33020,33788,33032,33800,33032,33800,33044,33812,33044,33812
.long 35536,36304,35536,36304,35548,36316,35548,36316,35560,36328,35560,36328,35572,36340,35572,36340
.long 35584,36352,35584,36352,35596,36364,35596,36364,35608,36376,35608,36376,35620,36388,35620,36388
.long 38112,38880,38112,38880,38124,38892,38124,38892,38136,38904,38136,38904,38148,38916,38148,38916
.long 38160,38928,38160,38928,38172,38940,38172,38940,38184,38952,38184,38952,38196,38964,38196,38964
.long 42224,42992,42224,42992,42236,43004,42236,43004,42248,43016,42248,43016,42260,43028,42260,43028
.long 42272,43040,42272,43040,42284,43052,42284,43052,42296,43064,42296,43064,42308,43076,42308,43076
.long 39392,40160,39396,40164,39404,40172,39408,40176,39416,40184,39420,40188,39428,40196,39432,40200
.long 39440,40208,39444,40212,39452,40220,39456,40224,39464,40232,39468,40236,39476,40244,39480,40248
.long 36816,37584,36820,37588,36828,37596,36832,37600,36840,37608,36844,37612,36852,37620,36856,37624
.long 36864,37632,36868,37636,36876,37644,36880,37648,36888,37656,36892,37660,36900,37668,36904,37672
.long 34240,35008,34244,35012,34252,35020,34256,35024,34264,35032,34268,35036,34276,35044,34280,35048
.long 34288,35056,34292,35060,34300,35068,34304,35072,34312,35080,34316,35084,34324,35092,34328,35096
.long 40784,41552,40784,41552,40796,41564,40796,41564,40808,41576,40808,41576,40820,41588,40820,41588
.long 40832,41600,40832,41600,40844,41612,40844,41612,40856,41624,40856,41624,40868,41636,40868,41636
.long 33056,33824,33056,33824,33068,33836,33068,33836,33080,33848,33080,33848,33092,33860,33092,33860
.long 33104,33872,33104,33872,33116,33884,33116,33884,33128,33896,33128,33896,33140,33908,33140,33908
.long 35632,36400,35632,36400,35644,36412,35644,36412,35656,36424,35656,36424,35668,36436,35668,36436
.long 35680,36448,35680,36448,35692,36460,35692,36460,35704,36472,35704,36472,35716,36484,35716,36484
.long 38208,38976,38208,38976,38220,38988,38220,38988,38232,39000,38232,39000,38244,39012,38244,39012
.long 38256,39024,38256,39024,38268,39036,38268,39036,38280,39048,38280,39048,38292,39060,38292,39060
.long 42320,43088,42320,43088,42332,43100,42332,43100,42344,43112,42344,43112,42356,43124,42356,43124
.long 42368,43136,42368,43136,42380,43148,42380,43148,42392,43160,42392,43160,42404,43172,42404,43172
.long 39488,40256,39492,40260,39500,40268,39504,40272,39512,40280,39516,40284,39524,40292,39528,40296
.long 39536,40304,39540,40308,39548,40316,39552,40320,39560,40328,39564,40332,39572,40340,39576,40344
.long 36912,37680,36916,37684,36924,37692,36928,37696,36936,37704,36940,37708,36948,37716,36952,37720
.long 36960,37728,36964,37732,36972,37740,36976,37744,36984,37752,36988,37756,36996,37764,37000,37768
.long 34336,35104,34340,35108,34348,35116,34352,35120,34360,35128,34364,35132,34372,35140,34376,35144
.long 34384,35152,34388,35156,34396,35164,34400,35168,34408,35176,34412,35180,34420,35188,34424,35192
.long 40880,41648,40880,41648,40892,41660,40892,41660,40904,41672,40904,41672,40916,41684,40916,41684
.long 40928,41696,40928,41696,40940,41708,40940,41708,40952,41720,40952,41720,40964,41732,40964,41732
.long 33152,33920,33152,33920,33164,33932,33164,33932,33176,33944,33176,33944,33188,33956,33188,33956
.long 33200,33968,33200,33968,33212,33980,33212,33980,33224,33992,33224,33992,33236,34004,33236,34004
.long 35728,36496,35728,36496,35740,36508,35740,36508,35752,36520,35752,36520,35764,36532,35764,36532
.long 35776,36544,35776,36544,35788,36556,35788,36556,35800,36568,35800,36568,35812,36580,35812,36580
.long 38304,39072,38304,39072,38316,39084,38316,39084,38328,39096,38328,39096,38340,39108,38340,39108
.long 38352,39120,38352,39120,38364,39132,38364,39132,38376,39144,38376,39144,38388,39156,38388,39156
.long 42416,43184,42416,43184,42428,43196,42428,43196,42440,43208,42440,43208,42452,43220,42452,43220
.long 42464,43232,42464,43232,42476,43244,42476,43244,42488,43256,42488,43256,42500,43268,42500,43268
.long 39584,40352,39588,40356,39596,40364,39600,40368,39608,40376,39612,40380,39620,40388,39624,40392
.long 39632,40400,39636,40404,39644,40412,39648,40416,39656,40424,39660,40428,39668,40436,39672,40440
.long 37008,37776,37012,37780,37020,37788,37024,37792,37032,37800,37036,37804,37044,37812,37048,37816
.long 37056,37824,37060,37828,37068,37836,37072,37840,37080,37848,37084,37852,37092,37860,37096,37864
.long 34432,35200,34436,35204,34444,35212,34448,35216,34456,35224,34460,35228,34468,35236,34472,35240
.long 34480,35248,34484,35252,34492,35260,34496,35264,34504,35272,34508,35276,34516,35284,34520,35288
.long 40976,41744,40976,41744,40988,41756,40988,41756,41000,41768,41000,41768,41012,41780,41012,41780
.long 41024,41792,41024,41792,41036,41804,41036,41804,41048,41816,41048,41816,41060,41828,41060,41828
.long 33248,34016,33248,34016,33260,34028,33260,34028,33272,34040,33272,34040,33284,43568,33284,43568
.long 33296,43568,33296,43568,33308,43568,33308,43568,33320,43568,33320,43568,33332,43568,33332,43568
.long 35824,36592,35824,36592,35836,36604,35836,36604,35848,36616,35848,36616,35860,43568,35860,43568
.long 35872,43568,35872,43568,35884,43568,35884,43568,35896,43568,35896,43568,35908,43568,35908,43568
.long 38400,39168,38400,39168,38412,39180,38412,39180,38424,39192,38424,39192,38436,43568,38436,43568
.long 38448,43568,38448,43568,38460,43568,38460,43568,38472,43568,38472,43568,38484,43568,38484,43568
.long 42512,43280,42512,43280,42524,43292,42524,43292,42536,43304,42536,43304,42548,43316,42548,43316
.long 42560,43328,42560,43328,42572,43340,42572,43340,42584,43352,42584,43352,42596,43364,42596,43364
.long 39680,40448,39684,40452,39692,40460,39696,40464,39704,40472,39708,40476,39716,43568,39720,43568
.long 39728,43568,39732,43568,39740,43568,39744,43568,39752,43568,39756,43568,39764,43568,39768,43568
.long 37104,37872,37108,37876,37116,37884,37120,37888,37128,37896,37132,37900,37140,43568,37144,43568
.long 37152,43568,37156,43568,37164,43568,37168,43568,37176,43568,37180,43568,37188,43568,37192,43568
.long 34528,35296,34532,35300,34540,35308,34544,35312,34552,35320,34556,35324,34564,43568,34568,43568
.long 34576,43568,34580,43568,34588,43568,34592,43568,34600,43568,34604,43568,34612,43568,34616,43568
.long 41072,41840,41072,41840,41084,41852,41084,41852,41096,41864,41096,41864,41108,41876,41108,41876
.long 41120,41888,41120,41888,41132,41900,41132,41900,41144,41912,41144,41912,41156,41924,41156,41924
.long 33344,43376,33344,43376,33356,43388,33356,43388,33368,43400,33368,43400,33380,43412,33380,43412
.long 33392,43424,33392,43424,33404,43436,33404,43436,33416,43448,33416,43448,33428,43460,33428,43460
.long 35920,41936,35920,41936,35932,41948,35932,41948,35944,41960,35944,41960,35956,41972,35956,41972
.long 35968,41984,35968,41984,35980,41996,35980,41996,35992,42008,35992,42008,36004,42020,36004,42020
.long 38496,43472,38496,43472,38508,43484,38508,43484,38520,43496,38520,43496,38532,43508,38532,43508
.long 38544,43520,38544,43520,38556,43532,38556,43532,38568,43544,38568,43544,38580,43556,38580,43556
.long 42608,43568,42608,43568,42620,43568,42620,43568,42632,43568,42632,43568,42644,43568,42644,43568
.long 42656,43568,42656,43568,42668,43568,42668,43568,42680,43568,42680,43568,42692,43568,42692,43568
.long 39776,43568,39780,43568,39788,43568,39792,43568,39800,43568,39804,43568,39812,43568,39816,43568
.long 39824,43568,39828,43568,39836,43568,39840,43568,39848,43568,39852,43568,39860,43568,39864,43568
.long 37200,43568,37204,43568,37212,43568,37216,43568,37224,43568,37228,43568,37236,43568,37240,43568
.long 37248,43568,37252,43568,37260,43568,37264,43568,37272,43568,37276,43568,37284,43568,37288,43568
.long 34624,43568,34628,43568,34636,43568,34640,43568,34648,43568,34652,43568,34660,43568,34664,43568
.long 34672,43568,34676,43568,34684,43568,34688,43568,34696,43568,34700,43568,34708,43568,34712,43568
.long 41168,43568,41168,43568,41180,43568,41180,43568,41192,43568,41192,43568,41204,43568,41204,43568
.long 41216,43568,41216,43568,41228,43568,41228,43568,41240,43568,41240,43568,41252,43568,41252,43568
.long 33440,43568,33440,43568,33452,43568,33452,43568,33464,43568,33464,43568,33476,43568,33476,43568
.long 33488,43568,33488,43568,33500,43568,33500,43568,33512,43568,33512,43568,33524,43568,33524,43568
.long 36016,43568,36016,43568,36028,43568,36028,43568,36040,43568,36040,43568,36052,43568,36052,43568
.long 36064,43568,36064,43568,36076,43568,36076,43568,36088,43568,36088,43568,36100,43568,36100,43568
.long 38592,43568,38592,43568,38604,43568,38604,43568,38616,43568,38616,43568,38628,43568,38628,43568
.long 38640,43568,38640,43568,38652,43568,38652,43568,38664,43568,38664,43568,38676,43568,38676,43568
.long 42704,43568,42704,43568,42716,43568,42716,43568,42728,43568,42728,43568,42740,43568,42740,43568
.long 42752,43568,42752,43568,42764,43568,42764,43568,42776,43568,42776,43568,42788,43568,42788,43568
.long 39872,43568,39876,43568,39884,43568,39888,43568,39896,43568,39900,43568,39908,43568,39912,43568
.long 39920,43568,39924,43568,39932,43568,39936,43568,39944,43568,39948,43568,39956,43568,39960,43568
.long 37296,43568,37300,43568,37308,43568,37312,43568,37320,43568,37324,43568,37332,43568,37336,43568
.long 37344,43568,37348,43568,37356,43568,37360,43568,37368,43568,37372,43568,37380,43568,37384,43568
.long 34720,43568,34724,43568,34732,43568,34736,43568,34744,43568,34748,43568,34756,43568,34760,43568
.long 34768,43568,34772,43568,34780,43568,34784,43568,34792,43568,34796,43568,34804,43568,34808,43568
.long 78552,78552,78552,78552,78550,78550,78550,78548,78548,78548,78548,78548,78546,78546,78546,78544
.long 78544,78544,78544,78544,78542,78542,78542,78540,78540,78540,78540,78540,78538,78538,78538,78536
.long 78536,78536,78536,78536,78534,78534,78534,78532,78532,78532,78532,78532,78530,78530,78530,78528
.long 78528,78528,78528,78528,78526,78526,78526,78524,78524,78524,78524,78524,78522,78522,78522,78520
.long 78520,78520,78520,78520,78518,78518,78518,78516,78516,78516,78516,78516,78514,78514,78514,78512
.long 78512,78512,78512,78512,78510,78510,78510,78508,78508,78508,78508,78508,78506,78506,78506,78504
.long 78504,78504,78504,78504,78502,78502,78502,78500,78500,78500,78500,78500,78498,78498,78498,78496
.long 78496,78496,78496,78496,78494,78494,78494,78492,78492,78492,78492,78492,78490,78490,78490,78488
.long 78488,78488,78488,78488,78486,78486,78486,78484,78484,78484,78484,78484,78482,78482,78482,78480
.long 78480,78480,78480,78480,78478,78478,78478,78476,78476,78476,78476,78476,78474,78474,78474,78472
.long 78472,78472,78472,78472,78470,78470,78470,78468,78468,78468,78468,78468,78466,78466,78466,78464
.long 78464,78464,78464,78464,78462,78462,78462,78460,78460,78460,78460,78460,78458,78458,78458,78456
.long 78456,78456,78456,78456,78454,78454,78454,78452,78452,78452,78452,78452,78450,78450,78450,78448
.long 78448,78448,78448,78448,78446,78446,78446,78444,78444,78444,78444,78444,78442,78442,78442,78440
.long 78440,78440,78440,78440,78438,78438,78438,78436,78436,78436,78436,78436,78434,78434,78434,78432
.long 78432,78432,78432,78432,78430,78430,78430,78428,78428,78428,78428,78428,78426,78426,78426,78424
.long 78424,78424,78424,78424,78422,78422,78422,78420,78420,78420,78420,78420,78418,78418,78418,78416
.long 78416,78416,78416,78416,78414,78414,78414,78412,78412,78412,78412,78412,78410,78410,78410,78408
.long 78408,78408,78408,78408,78406,78406,78406,78404,78404,78404,78404,78404,78402,78402,78402,78400
.long 78400,78400,78400,78400,78398,78398,78398,78396,78396,78396,78396,78396,78394,78394,78394,78392
.long 78392,78392,78392,78392,78390,78390,78390,78388,78388,78388,78388,78388,78386,78386,78386,78384
.long 78384,78384,78384,78384,78382,78382,78382,78380,78380,78380,78380,78380,78378,78378,78378,78376
.long 78376,78376,78376,78376,78374,78374,78374,78372,78372,78372,78372,78372,78370,78370,78370,78368
.long 78368,78368,78368,78368,78366,78366,78366,78364,78364,78364,78364,78364,78362,78362,78362,78360
.long 78360,78360,78360,78360,78358,78358,78358,78356,78356,78356,78356,78356,78354,78354,78354,78352
.long 78352,78352,78352,78352,78350,78350,78350,78348,78348,78348,78348,78348,78346,78346,78346,78344
.long 78344,78344,78344,78344,78342,78342,78342,78340,78340,78340,78340,78340,78338,78338,78338,78336
.long 78336,78336,78336,78336,78334,78334,78334,78332,78332,78332,78332,78332,78330,78330,78330,78328
.long 78328,78328,78328,78328,78326,78326,78326,78324,78324,78324,78324,78324,78322,78322,78322,78320
.long 78320,78320,78320,78320,78318,78318,78318,78316,78316,78316,78316,78316,78314,78314,78314,78312
.long 78312,78312,78312,78312,78310,78310,78310,78308,78308,78308,78308,78308,78306,78306,78306,78304
.long 78304,78304,78304,78304,78302,78302,78302,78300,78300,78300,78300,78300,78298,78298,78298,78296
.long 78296,78296,78294,78294,78292,78292,78290,78290,78288,78288,78286,78286,78284,78284,78282,78282
.long 78280,78280,78278,78278,78276,78276,78274,78274,78272,78272,78270,78270,78268,78268,78266,78266
.long 78264,78264,78262,78262,78260,78260,78258,78258,78256,78256,78254,78254,78252,78252,78250,78250
.long 78248,78248,78246,78246,78244,78244,78242,78242,78240,78240,78238,78238,78236,78236,78234,78234
.long 78232,78232,78230,78230,78228,78228,78226,78226,78224,78224,78222,78222,78220,78220,78218,78218
.long 78216,78216,78214,78214,78212,78212,78210,78210,78208,78208,78206,78206,78204,78204,78202,78202
.long 78200,78200,78198,78198,78196,78196,78194,78194,78192,78192,78190,78190,78188,78188,78186,78186
.long 78184,78184,78182,78182,78180,78180,78178,78178,78176,78176,78174,78174,78172,78172,78170,78170
.long 78168,78168,78166,78166,78164,78164,78162,78162,78160,78160,78158,78158,78156,78156,78154,78154
.long 78152,78152,78150,78150,78148,78148,78146,78146,78144,78144,78142,78142,78140,78140,78138,78138
.long 78136,78136,78134,78134,78132,78132,78130,78130,78128,78128,78126,78126,78124,78124,78122,78122
.long 78120,78120,78118,78118,78116,78116,78114,78114,78112,78112,78110,78110,78108,78108,78106,78106
.long 78104,78104,78102,78102,78100,78100,78098,78098,78096,78096,78094,78094,78092,78092,78090,78090
.long 78088,78088,78086,78086,78084,78084,78082,78082,78080,78080,78078,78078,78076,78076,78074,78074
.long 78072,78072,78070,78070,78068,78068,78066,78066,78064,78064,78062,78062,78060,78060,78058,78058
.long 78056,78056,78054,78054,78052,78052,78050,78050,78048,78048,78046,78046,78044,78044,78042,78042
.long 78040,78038,78036,78036,78032,78030,78028,78028,78024,78022,78020,78020,78016,78014,78012,78012
.long 78008,78006,78004,78004,78000,77998,77996,77996,77992,77990,77988,77988,77984,77982,77980,77980
.long 77976,77974,77972,77972,77968,77966,77964,77964,77960,77958,77956,77956,77952,77950,77948,77948
.long 77944,77942,77940,77940,77936,77934,77932,77932,77928,77926,77924,77924,77920,77918,77916,77916
.long 77912,77910,77908,77908,77904,77902,77900,77900,77896,77894,77892,77892,77888,77886,77884,77884
.long 77880,77878,77876,77876,77872,77870,77868,77868,77864,77862,77860,77860,77856,77854,77852,77852
.long 77848,77846,77844,77844,77840,77838,77836,77836,77832,77830,77828,77828,77824,77822,77820,77820
.long 77816,77814,77812,77812,77808,77806,77804,77804,77800,77798,77796,77796,77792,77790,77788,77788
.long 77782,77780,77778,77776,77766,77764,77762,77760,77750,77748,77746,77744,77734,77732,77730,77728
.long 77718,77716,77714,77712,77702,77700,77698,77696,77686,77684,77682,77680,77670,77668,77666,77664
.long 77654,77652,77650,77648,77638,77636,77634,77632,77622,77620,77618,77616,77606,77604,77602,77600
.long 77590,77588,77586,77584,77574,77572,77570,77568,77558,77556,77554,77552,77542,77540,77538,77536
.long 77526,77524,77522,77520,77510,77508,77506,77504,77494,77492,77490,77488,77478,77476,77474,77472
.long 77462,77460,77458,77456,77446,77444,77442,77440,77430,77428,77426,77424,77414,77412,77410,77408
.long 77398,77396,77394,77392,77382,77380,77378,77376,77366,77364,77362,77360,77350,77348,77346,77344
.long 77334,77332,77330,77328,77318,77316,77314,77312,77302,77300,77298,77296,77286,77284,77282,77280
.long 78550,78550,78550,78550,78548,78548,78548,78548,78546,78546,78546,78546,78544,78544,78544,78544
.long 78542,78542,78542,78542,78540,78540,78540,78540,78538,78538,78538,78538,78536,78536,78536,78536
.long 78534,78534,78534,78534,78532,78532,78532,78532,78530,78530,78530,78530,78528,78528,78528,78528
.long 78526,78526,78526,78526,78524,78524,78524,78524,78522,78522,78522,78522,78520,78520,78520,78520
.long 78518,78518,78518,78518,78516,78516,78516,78516,78514,78514,78514,78514,78512,78512,78512,78512
.long 78510,78510,78510,78510,78508,78508,78508,78508,78506,78506,78506,78506,78504,78504,78504,78504
.long 78502,78502,78502,78502,78500,78500,78500,78500,78498,78498,78498,78498,78496,78496,78496,78496
.long 78494,78494,78494,78494,78492,78492,78492,78492,78490,78490,78490,78490,78488,78488,78488,78488
.long 78486,78486,78486,78486,78484,78484,78484,78484,78482,78482,78482,78482,78480,78480,78480,78480
.long 78478,78478,78478,78478,78476,78476,78476,78476,78474,78474,78474,78474,78472,78472,78472,78472
.long 78470,78470,78470,78470,78468,78468,78468,78468,78466,78466,78466,78466,78464,78464,78464,78464
.long 78462,78462,78462,78462,78460,78460,78460,78460,78458,78458,78458,78458,78456,78456,78456,78456
.long 78454,78454,78454,78454,78452,78452,78452,78452,78450,78450,78450,78450,78448,78448,78448,78448
.long 78446,78446,78446,78446,78444,78444,78444,78444,78442,78442,78442,78442,78440,78440,78440,78440
.long 78438,78438,78438,78438,78436,78436,78436,78436,78434,78434,78434,78434,78432,78432,78432,78432
.long 78430,78430,78430,78430,78428,78428,78428,78428,78426,78426,78426,78426,78424,78424,78424,78424
.long 78422,78422,78422,78422,78420,78420,78420,78420,78418,78418,78418,78418,78416,78416,78416,78416
.long 78414,78414,78414,78414,78412,78412,78412,78412,78410,78410,78410,78410,78408,78408,78408,78408
.long 78406,78406,78406,78406,78404,78404,78404,78404,78402,78402,78402,78402,78400,78400,78400,78400
.long 78398,78398,78398,78398,78396,78396,78396,78396,78394,78394,78394,78394,78392,78392,78392,78392
.long 78390,78390,78390,78390,78388,78388,78388,78388,78386,78386,78386,78386,78384,78384,78384,78384
.long 78382,78382,78382,78382,78380,78380,78380,78380,78378,78378,78378,78378,78376,78376,78376,78376
.long 78374,78374,78374,78374,78372,78372,78372,78372,78370,78370,78370,78370,78368,78368,78368,78368
.long 78366,78366,78366,78366,78364,78364,78364,78364,78362,78362,78362,78362,78360,78360,78360,78360
.long 78358,78358,78358,78358,78356,78356,78356,78356,78354,78354,78354,78354,78352,78352,78352,78352
.long 78350,78350,78350,78350,78348,78348,78348,78348,78346,78346,78346,78346,78344,78344,78344,78344
.long 78342,78342,78342,78342,78340,78340,78340,78340,78338,78338,78338,78338,78336,78336,78336,78336
.long 78334,78334,78334,78334,78332,78332,78332,78332,78330,78330,78330,78330,78328,78328,78328,78328
.long 78326,78326,78326,78326,78324,78324,78324,78324,78322,78322,78322,78322,78320,78320,78320,78320
.long 78318,78318,78318,78318,78316,78316,78316,78316,78314,78314,78314,78314,78312,78312,78312,78312
.long 78310,78310,78310,78310,78308,78308,78308,78308,78306,78306,78306,78306,78304,78304,78304,78304
.long 78302,78302,78302,78302,78300,78300,78300,78300,78298,78298,78298,78298,78296,78296,78296,78296
.long 78294,78292,78292,78292,78290,78288,78288,78288,78286,78284,78284,78284,78282,78280,78280,78280
.long 78278,78276,78276,78276,78274,78272,78272,78272,78270,78268,78268,78268,78266,78264,78264,78264
.long 78262,78260,78260,78260,78258,78256,78256,78256,78254,78252,78252,78252,78250,78248,78248,78248
.long 78246,78244,78244,78244,78242,78240,78240,78240,78238,78236,78236,78236,78234,78232,78232,78232
.long 78230,78228,78228,78228,78226,78224,78224,78224,78222,78220,78220,78220,78218,78216,78216,78216
.long 78214,78212,78212,78212,78210,78208,78208,78208,78206,78204,78204,78204,78202,78200,78200,78200
.long 78198,78196,78196,78196,78194,78192,78192,78192,78190,78188,78188,78188,78186,78184,78184,78184
.long 78182,78180,78180,78180,78178,78176,78176,78176,78174,78172,78172,78172,78170,78168,78168,78168
.long 78166,78164,78164,78164,78162,78160,78160,78160,78158,78156,78156,78156,78154,78152,78152,78152
.long 78150,78148,78148,78148,78146,78144,78144,78144,78142,78140,78140,78140,78138,78136,78136,78136
.long 78134,78132,78132,78132,78130,78128,78128,78128,78126,78124,78124,78124,78122,78120,78120,78120
.long 78118,78116,78116,78116,78114,78112,78112,78112,78110,78108,78108,78108,78106,78104,78104,78104
.long 78102,78100,78100,78100,78098,78096,78096,78096,78094,78092,78092,78092,78090,78088,78088,78088
.long 78086,78084,78084,78084,78082,78080,78080,78080,78078,78076,78076,78076,78074,78072,78072,78072
.long 78070,78068,78068,78068,78066,78064,78064,78064,78062,78060,78060,78060,78058,78056,78056,78056
.long 78054,78052,78052,78052,78050,78048,78048,78048,78046,78044,78044,78044,78042,78040,78040,78040
.long 78036,78034,78032,78032,78028,78026,78024,78024,78020,78018,78016,78016,78012,78010,78008,78008
.long 78004,78002,78000,78000,77996,77994,77992,77992,77988,77986,77984,77984,77980,77978,77976,77976
.long 77972,77970,77968,77968,77964,77962,77960,77960,77956,77954,77952,77952,77948,77946,77944,77944
.long 77940,77938,77936,77936,77932,77930,77928,77928,77924,77922,77920,77920,77916,77914,77912,77912
.long 77908,77906,77904,77904,77900,77898,77896,77896,77892,77890,77888,77888,77884,77882,77880,77880
.long 77876,77874,77872,77872,77868,77866,77864,77864,77860,77858,77856,77856,77852,77850,77848,77848
.long 77844,77842,77840,77840,77836,77834,77832,77832,77828,77826,77824,77824,77820,77818,77816,77816
.long 77812,77810,77808,77808,77804,77802,77800,77800,77796,77794,77792,77792,77788,77786,77784,77784
.long 77774,77772,77770,77768,77758,77756,77754,77752,77742,77740,77738,77736,77726,77724,77722,77720
.long 77710,77708,77706,77704,77694,77692,77690,77688,77678,77676,77674,77672,77662,77660,77658,77656
.long 77646,77644,77642,77640,77630,77628,77626,77624,77614,77612,77610,77608,77598,77596,77594,77592
.long 77582,77580,77578,77576,77566,77564,77562,77560,77550,77548,77546,77544,77534,77532,77530,77528
.long 77518,77516,77514,77512,77502,77500,77498,77496,77486,77484,77482,77480,77470,77468,77466,77464
.long 77454,77452,77450,77448,77438,77436,77434,77432,77422,77420,77418,77416,77406,77404,77402,77400
.long 77390,77388,77386,77384,77374,77372,77370,77368,77358,77356,77354,77352,77342,77340,77338,77336
.long 77326,77324,77322,77320,77310,77308,77306,77304,77294,77292,77290,77288,77278,77276,77274,77272
.long 78550,78550,78550,0,78548,78548,78548,16,78546,78546,78546,32,78544,78544,78544,48
.long 78542,78542,78542,64,78540,78540,78540,80,78538,78538,78538,96,78536,78536,78536,112
.long 78534,78534,78534,128,78532,78532,78532,144,78530,78530,78530,160,78528,78528,78528,176
.long 78526,78526,78526,192,78524,78524,78524,208,78522,78522,78522,224,78520,78520,78520,240
.long 78518,78518,78518,256,78516,78516,78516,272,78514,78514,78514,288,78512,78512,78512,304
.long 78510,78510,78510,320,78508,78508,78508,336,78506,78506,78506,352,78504,78504,78504,368
.long 78502,78502,78502,384,78500,78500,78500,400,78498,78498,78498,416,78496,78496,78496,432
.long 78494,78494,78494,448,78492,78492,78492,464,78490,78490,78490,480,78488,78488,78488,496
.long 78486,78486,78486,512,78484,78484,78484,528,78482,78482,78482,544,78480,78480,78480,560
.long 78478,78478,78478,576,78476,78476,78476,592,78474,78474,78474,608,78472,78472,78472,624
.long 78470,78470,78470,640,78468,78468,78468,656,78466,78466,78466,672,78464,78464,78464,688
.long 78462,78462,78462,704,78460,78460,78460,720,78458,78458,78458,736,78456,78456,78456,752
.long 78454,78454,78454,768,78452,78452,78452,784,78450,78450,78450,800,78448,78448,78448,816
.long 78446,78446,78446,832,78444,78444,78444,848,78442,78442,78442,864,78440,78440,78440,880
.long 78438,78438,78438,896,78436,78436,78436,912,78434,78434,78434,928,78432,78432,78432,944
.long 78430,78430,78430,960,78428,78428,78428,976,78426,78426,78426,992,78424,78424,78424,1008
.long 78422,78422,78422,1024,78420,78420,78420,1040,78418,78418,78418,1056,78416,78416,78416,1072
.long 78414,78414,78414,1088,78412,78412,78412,1104,78410,78410,78410,1120,78408,78408,78408,1136
.long 78406,78406,78406,1152,78404,78404,78404,1168,78402,78402,78402,1184,78400,78400,78400,1200
.long 78398,78398,78398,1216,78396,78396,78396,1232,78394,78394,78394,1248,78392,78392,78392,1264
.long 78390,78390,78390,1280,78388,78388,78388,1296,78386,78386,78386,1312,78384,78384,78384,1328
.long 78382,78382,78382,1344,78380,78380,78380,1360,78378,78378,78378,1376,78376,78376,78376,1392
.long 78374,78374,78374,1408,78372,78372,78372,1424,78370,78370,78370,1440,78368,78368,78368,1456
.long 78366,78366,78366,1472,78364,78364,78364,1488,78362,78362,78362,1504,78360,78360,78360,1520
.long 78358,78358,78358,1536,78356,78356,78356,1552,78354,78354,78354,1568,78352,78352,78352,1584
.long 78350,78350,78350,1600,78348,78348,78348,1616,78346,78346,78346,1632,78344,78344,78344,1648
.long 78342,78342,78342,1664,78340,78340,78340,1680,78338,78338,78338,1696,78336,78336,78336,1712
.long 78334,78334,78334,1728,78332,78332,78332,1744,78330,78330,78330,1760,78328,78328,78328,1776
.long 78326,78326,78326,1792,78324,78324,78324,1808,78322,78322,78322,1824,78320,78320,78320,1840
.long 78318,78318,78318,1856,78316,78316,78316,1872,78314,78314,78314,1888,78312,78312,78312,1904
.long 78310,78310,78310,1920,78308,78308,78308,1936,78306,78306,78306,1952,78304,78304,78304,1968
.long 78302,78302,78302,1984,78300,78300,78300,2000,78298,78298,78298,2016,78296,78296,78294,2032
.long 78292,78292,78290,2048,78288,78288,78286,2064,78284,78284,78282,2080,78280,78280,78278,2096
.long 78276,78276,78274,2112,78272,78272,78270,2128,78268,78268,78266,2144,78264,78264,78262,2160
.long 78260,78260,78258,2176,78256,78256,78254,2192,78252,78252,78250,2208,78248,78248,78246,2224
.long 78244,78244,78242,2240,78240,78240,78238,2256,78236,78236,78234,2272,78232,78232,78230,2288
.long 78228,78228,78226,2304,78224,78224,78222,2320,78220,78220,78218,2336,78216,78216,78214,2352
.long 78212,78212,78210,2368,78208,78208,78206,2384,78204,78204,78202,2400,78200,78200,78198,2416
.long 78196,78196,78194,2432,78192,78192,78190,2448,78188,78188,78186,2464,78184,78184,78182,2480
.long 78180,78180,78178,2496,78176,78176,78174,2512,78172,78172,78170,2528,78168,78168,78166,2544
.long 78164,78164,78162,2560,78160,78160,78158,2576,78156,78156,78154,2592,78152,78152,78150,2608
.long 78148,78148,78146,2624,78144,78144,78142,2640,78140,78140,78138,2656,78136,78136,78134,2672
.long 78132,78132,78130,2688,78128,78128,78126,2704,78124,78124,78122,2720,78120,78120,78118,2736
.long 78116,78116,78114,2752,78112,78112,78110,2768,78108,78108,78106,2784,78104,78104,78102,2800
.long 78100,78100,78098,2816,78096,78096,78094,2832,78092,78092,78090,2848,78088,78088,78086,2864
.long 78084,78084,78082,2880,78080,78080,78078,2896,78076,78076,78074,2912,78072,78072,78070,2928
.long 78068,78068,78066,2944,78064,78064,78062,2960,78060,78060,78058,2976,78056,78056,78054,2992
.long 78052,78052,78050,3008,78048,78048,78046,3024,78044,78044,78042,3040,78040,78038,78036,3056
.long 78032,78030,78028,3072,78024,78022,78020,3088,78016,78014,78012,3104,78008,78006,78004,3120
.long 78000,77998,77996,3136,77992,77990,77988,3152,77984,77982,77980,3168,77976,77974,77972,3184
.long 77968,77966,77964,3200,77960,77958,77956,3216,77952,77950,77948,3232,77944,77942,77940,3248
.long 77936,77934,77932,3264,77928,77926,77924,3280,77920,77918,77916,3296,77912,77910,77908,3312
.long 77904,77902,77900,3328,77896,77894,77892,3344,77888,77886,77884,3360,77880,77878,77876,3376
.long 77872,77870,77868,3392,77864,77862,77860,3408,77856,77854,77852,3424,77848,77846,77844,3440
.long 77840,77838,77836,3456,77832,77830,77828,3472,77824,77822,77820,3488,77816,77814,77812,3504
.long 77808,77806,77804,3520,77800,77798,77796,3536,77792,77790,77788,3552,77782,77780,77778,3568
.long 77766,77764,77762,3584,77750,77748,77746,3600,77734,77732,77730,3616,77718,77716,77714,3632
.long 77702,77700,77698,3648,77686,77684,77682,3664,77670,77668,77666,3680,77654,77652,77650,3696
.long 77638,77636,77634,3712,77622,77620,77618,3728,77606,77604,77602,3744,77590,77588,77586,3760
.long 77574,77572,77570,3776,77558,77556,77554,3792,77542,77540,77538,3808,77526,77524,77522,3824
.long 77510,77508,77506,3840,77494,77492,77490,3856,77478,77476,77474,3872,77462,77460,77458,3888
.long 77446,77444,77442,3904,77430,77428,77426,3920,77414,77412,77410,3936,77398,77396,77394,3952
.long 77382,77380,77378,3968,77366,77364,77362,3984,77350,77348,77346,4000,77334,77332,77330,4016
.long 77318,77316,77314,4032,77302,77300,77298,4048,77286,77284,77282,4064,77270,77268,77266,4080
L_tabend:
.size L_table, L_tabend-L_table
.section .rodata,"a"
.p2align 6
.amdhsa_kernel concat_heads__spectral_gfnet__ssm_conv_s4__prompt_kernel
  .amdhsa_next_free_vgpr 128
  .amdhsa_next_free_sgpr 102
  .amdhsa_accum_offset 128
  .amdhsa_group_segment_fixed_size 0
  .amdhsa_kernarg_size 120
  .amdhsa_user_sgpr_count 2
  .amdhsa_user_sgpr_kernarg_segment_ptr 1
  .amdhsa_system_sgpr_workgroup_id_x 1
.end_amdhsa_kernel
```
